```python
import torch

def _softmax(x, axis=-1):
    return torch.softmax(x, dim=axis)
def _gelu(x):
    return torch.nn.functional.gelu(x, approximate="tanh")
def _silu(x):
    return torch.nn.functional.silu(x)
def _sigmoid(x):
    return torch.sigmoid(x)
def _layernorm(x, axis=-1, eps=1e-5):
    m = x.mean(dim=axis, keepdim=True)
    v = x.var(dim=axis, keepdim=True, unbiased=False)
    return (x - m) / torch.sqrt(v + eps)
def _scatter_add(tgt, idx, src, axis=0):
    return tgt.clone().index_add_(axis, idx, src)
def _segment_sum(src, seg, n):
    out = torch.zeros((n,) + src.shape[1:], dtype=src.dtype)
    return out.index_add_(0, seg, src)
def _pad(x, pw):
    flat = tuple(v for pair in reversed(pw) for v in pair)
    return torch.nn.functional.pad(x, flat)

kernel_name = 'recurrent_scan__spectral_gfnet__dense_activation_squared_relu__prompt'

def setup_inputs():

    _w = (lambda a: (lambda t: t.to(torch.bfloat16) if t.is_floating_point() else t)(torch.as_tensor(a)))
    def _A_setup():
        B, S, D = 1, 2048, 1024
        Df = D // 2 + 1
        return {
            "x": _w((lambda *s: torch.randn(*s, dtype=torch.bfloat16) * 0.05)(B, S, D)),
            "w_r": _w((lambda *s: torch.randn(*s, dtype=torch.bfloat16) * 0.05)(S, Df) * 0.02),
            "w_i": _w((lambda *s: torch.randn(*s, dtype=torch.bfloat16) * 0.05)(S, Df) * 0.02),
        }
    _A_in = _A_setup()

    def _B_setup():
        B, S, D, F = 1, 2048, 1024, 3584
        return {
            "x": _w((lambda *s: torch.randn(*s, dtype=torch.bfloat16) * 0.05)(B, S, D)),
            "w1": _w((lambda *s: torch.randn(*s, dtype=torch.bfloat16) * 0.05)(D, F)),
            "b1": _w((lambda *s: torch.randn(*s, dtype=torch.bfloat16) * 0.4)(F)),
            "w2": _w((lambda *s: torch.randn(*s, dtype=torch.bfloat16) * 0.05)(F, D)),
            "b2": _w((lambda *s: torch.randn(*s, dtype=torch.bfloat16) * 3.2)(D)),
        }
    _B_in = _B_setup()

    return {
        "A_x": _A_in["x"],
        "A_w_r": _A_in["w_r"],
        "A_w_i": _A_in["w_i"],
        "B_x": _B_in["x"],
        "B_w1": _B_in["w1"],
        "B_b1": _B_in["b1"],
        "B_w2": _B_in["w2"],
        "B_b2": _B_in["b2"],
    }

def reference(A_x, A_w_r, A_w_i, B_x, B_w1, B_b1, B_w2, B_b2):
    def _A_ref(x, w_r, w_i):
        B, S, D = x.shape
        X = (lambda x, axes=(-2,-1): torch.fft.rfft2(x.float(), dim=axes))(x, axes=(-2, -1))
        W = w_r + 1j * w_i
        X = X * W
        y = (lambda x, s, axes=(-2,-1): torch.fft.irfft2(x, s=s, dim=axes).to(torch.bfloat16))(X, (S, D), axes=(-2, -1))
        return y

    def _B_ref(x, w1, b1, w2, b2):
        h = torch.einsum("bsd,df->bsf", x, w1) + b1
        zero = torch.zeros_like(h)
        r = torch.where(h > zero, h, zero)
        h = r * r
        out = torch.einsum("bsf,fd->bsd", h, w2) + b2
        return out

    x = A_x
    xn = _layernorm(x, axis=-1)
    s = _A_ref(xn, A_w_r, A_w_i)
    g = _silu(_B_ref(xn, B_w1, B_b1, B_w2, B_b2))
    return x + s * g
```

```asm
; @launch grid=(256,1,1) block=(512,1,1) lds=156288
.amdgcn_target "amdgcn-amd-amdhsa--gfx950"
.text
.globl recurrent_scan__spectral_gfnet__dense_activation_squared_relu__prompt_kernel
.p2align 8
.type recurrent_scan__spectral_gfnet__dense_activation_squared_relu__prompt_kernel,@function
recurrent_scan__spectral_gfnet__dense_activation_squared_relu__prompt_kernel:
    s_cmp_ge_u32 s2, 256
    s_cbranch_scc1 K_end
    s_load_dwordx16 s[4:19], s[0:1], 0
    s_load_dwordx4 s[20:23], s[0:1], 64
    s_load_dwordx2 s[24:25], s[0:1], 80
    s_getpc_b64 s[60:61]
K_pc:
    s_lshr_b32 s62, s2, 3
    v_lshrrev_b32 v2, 5, v0
    v_lshl_add_u32 v2, v2, 5, s62
    v_lshlrev_b32 v2, 7, v2
    v_min_u32 v2, K_end-K_pc, v2
    global_load_dword v255, v2, s[60:61]
    v_lshrrev_b32 v1, 6, v0
    s_mov_b32 s79, 0x40000
    v_readfirstlane_b32 s3, v1
    s_and_b32 s60, s2, 4
    s_lshl_b32 s60, s60, 1
    s_lshr_b32 s59, s2, 5
    s_add_u32 s60, s60, s59
    s_and_b32 s61, s2, 3
    s_lshl_b32 s61, s61, 2
    s_bfe_u32 s59, s2, 0x20003
    s_add_u32 s61, s61, s59
    s_and_b32 s62, s2, 1
    s_lshl_b32 s62, s62, 2
    s_bfe_u32 s59, s2, 0x20003
    s_add_u32 s62, s62, s59
    s_bfe_u32 s63, s2, 0x10001
    s_and_b32 s75, s2, 4
    s_lshl_b32 s75, s75, 5
    s_lshr_b32 s59, s2, 4
    s_lshl_b32 s59, s59, 3
    s_add_u32 s75, s75, s59
    s_and_b32 s59, s2, 3
    s_lshl1_add_u32 s75, s59, s75
    s_bfe_u32 s59, s2, 0x10003
    s_add_u32 s75, s75, s59
    s_waitcnt lgkmcnt(0)
    s_cmp_ge_u32 s3, 6
    s_cbranch_scc1 K_worker
    s_cmp_ge_u32 s3, 4
    s_cbranch_scc1 K_loader
    s_mov_b32 s28, s4
    s_and_b32 s29, s5, 0xffff
    s_mov_b32 s30, 0x400000
    s_mov_b32 s31, 0x20000
    v_and_b32 v7, 63, v0
    s_and_b32 s48, s75, 31
    s_lshr_b32 s49, s75, 5
    s_lshl_b32 s49, s49, 2
    s_add_u32 s49, s49, s3
    s_lshl_b32 s49, s49, 5
    s_add_u32 s48, s48, s49
    s_lshl_b32 s49, s48, 12
    s_mul_i32 s50, s3, 4352
    s_add_u32 s50, s50, 90112
    s_mov_b32 m0, s50
    v_lshlrev_b32 v3, 4, v7
    buffer_load_dwordx4 v3, s[28:31], s49 offen lds
    buffer_load_dwordx4 v3, s[28:31], s49 offen offset:1024 lds
    s_add_u32 m0, s50, 128
    v_and_b32 v1, 31, v0
    buffer_load_dwordx4 v3, s[28:31], s49 offen offset:2048 lds
    buffer_load_dwordx4 v3, s[28:31], s49 offen offset:3072 lds
    v_bfe_u32 v2, v0, 5, 1
    v_lshlrev_b32 v4, 2, v2
    v_mul_u32_u24 v4, v4, v1
    v_mad_u32_u24 v8, v1, 0, v4
    v_cvt_f32_u32 v8, v8
    v_mul_f32 v9, 0x3d000000, v8
    v_mul_f32 v8, 0x3a800000, v8
    v_fract_f32 v9, v9
    v_cos_f32 v10, v9
    v_sin_f32 v11, v9
    v_cos_f32 v80, v8
    v_sin_f32 v81, v8
    v_cvt_pk_bf16_f32 v48, v10, v11
    v_cvt_pk_bf16_f32 v64, -v11, v10
    v_mad_u32_u24 v12, v1, 1, v4
    v_cvt_f32_u32 v12, v12
    v_mul_f32 v13, 0x3d000000, v12
    v_mul_f32 v12, 0x3a800000, v12
    v_fract_f32 v13, v13
    v_cos_f32 v14, v13
    v_sin_f32 v15, v13
    v_cos_f32 v82, v12
    v_sin_f32 v83, v12
    v_cvt_pk_bf16_f32 v49, v14, v15
    v_cvt_pk_bf16_f32 v65, -v15, v14
    v_mad_u32_u24 v8, v1, 2, v4
    v_cvt_f32_u32 v8, v8
    v_mul_f32 v9, 0x3d000000, v8
    v_mul_f32 v8, 0x3a800000, v8
    v_fract_f32 v9, v9
    v_cos_f32 v10, v9
    v_sin_f32 v11, v9
    v_cos_f32 v84, v8
    v_sin_f32 v85, v8
    v_cvt_pk_bf16_f32 v50, v10, v11
    v_cvt_pk_bf16_f32 v66, -v11, v10
    v_mad_u32_u24 v12, v1, 3, v4
    v_cvt_f32_u32 v12, v12
    v_mul_f32 v13, 0x3d000000, v12
    v_mul_f32 v12, 0x3a800000, v12
    v_fract_f32 v13, v13
    v_cos_f32 v14, v13
    v_sin_f32 v15, v13
    v_cos_f32 v86, v12
    v_sin_f32 v87, v12
    v_cvt_pk_bf16_f32 v51, v14, v15
    v_cvt_pk_bf16_f32 v67, -v15, v14
    v_mad_u32_u24 v8, v1, 8, v4
    v_cvt_f32_u32 v8, v8
    v_mul_f32 v9, 0x3d000000, v8
    v_mul_f32 v8, 0x3a800000, v8
    v_fract_f32 v9, v9
    v_cos_f32 v10, v9
    v_sin_f32 v11, v9
    v_cos_f32 v88, v8
    v_sin_f32 v89, v8
    v_cvt_pk_bf16_f32 v52, v10, v11
    v_cvt_pk_bf16_f32 v68, -v11, v10
    v_mad_u32_u24 v12, v1, 9, v4
    v_cvt_f32_u32 v12, v12
    v_mul_f32 v13, 0x3d000000, v12
    v_mul_f32 v12, 0x3a800000, v12
    v_fract_f32 v13, v13
    v_cos_f32 v14, v13
    v_sin_f32 v15, v13
    v_cos_f32 v90, v12
    v_sin_f32 v91, v12
    v_cvt_pk_bf16_f32 v53, v14, v15
    v_cvt_pk_bf16_f32 v69, -v15, v14
    v_mad_u32_u24 v8, v1, 10, v4
    v_cvt_f32_u32 v8, v8
    v_mul_f32 v9, 0x3d000000, v8
    v_mul_f32 v8, 0x3a800000, v8
    v_fract_f32 v9, v9
    v_cos_f32 v10, v9
    v_sin_f32 v11, v9
    v_cos_f32 v92, v8
    v_sin_f32 v93, v8
    v_cvt_pk_bf16_f32 v54, v10, v11
    v_cvt_pk_bf16_f32 v70, -v11, v10
    v_mad_u32_u24 v12, v1, 11, v4
    v_cvt_f32_u32 v12, v12
    v_mul_f32 v13, 0x3d000000, v12
    v_mul_f32 v12, 0x3a800000, v12
    v_fract_f32 v13, v13
    v_cos_f32 v14, v13
    v_sin_f32 v15, v13
    v_cos_f32 v94, v12
    v_sin_f32 v95, v12
    v_cvt_pk_bf16_f32 v55, v14, v15
    v_cvt_pk_bf16_f32 v71, -v15, v14
    v_mad_u32_u24 v8, v1, 16, v4
    v_cvt_f32_u32 v8, v8
    v_mul_f32 v9, 0x3d000000, v8
    v_mul_f32 v8, 0x3a800000, v8
    v_fract_f32 v9, v9
    v_cos_f32 v10, v9
    v_sin_f32 v11, v9
    v_cos_f32 v96, v8
    v_sin_f32 v97, v8
    v_cvt_pk_bf16_f32 v56, v10, v11
    v_cvt_pk_bf16_f32 v72, -v11, v10
    v_mad_u32_u24 v12, v1, 17, v4
    v_cvt_f32_u32 v12, v12
    v_mul_f32 v13, 0x3d000000, v12
    v_mul_f32 v12, 0x3a800000, v12
    v_fract_f32 v13, v13
    v_cos_f32 v14, v13
    v_sin_f32 v15, v13
    v_cos_f32 v98, v12
    v_sin_f32 v99, v12
    v_cvt_pk_bf16_f32 v57, v14, v15
    v_cvt_pk_bf16_f32 v73, -v15, v14
    v_mad_u32_u24 v8, v1, 18, v4
    v_cvt_f32_u32 v8, v8
    v_mul_f32 v9, 0x3d000000, v8
    v_mul_f32 v8, 0x3a800000, v8
    v_fract_f32 v9, v9
    v_cos_f32 v10, v9
    v_sin_f32 v11, v9
    v_cos_f32 v100, v8
    v_sin_f32 v101, v8
    v_cvt_pk_bf16_f32 v58, v10, v11
    v_cvt_pk_bf16_f32 v74, -v11, v10
    v_mad_u32_u24 v12, v1, 19, v4
    v_cvt_f32_u32 v12, v12
    v_mul_f32 v13, 0x3d000000, v12
    v_mul_f32 v12, 0x3a800000, v12
    v_fract_f32 v13, v13
    v_cos_f32 v14, v13
    v_sin_f32 v15, v13
    v_cos_f32 v102, v12
    v_sin_f32 v103, v12
    v_cvt_pk_bf16_f32 v59, v14, v15
    v_cvt_pk_bf16_f32 v75, -v15, v14
    v_mad_u32_u24 v8, v1, 24, v4
    v_cvt_f32_u32 v8, v8
    v_mul_f32 v9, 0x3d000000, v8
    v_mul_f32 v8, 0x3a800000, v8
    v_fract_f32 v9, v9
    v_cos_f32 v10, v9
    v_sin_f32 v11, v9
    v_cos_f32 v104, v8
    v_sin_f32 v105, v8
    v_cvt_pk_bf16_f32 v60, v10, v11
    v_cvt_pk_bf16_f32 v76, -v11, v10
    v_mad_u32_u24 v12, v1, 25, v4
    v_cvt_f32_u32 v12, v12
    v_mul_f32 v13, 0x3d000000, v12
    v_mul_f32 v12, 0x3a800000, v12
    v_fract_f32 v13, v13
    v_cos_f32 v14, v13
    v_sin_f32 v15, v13
    v_cos_f32 v106, v12
    v_sin_f32 v107, v12
    v_cvt_pk_bf16_f32 v61, v14, v15
    v_cvt_pk_bf16_f32 v77, -v15, v14
    v_mad_u32_u24 v8, v1, 26, v4
    v_cvt_f32_u32 v8, v8
    v_mul_f32 v9, 0x3d000000, v8
    v_mul_f32 v8, 0x3a800000, v8
    v_fract_f32 v9, v9
    v_cos_f32 v10, v9
    v_sin_f32 v11, v9
    v_cos_f32 v108, v8
    v_sin_f32 v109, v8
    v_cvt_pk_bf16_f32 v62, v10, v11
    v_cvt_pk_bf16_f32 v78, -v11, v10
    v_mad_u32_u24 v12, v1, 27, v4
    v_cvt_f32_u32 v12, v12
    v_mul_f32 v13, 0x3d000000, v12
    v_mul_f32 v12, 0x3a800000, v12
    v_fract_f32 v13, v13
    v_cos_f32 v14, v13
    v_sin_f32 v15, v13
    v_cos_f32 v110, v12
    v_sin_f32 v111, v12
    v_cvt_pk_bf16_f32 v63, v14, v15
    v_cvt_pk_bf16_f32 v79, -v15, v14
    v_bfe_u32 v3, v7, 2, 1
    v_mul_u32_u24 v3, 2176, v3
    v_bfe_u32 v4, v7, 3, 1
    v_lshl_add_u32 v3, v4, 6, v3
    v_bfe_u32 v4, v7, 4, 1
    v_lshl_add_u32 v3, v4, 5, v3
    v_and_b32 v4, 3, v7
    v_lshl_add_u32 v3, v4, 3, v3
    v_lshl_add_u32 v3, v2, 8, v3
    v_add_u32 v3, s50, v3
    s_lshl_b32 s50, s3, 2
    s_add_u32 s50, s50, 107520
    v_lshlrev_b32 v5, 4, v1
    v_lshl_add_u32 v5, v2, 12, v5
    v_cmp_eq_u32 vcc, 0, v1
    v_mov_b32 v4, 5120
    v_mov_b32 v6, 5632
    v_cndmask_b32 v6, v4, v6, vcc
    v_sub_u32 v6, v6, v5
    v_add_u32 v5, s50, v5
    v_add_u32 v6, s50, v6
    s_waitcnt vmcnt(0)
    ds_read_b64_tr_b16 v[112:113], v3 offset:0
    ds_read_b64_tr_b16 v[114:115], v3 offset:128
    ds_read_b64_tr_b16 v[116:117], v3 offset:512
    ds_read_b64_tr_b16 v[118:119], v3 offset:640
    ds_read_b64_tr_b16 v[120:121], v3 offset:1024
    ds_read_b64_tr_b16 v[122:123], v3 offset:1152
    ds_read_b64_tr_b16 v[124:125], v3 offset:1536
    ds_read_b64_tr_b16 v[126:127], v3 offset:1664
    s_waitcnt lgkmcnt(7)
    v_lshlrev_b32 v16, 16, v112
    v_and_b32 v17, 0xffff0000, v112
    v_lshlrev_b32 v18, 16, v113
    v_and_b32 v19, 0xffff0000, v113
    s_waitcnt lgkmcnt(6)
    v_lshlrev_b32 v20, 16, v114
    v_and_b32 v21, 0xffff0000, v114
    v_lshlrev_b32 v22, 16, v115
    v_and_b32 v23, 0xffff0000, v115
    s_waitcnt lgkmcnt(5)
    v_lshlrev_b32 v24, 16, v116
    v_and_b32 v25, 0xffff0000, v116
    v_lshlrev_b32 v26, 16, v117
    v_and_b32 v27, 0xffff0000, v117
    s_waitcnt lgkmcnt(4)
    v_lshlrev_b32 v28, 16, v118
    v_and_b32 v29, 0xffff0000, v118
    v_lshlrev_b32 v30, 16, v119
    v_and_b32 v31, 0xffff0000, v119
    s_waitcnt lgkmcnt(3)
    v_lshlrev_b32 v32, 16, v120
    v_and_b32 v33, 0xffff0000, v120
    v_lshlrev_b32 v34, 16, v121
    v_and_b32 v35, 0xffff0000, v121
    s_waitcnt lgkmcnt(2)
    v_lshlrev_b32 v36, 16, v122
    v_and_b32 v37, 0xffff0000, v122
    v_lshlrev_b32 v38, 16, v123
    v_and_b32 v39, 0xffff0000, v123
    s_waitcnt lgkmcnt(1)
    v_lshlrev_b32 v40, 16, v124
    v_and_b32 v41, 0xffff0000, v124
    v_lshlrev_b32 v42, 16, v125
    v_and_b32 v43, 0xffff0000, v125
    s_waitcnt lgkmcnt(0)
    v_lshlrev_b32 v44, 16, v126
    v_and_b32 v45, 0xffff0000, v126
    v_lshlrev_b32 v46, 16, v127
    v_and_b32 v47, 0xffff0000, v127
    v_pk_add_f32 v[128:129], v[16:17], v[18:19]
    v_pk_add_f32 v[130:131], v[20:21], v[22:23]
    v_pk_add_f32 v[132:133], v[24:25], v[26:27]
    v_pk_add_f32 v[134:135], v[28:29], v[30:31]
    v_pk_add_f32 v[136:137], v[32:33], v[34:35]
    v_pk_add_f32 v[138:139], v[36:37], v[38:39]
    v_pk_add_f32 v[140:141], v[40:41], v[42:43]
    v_pk_add_f32 v[142:143], v[44:45], v[46:47]
    v_pk_add_f32 v[128:129], v[128:129], v[136:137]
    v_pk_add_f32 v[130:131], v[130:131], v[138:139]
    v_pk_add_f32 v[132:133], v[132:133], v[140:141]
    v_pk_add_f32 v[134:135], v[134:135], v[142:143]
    v_pk_add_f32 v[128:129], v[128:129], v[132:133]
    v_pk_add_f32 v[130:131], v[130:131], v[134:135]
    v_pk_add_f32 v[128:129], v[128:129], v[130:131]
    s_nop 1
    v_add_f32_dpp v128, v128, v128 quad_perm:[1,0,3,2] row_mask:0xf bank_mask:0xf
    v_add_f32_dpp v129, v129, v129 quad_perm:[1,0,3,2] row_mask:0xf bank_mask:0xf
    s_nop 1
    v_add_f32_dpp v128, v128, v128 quad_perm:[2,3,0,1] row_mask:0xf bank_mask:0xf
    v_add_f32_dpp v129, v129, v129 quad_perm:[2,3,0,1] row_mask:0xf bank_mask:0xf
    s_nop 1
    v_add_f32_dpp v128, v128, v128 row_half_mirror row_mask:0xf bank_mask:0xf
    v_add_f32_dpp v129, v129, v129 row_half_mirror row_mask:0xf bank_mask:0xf
    s_nop 1
    v_add_f32_dpp v128, v128, v128 row_mirror row_mask:0xf bank_mask:0xf
    v_add_f32_dpp v129, v129, v129 row_mirror row_mask:0xf bank_mask:0xf
    v_mov_b32 v8, v128
    v_mov_b32 v9, v129
    s_nop 1
    v_permlane16_swap_b32 v128, v8
    v_permlane16_swap_b32 v129, v9
    s_nop 0
    v_add_f32 v128, v128, v8
    v_add_f32 v129, v129, v9
    v_mov_b32 v8, v128
    v_mov_b32 v9, v129
    s_nop 1
    v_permlane32_swap_b32 v128, v8
    v_permlane32_swap_b32 v129, v9
    s_nop 0
    v_add_f32 v128, v128, v8
    v_add_f32 v129, v129, v9
    v_mul_f32 v10, 0x3a800000, v128
    v_mul_f32 v11, 0x3a800000, v129
    v_pk_add_f32 v[16:17], v[16:17], v[10:11] neg_lo:[0,1] neg_hi:[0,1]
    v_pk_add_f32 v[18:19], v[18:19], v[10:11] neg_lo:[0,1] neg_hi:[0,1]
    v_pk_add_f32 v[20:21], v[20:21], v[10:11] neg_lo:[0,1] neg_hi:[0,1]
    v_pk_add_f32 v[22:23], v[22:23], v[10:11] neg_lo:[0,1] neg_hi:[0,1]
    v_pk_add_f32 v[24:25], v[24:25], v[10:11] neg_lo:[0,1] neg_hi:[0,1]
    v_pk_add_f32 v[26:27], v[26:27], v[10:11] neg_lo:[0,1] neg_hi:[0,1]
    v_pk_add_f32 v[28:29], v[28:29], v[10:11] neg_lo:[0,1] neg_hi:[0,1]
    v_pk_add_f32 v[30:31], v[30:31], v[10:11] neg_lo:[0,1] neg_hi:[0,1]
    v_pk_add_f32 v[32:33], v[32:33], v[10:11] neg_lo:[0,1] neg_hi:[0,1]
    v_pk_add_f32 v[34:35], v[34:35], v[10:11] neg_lo:[0,1] neg_hi:[0,1]
    v_pk_add_f32 v[36:37], v[36:37], v[10:11] neg_lo:[0,1] neg_hi:[0,1]
    v_pk_add_f32 v[38:39], v[38:39], v[10:11] neg_lo:[0,1] neg_hi:[0,1]
    v_pk_add_f32 v[40:41], v[40:41], v[10:11] neg_lo:[0,1] neg_hi:[0,1]
    v_pk_add_f32 v[42:43], v[42:43], v[10:11] neg_lo:[0,1] neg_hi:[0,1]
    v_pk_add_f32 v[44:45], v[44:45], v[10:11] neg_lo:[0,1] neg_hi:[0,1]
    v_pk_add_f32 v[46:47], v[46:47], v[10:11] neg_lo:[0,1] neg_hi:[0,1]
    v_pk_mul_f32 v[128:129], v[16:17], v[16:17]
    v_pk_mul_f32 v[130:131], v[18:19], v[18:19]
    v_pk_mul_f32 v[132:133], v[20:21], v[20:21]
    v_pk_mul_f32 v[134:135], v[22:23], v[22:23]
    v_pk_fma_f32 v[128:129], v[24:25], v[24:25], v[128:129]
    v_pk_fma_f32 v[130:131], v[26:27], v[26:27], v[130:131]
    v_pk_fma_f32 v[132:133], v[28:29], v[28:29], v[132:133]
    v_pk_fma_f32 v[134:135], v[30:31], v[30:31], v[134:135]
    v_pk_fma_f32 v[128:129], v[32:33], v[32:33], v[128:129]
    v_pk_fma_f32 v[130:131], v[34:35], v[34:35], v[130:131]
    v_pk_fma_f32 v[132:133], v[36:37], v[36:37], v[132:133]
    v_pk_fma_f32 v[134:135], v[38:39], v[38:39], v[134:135]
    v_pk_fma_f32 v[128:129], v[40:41], v[40:41], v[128:129]
    v_pk_fma_f32 v[130:131], v[42:43], v[42:43], v[130:131]
    v_pk_fma_f32 v[132:133], v[44:45], v[44:45], v[132:133]
    v_pk_fma_f32 v[134:135], v[46:47], v[46:47], v[134:135]
    v_pk_add_f32 v[128:129], v[128:129], v[132:133]
    v_pk_add_f32 v[130:131], v[130:131], v[134:135]
    v_pk_add_f32 v[128:129], v[128:129], v[130:131]
    s_nop 1
    v_add_f32_dpp v128, v128, v128 quad_perm:[1,0,3,2] row_mask:0xf bank_mask:0xf
    v_add_f32_dpp v129, v129, v129 quad_perm:[1,0,3,2] row_mask:0xf bank_mask:0xf
    s_nop 1
    v_add_f32_dpp v128, v128, v128 quad_perm:[2,3,0,1] row_mask:0xf bank_mask:0xf
    v_add_f32_dpp v129, v129, v129 quad_perm:[2,3,0,1] row_mask:0xf bank_mask:0xf
    s_nop 1
    v_add_f32_dpp v128, v128, v128 row_half_mirror row_mask:0xf bank_mask:0xf
    v_add_f32_dpp v129, v129, v129 row_half_mirror row_mask:0xf bank_mask:0xf
    s_nop 1
    v_add_f32_dpp v128, v128, v128 row_mirror row_mask:0xf bank_mask:0xf
    v_add_f32_dpp v129, v129, v129 row_mirror row_mask:0xf bank_mask:0xf
    v_mov_b32 v8, v128
    v_mov_b32 v9, v129
    s_nop 1
    v_permlane16_swap_b32 v128, v8
    v_permlane16_swap_b32 v129, v9
    s_nop 0
    v_add_f32 v128, v128, v8
    v_add_f32 v129, v129, v9
    v_mov_b32 v8, v128
    v_mov_b32 v9, v129
    s_nop 1
    v_permlane32_swap_b32 v128, v8
    v_permlane32_swap_b32 v129, v9
    s_nop 0
    v_add_f32 v128, v128, v8
    v_add_f32 v129, v129, v9
    v_mul_f32 v128, 0x3a800000, v128
    v_mul_f32 v129, 0x3a800000, v129
    v_cvt_pk_bf16_f32 v8, v128, v129
    v_cvt_pk_bf16_f32 v9, v10, v11
    v_lshlrev_b32 v128, 16, v8
    v_and_b32 v129, 0xffff0000, v8
    v_lshlrev_b32 v12, 16, v9
    v_and_b32 v14, 0xffff0000, v9
    v_add_f32 v128, 0x3727c5ac, v128
    v_add_f32 v129, 0x3727c5ac, v129
    v_cvt_pk_bf16_f32 v8, v128, v129
    v_lshlrev_b32 v128, 16, v8
    v_and_b32 v129, 0xffff0000, v8
    v_sqrt_f32 v128, v128
    v_sqrt_f32 v129, v129
    v_sub_f32 v10, v10, v12
    v_cvt_pk_bf16_f32 v8, v128, v129
    v_lshlrev_b32 v13, 16, v8
    v_and_b32 v15, 0xffff0000, v8
    v_rcp_f32 v8, v13
    v_rcp_f32 v9, v15
    v_sub_f32 v11, v11, v14
    s_lshl_b32 s49, s3, 4
    s_add_u32 s49, s49, 155968
    v_mul_f32 v8, 0x35000000, v8
    v_mul_f32 v9, 0x35000000, v9
    v_mov_b32 v7, s49
    v_mul_f32 v10, v10, v8
    v_mul_f32 v11, v11, v9
    v_pk_fma_f32 v[16:17], v[16:17], v[8:9], v[10:11]
    v_cvt_pk_bf16_f32 v112, v16, v17
    v_pk_fma_f32 v[18:19], v[18:19], v[8:9], v[10:11]
    v_cvt_pk_bf16_f32 v113, v18, v19
    v_pk_fma_f32 v[20:21], v[20:21], v[8:9], v[10:11]
    v_cvt_pk_bf16_f32 v114, v20, v21
    v_pk_fma_f32 v[22:23], v[22:23], v[8:9], v[10:11]
    v_cvt_pk_bf16_f32 v115, v22, v23
    v_pk_fma_f32 v[24:25], v[24:25], v[8:9], v[10:11]
    v_cvt_pk_bf16_f32 v116, v24, v25
    v_pk_fma_f32 v[26:27], v[26:27], v[8:9], v[10:11]
    v_cvt_pk_bf16_f32 v117, v26, v27
    v_pk_fma_f32 v[28:29], v[28:29], v[8:9], v[10:11]
    v_cvt_pk_bf16_f32 v118, v28, v29
    v_pk_fma_f32 v[30:31], v[30:31], v[8:9], v[10:11]
    v_cvt_pk_bf16_f32 v119, v30, v31
    v_pk_fma_f32 v[32:33], v[32:33], v[8:9], v[10:11]
    v_cvt_pk_bf16_f32 v120, v32, v33
    v_pk_fma_f32 v[34:35], v[34:35], v[8:9], v[10:11]
    v_cvt_pk_bf16_f32 v121, v34, v35
    v_pk_fma_f32 v[36:37], v[36:37], v[8:9], v[10:11]
    v_cvt_pk_bf16_f32 v122, v36, v37
    v_pk_fma_f32 v[38:39], v[38:39], v[8:9], v[10:11]
    v_cvt_pk_bf16_f32 v123, v38, v39
    v_pk_fma_f32 v[40:41], v[40:41], v[8:9], v[10:11]
    v_cvt_pk_bf16_f32 v124, v40, v41
    v_pk_fma_f32 v[42:43], v[42:43], v[8:9], v[10:11]
    v_cvt_pk_bf16_f32 v125, v42, v43
    v_pk_fma_f32 v[44:45], v[44:45], v[8:9], v[10:11]
    v_cvt_pk_bf16_f32 v126, v44, v45
    v_pk_fma_f32 v[46:47], v[46:47], v[8:9], v[10:11]
    v_cvt_pk_bf16_f32 v127, v46, v47
    s_mov_b64 exec, 1
    ds_write_b128 v7, v[12:15]
    s_mov_b64 exec, -1
    v_mfma_f32_32x32x16_bf16 v[128:143], v[112:115], v[48:51], 0
    v_mfma_f32_32x32x16_bf16 v[144:159], v[112:115], v[64:67], 0
    v_mfma_f32_32x32x16_bf16 v[128:143], v[116:119], v[52:55], v[128:143]
    v_mfma_f32_32x32x16_bf16 v[144:159], v[116:119], v[68:71], v[144:159]
    v_mfma_f32_32x32x16_bf16 v[128:143], v[120:123], v[56:59], v[128:143]
    v_mfma_f32_32x32x16_bf16 v[144:159], v[120:123], v[72:75], v[144:159]
    v_mfma_f32_32x32x16_bf16 v[128:143], v[124:127], v[60:63], v[128:143]
    v_mfma_f32_32x32x16_bf16 v[144:159], v[124:127], v[76:79], v[144:159]
    s_nop 11
    s_nop 0
    v_pk_mul_f32 v[8:9], v[128:129], v[80:81] op_sel:[0,0] op_sel_hi:[0,1] neg_hi:[0,1]
    v_pk_fma_f32 v[8:9], v[144:145], v[80:81], v[8:9] op_sel:[0,1,0] op_sel_hi:[0,0,1]
    v_cvt_pk_bf16_f32 v112, v8, v9
    v_pk_mul_f32 v[10:11], v[128:129], v[82:83] op_sel:[1,0] op_sel_hi:[1,1] neg_hi:[0,1]
    v_pk_fma_f32 v[10:11], v[144:145], v[82:83], v[10:11] op_sel:[1,1,0] op_sel_hi:[1,0,1]
    v_cvt_pk_bf16_f32 v113, v10, v11
    v_pk_mul_f32 v[8:9], v[130:131], v[84:85] op_sel:[0,0] op_sel_hi:[0,1] neg_hi:[0,1]
    v_pk_fma_f32 v[8:9], v[146:147], v[84:85], v[8:9] op_sel:[0,1,0] op_sel_hi:[0,0,1]
    v_cvt_pk_bf16_f32 v114, v8, v9
    v_pk_mul_f32 v[10:11], v[130:131], v[86:87] op_sel:[1,0] op_sel_hi:[1,1] neg_hi:[0,1]
    v_pk_fma_f32 v[10:11], v[146:147], v[86:87], v[10:11] op_sel:[1,1,0] op_sel_hi:[1,0,1]
    v_cvt_pk_bf16_f32 v115, v10, v11
    v_pk_mul_f32 v[8:9], v[132:133], v[88:89] op_sel:[0,0] op_sel_hi:[0,1] neg_hi:[0,1]
    v_pk_fma_f32 v[8:9], v[148:149], v[88:89], v[8:9] op_sel:[0,1,0] op_sel_hi:[0,0,1]
    v_cvt_pk_bf16_f32 v116, v8, v9
    v_pk_mul_f32 v[10:11], v[132:133], v[90:91] op_sel:[1,0] op_sel_hi:[1,1] neg_hi:[0,1]
    v_pk_fma_f32 v[10:11], v[148:149], v[90:91], v[10:11] op_sel:[1,1,0] op_sel_hi:[1,0,1]
    v_cvt_pk_bf16_f32 v117, v10, v11
    v_pk_mul_f32 v[8:9], v[134:135], v[92:93] op_sel:[0,0] op_sel_hi:[0,1] neg_hi:[0,1]
    v_pk_fma_f32 v[8:9], v[150:151], v[92:93], v[8:9] op_sel:[0,1,0] op_sel_hi:[0,0,1]
    v_cvt_pk_bf16_f32 v118, v8, v9
    v_pk_mul_f32 v[10:11], v[134:135], v[94:95] op_sel:[1,0] op_sel_hi:[1,1] neg_hi:[0,1]
    v_pk_fma_f32 v[10:11], v[150:151], v[94:95], v[10:11] op_sel:[1,1,0] op_sel_hi:[1,0,1]
    v_cvt_pk_bf16_f32 v119, v10, v11
    v_pk_mul_f32 v[8:9], v[136:137], v[96:97] op_sel:[0,0] op_sel_hi:[0,1] neg_hi:[0,1]
    v_pk_fma_f32 v[8:9], v[152:153], v[96:97], v[8:9] op_sel:[0,1,0] op_sel_hi:[0,0,1]
    v_cvt_pk_bf16_f32 v120, v8, v9
    v_pk_mul_f32 v[10:11], v[136:137], v[98:99] op_sel:[1,0] op_sel_hi:[1,1] neg_hi:[0,1]
    v_pk_fma_f32 v[10:11], v[152:153], v[98:99], v[10:11] op_sel:[1,1,0] op_sel_hi:[1,0,1]
    v_cvt_pk_bf16_f32 v121, v10, v11
    v_pk_mul_f32 v[8:9], v[138:139], v[100:101] op_sel:[0,0] op_sel_hi:[0,1] neg_hi:[0,1]
    v_pk_fma_f32 v[8:9], v[154:155], v[100:101], v[8:9] op_sel:[0,1,0] op_sel_hi:[0,0,1]
    v_cvt_pk_bf16_f32 v122, v8, v9
    v_pk_mul_f32 v[10:11], v[138:139], v[102:103] op_sel:[1,0] op_sel_hi:[1,1] neg_hi:[0,1]
    v_pk_fma_f32 v[10:11], v[154:155], v[102:103], v[10:11] op_sel:[1,1,0] op_sel_hi:[1,0,1]
    v_cvt_pk_bf16_f32 v123, v10, v11
    v_pk_mul_f32 v[8:9], v[140:141], v[104:105] op_sel:[0,0] op_sel_hi:[0,1] neg_hi:[0,1]
    v_pk_fma_f32 v[8:9], v[156:157], v[104:105], v[8:9] op_sel:[0,1,0] op_sel_hi:[0,0,1]
    v_cvt_pk_bf16_f32 v124, v8, v9
    v_pk_mul_f32 v[10:11], v[140:141], v[106:107] op_sel:[1,0] op_sel_hi:[1,1] neg_hi:[0,1]
    v_pk_fma_f32 v[10:11], v[156:157], v[106:107], v[10:11] op_sel:[1,1,0] op_sel_hi:[1,0,1]
    v_cvt_pk_bf16_f32 v125, v10, v11
    v_pk_mul_f32 v[8:9], v[142:143], v[108:109] op_sel:[0,0] op_sel_hi:[0,1] neg_hi:[0,1]
    v_pk_fma_f32 v[8:9], v[158:159], v[108:109], v[8:9] op_sel:[0,1,0] op_sel_hi:[0,0,1]
    v_cvt_pk_bf16_f32 v126, v8, v9
    v_pk_mul_f32 v[10:11], v[142:143], v[110:111] op_sel:[1,0] op_sel_hi:[1,1] neg_hi:[0,1]
    v_pk_fma_f32 v[10:11], v[158:159], v[110:111], v[10:11] op_sel:[1,1,0] op_sel_hi:[1,0,1]
    v_cvt_pk_bf16_f32 v127, v10, v11
    s_nop 1
    v_mfma_f32_32x32x16_bf16 v[128:143], v[48:51], v[112:115], 0
    v_mfma_f32_32x32x16_bf16 v[144:159], v[64:67], v[112:115], 0
    v_mfma_f32_32x32x16_bf16 v[128:143], v[52:55], v[116:119], v[128:143]
    v_mfma_f32_32x32x16_bf16 v[144:159], v[68:71], v[116:119], v[144:159]
    v_mfma_f32_32x32x16_bf16 v[128:143], v[56:59], v[120:123], v[128:143]
    v_mfma_f32_32x32x16_bf16 v[144:159], v[72:75], v[120:123], v[144:159]
    v_mfma_f32_32x32x16_bf16 v[128:143], v[60:63], v[124:127], v[128:143]
    v_mfma_f32_32x32x16_bf16 v[144:159], v[76:79], v[124:127], v[144:159]
    s_nop 11
    v_cvt_pk_bf16_f32 v112, v128, v144
    ds_write_b32 v5, v112 offset:0
    v_cvt_pk_bf16_f32 v113, v129, v145
    ds_write_b32 v5, v113 offset:1024
    v_cvt_pk_bf16_f32 v114, v130, v146
    ds_write_b32 v5, v114 offset:2048
    v_cvt_pk_bf16_f32 v115, v131, v147
    ds_write_b32 v5, v115 offset:3072
    v_cvt_pk_bf16_f32 v116, v132, v148
    ds_write_b32 v5, v116 offset:8192
    v_cvt_pk_bf16_f32 v117, v133, v149
    ds_write_b32 v5, v117 offset:9216
    v_cvt_pk_bf16_f32 v118, v134, v150
    ds_write_b32 v5, v118 offset:10240
    v_cvt_pk_bf16_f32 v119, v135, v151
    ds_write_b32 v5, v119 offset:11264
    v_cvt_pk_bf16_f32 v120, v136, -v152
    ds_write_b32 v6, v120 offset:11264
    v_cvt_pk_bf16_f32 v121, v137, -v153
    ds_write_b32 v6, v121 offset:10240
    v_cvt_pk_bf16_f32 v122, v138, -v154
    ds_write_b32 v6, v122 offset:9216
    v_cvt_pk_bf16_f32 v123, v139, -v155
    ds_write_b32 v6, v123 offset:8192
    v_cvt_pk_bf16_f32 v124, v140, -v156
    ds_write_b32 v6, v124 offset:3072
    v_cvt_pk_bf16_f32 v125, v141, -v157
    ds_write_b32 v6, v125 offset:2048
    v_cvt_pk_bf16_f32 v126, v142, -v158
    ds_write_b32 v6, v126 offset:1024
    v_cvt_pk_bf16_f32 v127, v143, -v159
    ds_write_b32 v6, v127 offset:0
    v_cvt_pk_bf16_f32 v8, v128, -v144
    v_cvt_pk_bf16_f32 v9, v136, v152
    s_mov_b64 exec, 1
    ds_write_b32 v5, v8 offset:512
    ds_write_b32 v5, v9 offset:16384
    s_mov_b64 exec, -1
    v_mov_b32 v8, 155936
    v_mov_b32 v9, 1
    s_mov_b64 exec, 1
    ds_add_u32 v8, v9
    s_mov_b64 exec, -1
    s_setprio 2
    s_mov_b32 s32, s24
    s_and_b32 s33, s25, 0xffff
    s_mov_b32 s34, 0x10000000
    s_mov_b32 s35, 0x20000
    s_mov_b32 s36, s18
    s_and_b32 s37, s19, 0xffff
    s_mov_b32 s38, 0x800
    s_mov_b32 s39, 0x20000
    s_mov_b32 s40, s20
    s_and_b32 s41, s21, 0xffff
    s_mov_b32 s42, 0x400000
    s_mov_b32 s43, 0x20000
    v_and_b32 v1, 63, v0
    s_lshr_b32 s50, s3, 1
    s_and_b32 s51, s3, 1
    v_and_b32 v16, 15, v1
    v_lshrrev_b32 v17, 4, v1
    s_lshl_b32 s52, s50, 6
    v_add_u32 v18, s52, v16
    v_lshrrev_b32 v19, 1, v16
    v_xor_b32 v19, v19, v17
    v_lshlrev_b32 v19, 4, v19
    v_lshl_add_u32 v2, v18, 7, v19
    v_xor_b32 v3, 64, v2
    v_lshrrev_b32 v19, 2, v16
    v_lshl_add_u32 v19, v17, 3, v19
    v_mul_u32_u24 v19, 448, v19
    v_and_b32 v20, 3, v16
    v_lshl_add_u32 v19, v20, 3, v19
    s_lshl_b32 s52, s51, 8
    s_add_u32 s52, s52, 16384
    v_add_u32 v19, s52, v19
    v_and_b32 v20, 1, v17
    v_lshlrev_b32 v20, 5, v20
    v_add_u32 v4, v19, v20
    v_sub_u32 v5, v19, v20
    s_cmp_eq_u32 s51, 0
    s_cselect_b64 vcc, -1, 0
    v_subrev_u32 v6, 224, v5
    s_nop 0
    v_cndmask_b32 v6, v6, v4, vcc
    v_lshrrev_b32 v19, 2, v16
    v_sub_u32 v19, 0, v19
    v_and_b32 v19, 3, v19
    v_xor_b32 v19, v19, v17
    v_lshlrev_b32 v19, 4, v19
    v_lshl_add_u32 v7, v18, 6, v19
    v_mov_b32 v8, 155904
    v_and_b32 v19, 1, v17
    v_lshrrev_b32 v20, 1, v17
    v_lshl_add_u32 v19, v19, 1, v20
    v_lshrrev_b32 v20, 1, v16
    v_xor_b32 v19, v19, v20
    v_xor_b32 v20, v17, v20
    v_sub_u32 v19, v19, v20
    v_lshlrev_b32 v19, 4, v19
    s_lshl_b32 s52, s63, 12
    v_add_u32 v9, s52, v19
    s_lshr_b32 s53, s62, 0
    s_lshl_b32 s53, s53, 1
    s_lshl_b32 s54, s51, 0
    s_add_u32 s53, s53, s54
    s_mov_b32 s54, 0
    s_mov_b32 s55, 45056
    s_mov_b32 s57, 4294877184
    s_mov_b32 s58, 45056
    s_waitcnt lgkmcnt(0)
    s_barrier
    ds_read_b128 v[40:43], v2 offset:0
    ds_read_b64_tr_b16 v[56:57], v4 offset:0
    ds_read_b64_tr_b16 v[58:59], v4 offset:1792
    ds_read_b128 v[44:47], v2 offset:2048
    ds_read_b128 v[48:51], v2 offset:4096
    ds_read_b128 v[52:55], v2 offset:6144
    ds_read_b64_tr_b16 v[60:61], v5 offset:32
    ds_read_b64_tr_b16 v[62:63], v5 offset:1824
    ds_read_b64_tr_b16 v[64:65], v4 offset:64
    ds_read_b64_tr_b16 v[66:67], v4 offset:1856
    ds_read_b64_tr_b16 v[68:69], v5 offset:96
    ds_read_b64_tr_b16 v[70:71], v5 offset:1888
    ds_read_b64_tr_b16 v[72:73], v4 offset:128
    ds_read_b64_tr_b16 v[74:75], v4 offset:1920
    ds_read_b64_tr_b16 v[76:77], v5 offset:160
    ds_read_b64_tr_b16 v[78:79], v5 offset:1952
    ds_read_b64_tr_b16 v[80:81], v6 offset:192
    ds_read_b64_tr_b16 v[82:83], v6 offset:1984
    s_waitcnt lgkmcnt(15)
    v_mfma_f32_16x16x32_bf16 v[128:131], v[56:59], v[40:43], 0
    ds_read_b128 v[84:87], v3 offset:0
    s_waitcnt lgkmcnt(15)
    v_mfma_f32_16x16x32_bf16 v[132:135], v[56:59], v[44:47], 0
    ds_read_b64_tr_b16 v[100:101], v4 offset:14336
    s_cmp_lg_u32 s54, s53
    s_cbranch_scc1 C1_xq
    v_add_u32 v10, v9, v2
    v_xor_b32 v11, 64, v10
    ds_read_b128 v[240:243], v10 offset:0
    ds_read_b128 v[244:247], v11 offset:0
    ds_read_b128 v[248:251], v10 offset:2048
    ds_read_b128 v[252:255], v11 offset:2048
C1_xq:
    s_waitcnt lgkmcnt(15)
    v_mfma_f32_16x16x32_bf16 v[136:139], v[56:59], v[48:51], 0
    ds_read_b64_tr_b16 v[102:103], v4 offset:16128
    s_waitcnt lgkmcnt(15)
    v_mfma_f32_16x16x32_bf16 v[140:143], v[56:59], v[52:55], 0
    ds_read_b128 v[88:91], v3 offset:2048
    s_waitcnt lgkmcnt(14)
    v_mfma_f32_16x16x32_bf16 v[156:159], v[60:63], v[52:55], 0
    ds_read_b128 v[92:95], v3 offset:4096
    v_mfma_f32_16x16x32_bf16 v[152:155], v[60:63], v[48:51], 0
    ds_read_b128 v[96:99], v3 offset:6144
    v_mfma_f32_16x16x32_bf16 v[148:151], v[60:63], v[44:47], 0
    ds_read_b64_tr_b16 v[104:105], v5 offset:14368
    v_mfma_f32_16x16x32_bf16 v[144:147], v[60:63], v[40:43], 0
    ds_read_b64_tr_b16 v[106:107], v5 offset:16160
    s_waitcnt lgkmcnt(15)
    v_mfma_f32_16x16x32_bf16 v[160:163], v[64:67], v[40:43], 0
    ds_read_b64_tr_b16 v[108:109], v4 offset:14400
    v_mfma_f32_16x16x32_bf16 v[164:167], v[64:67], v[44:47], 0
    ds_read_b64_tr_b16 v[110:111], v4 offset:16192
    v_mfma_f32_16x16x32_bf16 v[168:171], v[64:67], v[48:51], 0
    ds_read_b64_tr_b16 v[112:113], v5 offset:14432
    v_mfma_f32_16x16x32_bf16 v[172:175], v[64:67], v[52:55], 0
    ds_read_b64_tr_b16 v[114:115], v5 offset:16224
    s_waitcnt lgkmcnt(15)
    v_mfma_f32_16x16x32_bf16 v[188:191], v[68:71], v[52:55], 0
    ds_read_b64_tr_b16 v[116:117], v4 offset:14464
    v_mfma_f32_16x16x32_bf16 v[184:187], v[68:71], v[48:51], 0
    ds_read_b64_tr_b16 v[118:119], v4 offset:16256
    v_mfma_f32_16x16x32_bf16 v[180:183], v[68:71], v[44:47], 0
    ds_read_b64_tr_b16 v[120:121], v5 offset:14496
    v_mfma_f32_16x16x32_bf16 v[176:179], v[68:71], v[40:43], 0
    ds_read_b64_tr_b16 v[122:123], v5 offset:16288
    v_mfma_f32_16x16x32_bf16 v[192:195], v[72:75], v[40:43], 0
    ds_read_b64_tr_b16 v[124:125], v6 offset:14528
    v_mfma_f32_16x16x32_bf16 v[196:199], v[72:75], v[44:47], 0
    ds_read_b64_tr_b16 v[126:127], v6 offset:16320
    v_mfma_f32_16x16x32_bf16 v[200:203], v[72:75], v[48:51], 0
    v_add_u32 v2, s55, v2
    v_mfma_f32_16x16x32_bf16 v[204:207], v[72:75], v[52:55], 0
    v_add_u32 v4, s55, v4
    s_waitcnt lgkmcnt(15)
    v_mfma_f32_16x16x32_bf16 v[220:223], v[76:79], v[52:55], 0
    v_add_u32 v5, s55, v5
    v_mfma_f32_16x16x32_bf16 v[216:219], v[76:79], v[48:51], 0
    v_add_u32 v6, s55, v6
    v_mfma_f32_16x16x32_bf16 v[212:215], v[76:79], v[44:47], 0
    v_add_u32 v3, s55, v3
    v_mfma_f32_16x16x32_bf16 v[208:211], v[76:79], v[40:43], 0
    s_waitcnt lgkmcnt(0)
    s_barrier
    v_mfma_f32_16x16x32_bf16 v[224:227], v[80:83], v[40:43], 0
    v_mfma_f32_16x16x32_bf16 v[228:231], v[80:83], v[44:47], 0
    v_mfma_f32_16x16x32_bf16 v[232:235], v[80:83], v[48:51], 0
    v_mfma_f32_16x16x32_bf16 v[236:239], v[80:83], v[52:55], 0
    s_branch C1_mid
C1_loop:
    s_waitcnt lgkmcnt(15)
    v_mfma_f32_16x16x32_bf16 v[128:131], v[56:59], v[40:43], v[128:131]
    ds_read_b128 v[84:87], v3 offset:0
    s_waitcnt lgkmcnt(15)
    v_mfma_f32_16x16x32_bf16 v[132:135], v[56:59], v[44:47], v[132:135]
    ds_read_b64_tr_b16 v[100:101], v4 offset:14336
    s_cmp_lg_u32 s54, s53
    s_cbranch_scc1 C1_xr
    v_add_u32 v10, v9, v2
    v_xor_b32 v11, 64, v10
    ds_read_b128 v[240:243], v10 offset:0
    ds_read_b128 v[244:247], v11 offset:0
    ds_read_b128 v[248:251], v10 offset:2048
    ds_read_b128 v[252:255], v11 offset:2048
C1_xr:
    s_waitcnt lgkmcnt(15)
    v_mfma_f32_16x16x32_bf16 v[136:139], v[56:59], v[48:51], v[136:139]
    ds_read_b64_tr_b16 v[102:103], v4 offset:16128
    s_waitcnt lgkmcnt(15)
    v_mfma_f32_16x16x32_bf16 v[140:143], v[56:59], v[52:55], v[140:143]
    ds_read_b128 v[88:91], v3 offset:2048
    s_waitcnt lgkmcnt(14)
    v_mfma_f32_16x16x32_bf16 v[156:159], v[60:63], v[52:55], v[156:159]
    ds_read_b128 v[92:95], v3 offset:4096
    v_mfma_f32_16x16x32_bf16 v[152:155], v[60:63], v[48:51], v[152:155]
    ds_read_b128 v[96:99], v3 offset:6144
    v_mfma_f32_16x16x32_bf16 v[148:151], v[60:63], v[44:47], v[148:151]
    ds_read_b64_tr_b16 v[104:105], v5 offset:14368
    v_mfma_f32_16x16x32_bf16 v[144:147], v[60:63], v[40:43], v[144:147]
    ds_read_b64_tr_b16 v[106:107], v5 offset:16160
    s_waitcnt lgkmcnt(15)
    v_mfma_f32_16x16x32_bf16 v[160:163], v[64:67], v[40:43], v[160:163]
    ds_read_b64_tr_b16 v[108:109], v4 offset:14400
    v_mfma_f32_16x16x32_bf16 v[164:167], v[64:67], v[44:47], v[164:167]
    ds_read_b64_tr_b16 v[110:111], v4 offset:16192
    v_mfma_f32_16x16x32_bf16 v[168:171], v[64:67], v[48:51], v[168:171]
    ds_read_b64_tr_b16 v[112:113], v5 offset:14432
    v_mfma_f32_16x16x32_bf16 v[172:175], v[64:67], v[52:55], v[172:175]
    ds_read_b64_tr_b16 v[114:115], v5 offset:16224
    s_waitcnt lgkmcnt(15)
    v_mfma_f32_16x16x32_bf16 v[188:191], v[68:71], v[52:55], v[188:191]
    ds_read_b64_tr_b16 v[116:117], v4 offset:14464
    v_mfma_f32_16x16x32_bf16 v[184:187], v[68:71], v[48:51], v[184:187]
    ds_read_b64_tr_b16 v[118:119], v4 offset:16256
    v_mfma_f32_16x16x32_bf16 v[180:183], v[68:71], v[44:47], v[180:183]
    ds_read_b64_tr_b16 v[120:121], v5 offset:14496
    v_mfma_f32_16x16x32_bf16 v[176:179], v[68:71], v[40:43], v[176:179]
    ds_read_b64_tr_b16 v[122:123], v5 offset:16288
    v_mfma_f32_16x16x32_bf16 v[192:195], v[72:75], v[40:43], v[192:195]
    ds_read_b64_tr_b16 v[124:125], v6 offset:14528
    v_mfma_f32_16x16x32_bf16 v[196:199], v[72:75], v[44:47], v[196:199]
    ds_read_b64_tr_b16 v[126:127], v6 offset:16320
    v_mfma_f32_16x16x32_bf16 v[200:203], v[72:75], v[48:51], v[200:203]
    v_add_u32 v2, s55, v2
    v_mfma_f32_16x16x32_bf16 v[204:207], v[72:75], v[52:55], v[204:207]
    v_add_u32 v4, s55, v4
    s_waitcnt lgkmcnt(15)
    v_mfma_f32_16x16x32_bf16 v[220:223], v[76:79], v[52:55], v[220:223]
    v_add_u32 v5, s55, v5
    v_mfma_f32_16x16x32_bf16 v[216:219], v[76:79], v[48:51], v[216:219]
    v_add_u32 v6, s55, v6
    v_mfma_f32_16x16x32_bf16 v[212:215], v[76:79], v[44:47], v[212:215]
    v_add_u32 v3, s55, v3
    v_mfma_f32_16x16x32_bf16 v[208:211], v[76:79], v[40:43], v[208:211]
    s_waitcnt lgkmcnt(0)
    s_barrier
    v_mfma_f32_16x16x32_bf16 v[224:227], v[80:83], v[40:43], v[224:227]
    v_mfma_f32_16x16x32_bf16 v[228:231], v[80:83], v[44:47], v[228:231]
    v_mfma_f32_16x16x32_bf16 v[232:235], v[80:83], v[48:51], v[232:235]
    v_mfma_f32_16x16x32_bf16 v[236:239], v[80:83], v[52:55], v[236:239]
C1_mid:
    v_mfma_f32_16x16x32_bf16 v[128:131], v[100:103], v[84:87], v[128:131]
    ds_read_b128 v[40:43], v2 offset:0
    v_mfma_f32_16x16x32_bf16 v[132:135], v[100:103], v[88:91], v[132:135]
    ds_read_b64_tr_b16 v[56:57], v4 offset:0
    v_mfma_f32_16x16x32_bf16 v[136:139], v[100:103], v[92:95], v[136:139]
    ds_read_b64_tr_b16 v[58:59], v4 offset:1792
    v_mfma_f32_16x16x32_bf16 v[140:143], v[100:103], v[96:99], v[140:143]
    ds_read_b128 v[44:47], v2 offset:2048
    v_mfma_f32_16x16x32_bf16 v[156:159], v[104:107], v[96:99], v[156:159]
    ds_read_b128 v[48:51], v2 offset:4096
    v_mfma_f32_16x16x32_bf16 v[152:155], v[104:107], v[92:95], v[152:155]
    ds_read_b128 v[52:55], v2 offset:6144
    v_mfma_f32_16x16x32_bf16 v[148:151], v[104:107], v[88:91], v[148:151]
    ds_read_b64_tr_b16 v[60:61], v5 offset:32
    v_mfma_f32_16x16x32_bf16 v[144:147], v[104:107], v[84:87], v[144:147]
    ds_read_b64_tr_b16 v[62:63], v5 offset:1824
    v_mfma_f32_16x16x32_bf16 v[160:163], v[108:111], v[84:87], v[160:163]
    ds_read_b64_tr_b16 v[64:65], v4 offset:64
    v_mfma_f32_16x16x32_bf16 v[164:167], v[108:111], v[88:91], v[164:167]
    ds_read_b64_tr_b16 v[66:67], v4 offset:1856
    v_mfma_f32_16x16x32_bf16 v[168:171], v[108:111], v[92:95], v[168:171]
    ds_read_b64_tr_b16 v[68:69], v5 offset:96
    v_mfma_f32_16x16x32_bf16 v[172:175], v[108:111], v[96:99], v[172:175]
    ds_read_b64_tr_b16 v[70:71], v5 offset:1888
    v_mfma_f32_16x16x32_bf16 v[188:191], v[112:115], v[96:99], v[188:191]
    ds_read_b64_tr_b16 v[72:73], v4 offset:128
    v_mfma_f32_16x16x32_bf16 v[184:187], v[112:115], v[92:95], v[184:187]
    ds_read_b64_tr_b16 v[74:75], v4 offset:1920
    v_mfma_f32_16x16x32_bf16 v[180:183], v[112:115], v[88:91], v[180:183]
    ds_read_b64_tr_b16 v[76:77], v5 offset:160
    v_mfma_f32_16x16x32_bf16 v[176:179], v[112:115], v[84:87], v[176:179]
    ds_read_b64_tr_b16 v[78:79], v5 offset:1952
    v_mfma_f32_16x16x32_bf16 v[192:195], v[116:119], v[84:87], v[192:195]
    ds_read_b64_tr_b16 v[80:81], v6 offset:192
    v_mfma_f32_16x16x32_bf16 v[196:199], v[116:119], v[88:91], v[196:199]
    ds_read_b64_tr_b16 v[82:83], v6 offset:1984
    v_mfma_f32_16x16x32_bf16 v[200:203], v[116:119], v[92:95], v[200:203]
    v_mfma_f32_16x16x32_bf16 v[204:207], v[116:119], v[96:99], v[204:207]
    v_mfma_f32_16x16x32_bf16 v[220:223], v[120:123], v[96:99], v[220:223]
    v_mfma_f32_16x16x32_bf16 v[216:219], v[120:123], v[92:95], v[216:219]
    v_mfma_f32_16x16x32_bf16 v[212:215], v[120:123], v[88:91], v[212:215]
    v_mfma_f32_16x16x32_bf16 v[208:211], v[120:123], v[84:87], v[208:211]
    s_add_u32 s59, s54, 1
    s_mul_i32 s59, s59, 0x5556
    v_mfma_f32_16x16x32_bf16 v[224:227], v[124:127], v[84:87], v[224:227]
    s_lshr_b32 s59, s59, 16
    s_mul_i32 s59, s59, 3
    v_mfma_f32_16x16x32_bf16 v[228:231], v[124:127], v[88:91], v[228:231]
    s_add_u32 s54, s54, 1
    s_sub_u32 s59, s54, s59
    v_mfma_f32_16x16x32_bf16 v[232:235], v[124:127], v[92:95], v[232:235]
    s_cmp_eq_u32 s59, 2
    s_cselect_b32 s55, s57, s58
    v_mfma_f32_16x16x32_bf16 v[236:239], v[124:127], v[96:99], v[236:239]
    s_cmp_lt_u32 s54, 16
    s_cbranch_scc1 C1_loop
    s_waitcnt lgkmcnt(0)
    v_lshlrev_b32 v14, 3, v16
    s_lshl_b32 s52, s51, 10
    s_add_u32 s52, s52, 135168
    v_add_u32 v14, s52, v14
    s_mul_i32 s52, s51, 896
    v_subrev_u32 v15, s52, v14
    v_lshlrev_b32 v11, 3, v18
    v_add_u32 v11, 136960, v11
    v_mov_b32 v40, 0
    v_mov_b32 v41, 0
    v_mov_b32 v42, 0
    v_mov_b32 v43, 0
    v_mov_b32 v44, 0
    v_mov_b32 v45, 0
    v_mov_b32 v46, 0
    v_mov_b32 v47, 0
    v_mov_b32 v48, 0
    v_mov_b32 v49, 0
    v_mov_b32 v50, 0
    v_mov_b32 v51, 0
    v_mov_b32 v52, 0
    v_mov_b32 v53, 0
    v_mov_b32 v54, 0
    v_mov_b32 v55, 0
    v_mov_b32 v56, 0
    v_mov_b32 v57, 0
    v_mov_b32 v58, 0
    v_mov_b32 v59, 0
    v_mov_b32 v60, 0
    v_mov_b32 v61, 0
    v_mov_b32 v62, 0
    v_mov_b32 v63, 0
C1_epi:
    ds_read_b64 v[20:21], v8
    s_mov_b64 exec, 0xffff
    ds_read_b64 v[56:57], v11 offset:0
    ds_read_b64 v[58:59], v11 offset:128
    ds_read_b64 v[60:61], v11 offset:256
    ds_read_b64 v[62:63], v11 offset:384
    ds_read_b64 v[40:41], v14 offset:0
    ds_read_b64 v[42:43], v14 offset:128
    ds_read_b64 v[44:45], v14 offset:256
    ds_read_b64 v[46:47], v14 offset:384
    ds_read_b64 v[48:49], v14 offset:512
    ds_read_b64 v[50:51], v14 offset:640
    ds_read_b64 v[52:53], v15 offset:768
    s_mov_b64 exec, -1
    s_lshl_b32 s54, s51, 3
    s_lshl_b32 s55, s51, 15
    s_waitcnt lgkmcnt(0)
    v_readfirstlane_b32 s64, v20
    v_readfirstlane_b32 s56, v21
    s_nop 0
    s_cmp_eq_u32 s56, 2
    s_cbranch_scc1 C1_epiok
    s_sub_u32 s79, s79, 1
    s_cbranch_scc0 C1_epi
    s_movk_i32 s78, 1
    s_branch K_bail
C1_epiok:
    v_add_u32 v14, s55, v7
    v_add_u32 v15, s54, v7
    s_lshl_b32 s54, s51, 2
    s_add_u32 s54, s54, 155940
    v_mov_b32 v20, s54
    v_mov_b32 v21, 1
    v_mfma_f32_16x16x16_bf16 v[128:131], v[40:41], v[56:57], v[128:131]
    v_mfma_f32_16x16x16_bf16 v[144:147], v[42:43], v[56:57], v[144:147]
    v_mfma_f32_16x16x16_bf16 v[132:135], v[40:41], v[58:59], v[132:135]
    s_nop 5
    v_mfma_f32_16x16x16_bf16 v[148:151], v[42:43], v[58:59], v[148:151]
    v_mul_f32 v128, v128, |v128|
    v_mul_f32 v129, v129, |v129|
    v_mul_f32 v130, v130, |v130|
    v_mul_f32 v131, v131, |v131|
    v_cvt_pk_bf16_f32 v64, v128, v129
    v_cvt_pk_bf16_f32 v65, v130, v131
    v_pk_max_i16 v64, v64, 0
    v_pk_max_i16 v65, v65, 0
    v_mfma_f32_16x16x16_bf16 v[224:227], v[52:53], v[56:57], v[224:227]
    v_mfma_f32_16x16x16_bf16 v[136:139], v[40:41], v[60:61], v[136:139]
    v_mul_f32 v144, v144, |v144|
    v_mul_f32 v145, v145, |v145|
    v_mul_f32 v146, v146, |v146|
    v_mul_f32 v147, v147, |v147|
    v_cvt_pk_bf16_f32 v66, v144, v145
    v_cvt_pk_bf16_f32 v67, v146, v147
    v_pk_max_i16 v66, v66, 0
    v_pk_max_i16 v67, v67, 0
    ds_write_b128 v14, v[64:67] offset:0
    v_mfma_f32_16x16x16_bf16 v[152:155], v[42:43], v[60:61], v[152:155]
    v_mul_f32 v132, v132, |v132|
    v_mul_f32 v133, v133, |v133|
    v_mul_f32 v134, v134, |v134|
    v_mul_f32 v135, v135, |v135|
    v_cvt_pk_bf16_f32 v68, v132, v133
    v_cvt_pk_bf16_f32 v69, v134, v135
    v_pk_max_i16 v68, v68, 0
    v_pk_max_i16 v69, v69, 0
    v_mfma_f32_16x16x16_bf16 v[228:231], v[52:53], v[58:59], v[228:231]
    v_mfma_f32_16x16x16_bf16 v[140:143], v[40:41], v[62:63], v[140:143]
    v_mul_f32 v148, v148, |v148|
    v_mul_f32 v149, v149, |v149|
    v_mul_f32 v150, v150, |v150|
    v_mul_f32 v151, v151, |v151|
    v_cvt_pk_bf16_f32 v70, v148, v149
    v_cvt_pk_bf16_f32 v71, v150, v151
    v_pk_max_i16 v70, v70, 0
    v_pk_max_i16 v71, v71, 0
    ds_write_b128 v14, v[68:71] offset:1024
    v_mfma_f32_16x16x16_bf16 v[156:159], v[42:43], v[62:63], v[156:159]
    v_mul_f32 v136, v136, |v136|
    v_mul_f32 v137, v137, |v137|
    v_mul_f32 v138, v138, |v138|
    v_mul_f32 v139, v139, |v139|
    v_cvt_pk_bf16_f32 v72, v136, v137
    v_cvt_pk_bf16_f32 v73, v138, v139
    v_pk_max_i16 v72, v72, 0
    v_pk_max_i16 v73, v73, 0
    v_mfma_f32_16x16x16_bf16 v[232:235], v[52:53], v[60:61], v[232:235]
    v_mfma_f32_16x16x16_bf16 v[160:163], v[44:45], v[56:57], v[160:163]
    v_mul_f32 v152, v152, |v152|
    v_mul_f32 v153, v153, |v153|
    v_mul_f32 v154, v154, |v154|
    v_mul_f32 v155, v155, |v155|
    v_cvt_pk_bf16_f32 v74, v152, v153
    v_cvt_pk_bf16_f32 v75, v154, v155
    v_pk_max_i16 v74, v74, 0
    v_pk_max_i16 v75, v75, 0
    ds_write_b128 v14, v[72:75] offset:2048
    v_mfma_f32_16x16x16_bf16 v[176:179], v[46:47], v[56:57], v[176:179]
    v_mul_f32 v140, v140, |v140|
    v_mul_f32 v141, v141, |v141|
    v_mul_f32 v142, v142, |v142|
    v_mul_f32 v143, v143, |v143|
    v_cvt_pk_bf16_f32 v76, v140, v141
    v_cvt_pk_bf16_f32 v77, v142, v143
    v_pk_max_i16 v76, v76, 0
    v_pk_max_i16 v77, v77, 0
    v_mfma_f32_16x16x16_bf16 v[236:239], v[52:53], v[62:63], v[236:239]
    v_mfma_f32_16x16x16_bf16 v[164:167], v[44:45], v[58:59], v[164:167]
    v_mul_f32 v156, v156, |v156|
    v_mul_f32 v157, v157, |v157|
    v_mul_f32 v158, v158, |v158|
    v_mul_f32 v159, v159, |v159|
    v_cvt_pk_bf16_f32 v78, v156, v157
    v_cvt_pk_bf16_f32 v79, v158, v159
    v_pk_max_i16 v78, v78, 0
    v_pk_max_i16 v79, v79, 0
    ds_write_b128 v14, v[76:79] offset:3072
    s_mov_b64 exec, 1
    ds_add_u32 v20, v21 offset:0
    s_mov_b64 exec, -1
    v_mfma_f32_16x16x16_bf16 v[180:183], v[46:47], v[58:59], v[180:183]
    v_mul_f32 v160, v160, |v160|
    v_mul_f32 v161, v161, |v161|
    v_mul_f32 v162, v162, |v162|
    v_mul_f32 v163, v163, |v163|
    v_cvt_pk_bf16_f32 v80, v160, v161
    v_cvt_pk_bf16_f32 v81, v162, v163
    v_pk_max_i16 v80, v80, 0
    v_pk_max_i16 v81, v81, 0
    v_mfma_f32_16x16x16_bf16 v[168:171], v[44:45], v[60:61], v[168:171]
    v_mul_f32 v176, v176, |v176|
    v_mul_f32 v177, v177, |v177|
    v_mul_f32 v178, v178, |v178|
    v_mul_f32 v179, v179, |v179|
    v_cvt_pk_bf16_f32 v82, v176, v177
    v_cvt_pk_bf16_f32 v83, v178, v179
    v_pk_max_i16 v82, v82, 0
    v_pk_max_i16 v83, v83, 0
    ds_write_b128 v14, v[80:83] offset:8192
    v_mfma_f32_16x16x16_bf16 v[184:187], v[46:47], v[60:61], v[184:187]
    v_mul_f32 v164, v164, |v164|
    v_mul_f32 v165, v165, |v165|
    v_mul_f32 v166, v166, |v166|
    v_mul_f32 v167, v167, |v167|
    v_cvt_pk_bf16_f32 v84, v164, v165
    v_cvt_pk_bf16_f32 v85, v166, v167
    v_pk_max_i16 v84, v84, 0
    v_pk_max_i16 v85, v85, 0
    v_mfma_f32_16x16x16_bf16 v[172:175], v[44:45], v[62:63], v[172:175]
    v_mul_f32 v180, v180, |v180|
    v_mul_f32 v181, v181, |v181|
    v_mul_f32 v182, v182, |v182|
    v_mul_f32 v183, v183, |v183|
    v_cvt_pk_bf16_f32 v86, v180, v181
    v_cvt_pk_bf16_f32 v87, v182, v183
    v_pk_max_i16 v86, v86, 0
    v_pk_max_i16 v87, v87, 0
    ds_write_b128 v14, v[84:87] offset:9216
    v_mfma_f32_16x16x16_bf16 v[188:191], v[46:47], v[62:63], v[188:191]
    v_mul_f32 v168, v168, |v168|
    v_mul_f32 v169, v169, |v169|
    v_mul_f32 v170, v170, |v170|
    v_mul_f32 v171, v171, |v171|
    v_cvt_pk_bf16_f32 v88, v168, v169
    v_cvt_pk_bf16_f32 v89, v170, v171
    v_pk_max_i16 v88, v88, 0
    v_pk_max_i16 v89, v89, 0
    v_mfma_f32_16x16x16_bf16 v[192:195], v[48:49], v[56:57], v[192:195]
    v_mul_f32 v184, v184, |v184|
    v_mul_f32 v185, v185, |v185|
    v_mul_f32 v186, v186, |v186|
    v_mul_f32 v187, v187, |v187|
    v_cvt_pk_bf16_f32 v90, v184, v185
    v_cvt_pk_bf16_f32 v91, v186, v187
    v_pk_max_i16 v90, v90, 0
    v_pk_max_i16 v91, v91, 0
    ds_write_b128 v14, v[88:91] offset:10240
    v_mfma_f32_16x16x16_bf16 v[208:211], v[50:51], v[56:57], v[208:211]
    v_mul_f32 v172, v172, |v172|
    v_mul_f32 v173, v173, |v173|
    v_mul_f32 v174, v174, |v174|
    v_mul_f32 v175, v175, |v175|
    v_cvt_pk_bf16_f32 v92, v172, v173
    v_cvt_pk_bf16_f32 v93, v174, v175
    v_pk_max_i16 v92, v92, 0
    v_pk_max_i16 v93, v93, 0
    v_mfma_f32_16x16x16_bf16 v[196:199], v[48:49], v[58:59], v[196:199]
    v_mul_f32 v188, v188, |v188|
    v_mul_f32 v189, v189, |v189|
    v_mul_f32 v190, v190, |v190|
    v_mul_f32 v191, v191, |v191|
    v_cvt_pk_bf16_f32 v94, v188, v189
    v_cvt_pk_bf16_f32 v95, v190, v191
    v_pk_max_i16 v94, v94, 0
    v_pk_max_i16 v95, v95, 0
    ds_write_b128 v14, v[92:95] offset:11264
    s_mov_b64 exec, 1
    ds_add_u32 v20, v21 offset:8
    s_mov_b64 exec, -1
    v_mfma_f32_16x16x16_bf16 v[212:215], v[50:51], v[58:59], v[212:215]
    v_mul_f32 v192, v192, |v192|
    v_mul_f32 v193, v193, |v193|
    v_mul_f32 v194, v194, |v194|
    v_mul_f32 v195, v195, |v195|
    v_cvt_pk_bf16_f32 v96, v192, v193
    v_cvt_pk_bf16_f32 v97, v194, v195
    v_pk_max_i16 v96, v96, 0
    v_pk_max_i16 v97, v97, 0
    v_mfma_f32_16x16x16_bf16 v[200:203], v[48:49], v[60:61], v[200:203]
    v_mul_f32 v208, v208, |v208|
    v_mul_f32 v209, v209, |v209|
    v_mul_f32 v210, v210, |v210|
    v_mul_f32 v211, v211, |v211|
    v_cvt_pk_bf16_f32 v98, v208, v209
    v_cvt_pk_bf16_f32 v99, v210, v211
    v_pk_max_i16 v98, v98, 0
    v_pk_max_i16 v99, v99, 0
    ds_write_b128 v14, v[96:99] offset:16384
    v_mfma_f32_16x16x16_bf16 v[216:219], v[50:51], v[60:61], v[216:219]
    v_mul_f32 v196, v196, |v196|
    v_mul_f32 v197, v197, |v197|
    v_mul_f32 v198, v198, |v198|
    v_mul_f32 v199, v199, |v199|
    v_cvt_pk_bf16_f32 v100, v196, v197
    v_cvt_pk_bf16_f32 v101, v198, v199
    v_pk_max_i16 v100, v100, 0
    v_pk_max_i16 v101, v101, 0
    v_mfma_f32_16x16x16_bf16 v[204:207], v[48:49], v[62:63], v[204:207]
    v_mul_f32 v212, v212, |v212|
    v_mul_f32 v213, v213, |v213|
    v_mul_f32 v214, v214, |v214|
    v_mul_f32 v215, v215, |v215|
    v_cvt_pk_bf16_f32 v102, v212, v213
    v_cvt_pk_bf16_f32 v103, v214, v215
    v_pk_max_i16 v102, v102, 0
    v_pk_max_i16 v103, v103, 0
    ds_write_b128 v14, v[100:103] offset:17408
    v_mfma_f32_16x16x16_bf16 v[220:223], v[50:51], v[62:63], v[220:223]
    v_mul_f32 v200, v200, |v200|
    v_mul_f32 v201, v201, |v201|
    v_mul_f32 v202, v202, |v202|
    v_mul_f32 v203, v203, |v203|
    v_cvt_pk_bf16_f32 v104, v200, v201
    v_cvt_pk_bf16_f32 v105, v202, v203
    v_pk_max_i16 v104, v104, 0
    v_pk_max_i16 v105, v105, 0
    v_mul_f32 v216, v216, |v216|
    v_mul_f32 v217, v217, |v217|
    v_mul_f32 v218, v218, |v218|
    v_mul_f32 v219, v219, |v219|
    v_cvt_pk_bf16_f32 v106, v216, v217
    v_cvt_pk_bf16_f32 v107, v218, v219
    v_pk_max_i16 v106, v106, 0
    v_pk_max_i16 v107, v107, 0
    ds_write_b128 v14, v[104:107] offset:18432
    v_mul_f32 v204, v204, |v204|
    v_mul_f32 v205, v205, |v205|
    v_mul_f32 v206, v206, |v206|
    v_mul_f32 v207, v207, |v207|
    v_cvt_pk_bf16_f32 v108, v204, v205
    v_cvt_pk_bf16_f32 v109, v206, v207
    v_pk_max_i16 v108, v108, 0
    v_pk_max_i16 v109, v109, 0
    v_mul_f32 v220, v220, |v220|
    v_mul_f32 v221, v221, |v221|
    v_mul_f32 v222, v222, |v222|
    v_mul_f32 v223, v223, |v223|
    v_cvt_pk_bf16_f32 v110, v220, v221
    v_cvt_pk_bf16_f32 v111, v222, v223
    v_pk_max_i16 v110, v110, 0
    v_pk_max_i16 v111, v111, 0
    ds_write_b128 v14, v[108:111] offset:19456
    s_mov_b64 exec, 1
    ds_add_u32 v20, v21 offset:16
    s_mov_b64 exec, -1
    v_mul_f32 v224, v224, |v224|
    v_mul_f32 v225, v225, |v225|
    v_mul_f32 v226, v226, |v226|
    v_mul_f32 v227, v227, |v227|
    v_cvt_pk_bf16_f32 v112, v224, v225
    v_cvt_pk_bf16_f32 v113, v226, v227
    v_pk_max_i16 v112, v112, 0
    v_pk_max_i16 v113, v113, 0
    ds_write_b64 v15, v[112:113] offset:24576
    v_mul_f32 v228, v228, |v228|
    v_mul_f32 v229, v229, |v229|
    v_mul_f32 v230, v230, |v230|
    v_mul_f32 v231, v231, |v231|
    v_cvt_pk_bf16_f32 v114, v228, v229
    v_cvt_pk_bf16_f32 v115, v230, v231
    v_pk_max_i16 v114, v114, 0
    v_pk_max_i16 v115, v115, 0
    ds_write_b64 v15, v[114:115] offset:25600
    v_mul_f32 v232, v232, |v232|
    v_mul_f32 v233, v233, |v233|
    v_mul_f32 v234, v234, |v234|
    v_mul_f32 v235, v235, |v235|
    v_cvt_pk_bf16_f32 v116, v232, v233
    v_cvt_pk_bf16_f32 v117, v234, v235
    v_pk_max_i16 v116, v116, 0
    v_pk_max_i16 v117, v117, 0
    ds_write_b64 v15, v[116:117] offset:26624
    v_mul_f32 v236, v236, |v236|
    v_mul_f32 v237, v237, |v237|
    v_mul_f32 v238, v238, |v238|
    v_mul_f32 v239, v239, |v239|
    v_cvt_pk_bf16_f32 v118, v236, v237
    v_cvt_pk_bf16_f32 v119, v238, v239
    v_pk_max_i16 v118, v118, 0
    v_pk_max_i16 v119, v119, 0
    ds_write_b64 v15, v[118:119] offset:27648
    v_mov_b32 v20, 155924
    v_mov_b32 v21, 1
    s_mov_b64 exec, 1
    ds_add_u32 v20, v21
    s_mov_b64 exec, -1
    s_setprio 2
    v_lshlrev_b32 v8, 4, v1
    s_lshl_b32 s52, s63, 11
    v_xor_b32 v2, s52, v7
    v_xor_b32 v14, 2048, v2
    v_lshrrev_b32 v19, 2, v16
    v_lshl_add_u32 v19, v17, 2, v19
    v_and_b32 v20, 3, v16
    v_lshlrev_b32 v20, 3, v20
    v_lshl_add_u32 v20, v19, 8, v20
    v_add_u32 v20, 65536, v20
    v_and_b32 v19, 7, v19
    s_lshl_b32 s54, s51, 2
    v_xor_b32 v19, s54, v19
    v_xor_b32 v21, 0, v19
    v_lshl_add_u32 v4, v21, 5, v20
    v_xor_b32 v21, 1, v19
    v_lshl_add_u32 v5, v21, 5, v20
    v_xor_b32 v21, 2, v19
    v_lshl_add_u32 v6, v21, 5, v20
    v_xor_b32 v21, 3, v19
    v_lshl_add_u32 v7, v21, 5, v20
    s_lshl_b32 s52, s63, 5
    v_add_u32 v18, s52, v18
    v_and_b32 v11, 1, v17
    v_lshlrev_b32 v11, 5, v11
    v_lshrrev_b32 v19, 1, v17
    v_lshl_add_u32 v15, v19, 4, v11
    v_lshl_add_u32 v3, v18, 11, v15
    s_lshr_b32 s65, s62, 0
    s_lshl_b32 s65, s65, 1
    s_lshl_b32 s54, s51, 0
    s_add_u32 s65, s65, s54
    s_lshl_b32 s65, s65, 7
    s_lshl_b32 s54, s60, 18
    s_add_u32 s66, s54, s65
    s_add_u32 s67, s66, 32768
    buffer_load_dwordx4 v[224:227], v15, s[36:39], s65 offen offset:0
    buffer_load_dwordx4 v[228:231], v15, s[36:39], s65 offen offset:64
    v_lshlrev_b32 v23, 2, v18
    v_add_u32 v23, 137984, v23
    ds_read_b32 v232, v23 offset:0
    ds_read_b32 v233, v23 offset:64
    v_and_b32 v19, 31, v1
    v_lshrrev_b32 v20, 5, v1
    v_lshlrev_b32 v13, 4, v19
    v_lshl_add_u32 v13, v20, 12, v13
    v_cmp_eq_u32 vcc, 0, v19
    v_mov_b32 v11, 5120
    v_mov_b32 v21, 5632
    v_cndmask_b32 v11, v11, v21, vcc
    v_sub_u32 v11, v11, v13
    s_lshl_b32 s54, s3, 2
    s_add_u32 s54, s54, 138496
    v_add_u32 v13, s54, v13
    v_add_u32 v11, s54, v11
    v_lshlrev_b32 v12, 6, v16
    v_bfe_u32 v19, v1, 4, 1
    v_lshl_add_u32 v12, v19, 5, v12
    v_lshl_add_u32 v12, v20, 4, v12
    s_lshr_b32 s68, s75, 5
    s_lshl2_add_u32 s68, s68, s3
    s_lshl_b32 s68, s68, 5
    s_and_b32 s54, s75, 31
    s_add_u32 s68, s68, s54
    s_lshl_b32 s68, s68, 12
    s_add_u32 s68, s68, 41943040
    s_add_u32 s69, s66, 41943040
    s_add_u32 s70, s67, 41943040
    v_mov_b32 v22, 155932
    s_mov_b32 s54, 0
    s_mov_b32 s55, 16384
    s_mov_b32 s57, 4294918144
    s_mov_b32 s58, 16384
    v_mov_b32 v10, 155928
    v_mov_b32 v9, 1
    v_mov_b32 v20, 155924
C2_ha:
    ds_read_b32 v21, v20
    s_waitcnt lgkmcnt(0)
    v_readfirstlane_b32 s73, v21
    s_nop 0
    s_cmp_ge_u32 s73, 8
    s_cbranch_scc1 C2_ha_ok
    s_sub_u32 s79, s79, 1
    s_cbranch_scc0 C2_ha
    s_movk_i32 s78, 2
    s_branch K_bail
C2_ha_ok:
    ds_read_b128 v[64:67], v2 offset:0
    ds_read_b64_tr_b16 v[80:81], v4 offset:0
    ds_read_b64_tr_b16 v[82:83], v4 offset:4096
    ds_read_b64_tr_b16 v[84:85], v5 offset:0
    ds_read_b64_tr_b16 v[86:87], v5 offset:4096
    ds_read_b128 v[68:71], v2 offset:1024
    ds_read_b64_tr_b16 v[88:89], v6 offset:0
    ds_read_b64_tr_b16 v[90:91], v6 offset:4096
    ds_read_b64_tr_b16 v[92:93], v7 offset:0
    ds_read_b64_tr_b16 v[94:95], v7 offset:4096
    ds_read_b128 v[72:75], v14 offset:0
    ds_read_b128 v[76:79], v14 offset:1024
    s_waitcnt lgkmcnt(9)
    v_mfma_f32_16x16x32_bf16 v[128:131], v[80:83], v[64:67], 0
    ds_read_b128 v[96:99], v2 offset:8192
    s_waitcnt lgkmcnt(8)
    v_mfma_f32_16x16x32_bf16 v[132:135], v[84:87], v[64:67], 0
    ds_read_b64_tr_b16 v[112:113], v4 offset:8192
    s_waitcnt lgkmcnt(6)
    v_mfma_f32_16x16x32_bf16 v[136:139], v[88:91], v[64:67], 0
    ds_read_b64_tr_b16 v[114:115], v4 offset:12288
    s_waitcnt lgkmcnt(5)
    v_mfma_f32_16x16x32_bf16 v[140:143], v[92:95], v[64:67], 0
    ds_read_b64_tr_b16 v[116:117], v5 offset:8192
    v_add_u32 v4, s55, v4
    v_mfma_f32_16x16x32_bf16 v[144:147], v[80:83], v[68:71], 0
    ds_read_b64_tr_b16 v[118:119], v5 offset:12288
    v_mfma_f32_16x16x32_bf16 v[148:151], v[84:87], v[68:71], 0
    ds_read_b128 v[100:103], v2 offset:9216
    v_add_u32 v5, s55, v5
    v_mfma_f32_16x16x32_bf16 v[152:155], v[88:91], v[68:71], 0
    ds_read_b64_tr_b16 v[120:121], v6 offset:8192
    v_add_u32 v2, s55, v2
    v_mfma_f32_16x16x32_bf16 v[156:159], v[92:95], v[68:71], 0
    ds_read_b64_tr_b16 v[122:123], v6 offset:12288
    s_waitcnt lgkmcnt(9)
    v_mfma_f32_16x16x32_bf16 v[160:163], v[80:83], v[72:75], 0
    ds_read_b64_tr_b16 v[124:125], v7 offset:8192
    v_add_u32 v6, s55, v6
    v_mfma_f32_16x16x32_bf16 v[164:167], v[84:87], v[72:75], 0
    ds_read_b64_tr_b16 v[126:127], v7 offset:12288
    v_mfma_f32_16x16x32_bf16 v[168:171], v[88:91], v[72:75], 0
    ds_read_b128 v[104:107], v14 offset:8192
    v_add_u32 v7, s55, v7
    v_mfma_f32_16x16x32_bf16 v[172:175], v[92:95], v[72:75], 0
    ds_read_b128 v[108:111], v14 offset:9216
    s_waitcnt lgkmcnt(12)
    v_mfma_f32_16x16x32_bf16 v[176:179], v[80:83], v[76:79], 0
    v_add_u32 v14, s55, v14
    v_mfma_f32_16x16x32_bf16 v[180:183], v[84:87], v[76:79], 0
    s_cmp_gt_u32 s54, 2
    v_mfma_f32_16x16x32_bf16 v[184:187], v[88:91], v[76:79], 0
    s_waitcnt lgkmcnt(0)
    s_cbranch_scc0 C2_early_xq
C2_bar_xq:
    s_barrier
C2_nobar_xq:
    v_mfma_f32_16x16x32_bf16 v[188:191], v[92:95], v[76:79], 0
    s_branch C2_mid
C2_loop:
    s_waitcnt lgkmcnt(9)
    v_mfma_f32_16x16x32_bf16 v[128:131], v[80:83], v[64:67], v[128:131]
    ds_read_b128 v[96:99], v2 offset:8192
    s_waitcnt lgkmcnt(8)
    v_mfma_f32_16x16x32_bf16 v[132:135], v[84:87], v[64:67], v[132:135]
    ds_read_b64_tr_b16 v[112:113], v4 offset:8192
    s_waitcnt lgkmcnt(6)
    v_mfma_f32_16x16x32_bf16 v[136:139], v[88:91], v[64:67], v[136:139]
    ds_read_b64_tr_b16 v[114:115], v4 offset:12288
    s_waitcnt lgkmcnt(5)
    v_mfma_f32_16x16x32_bf16 v[140:143], v[92:95], v[64:67], v[140:143]
    ds_read_b64_tr_b16 v[116:117], v5 offset:8192
    v_add_u32 v4, s55, v4
    v_mfma_f32_16x16x32_bf16 v[144:147], v[80:83], v[68:71], v[144:147]
    ds_read_b64_tr_b16 v[118:119], v5 offset:12288
    v_mfma_f32_16x16x32_bf16 v[148:151], v[84:87], v[68:71], v[148:151]
    ds_read_b128 v[100:103], v2 offset:9216
    v_add_u32 v5, s55, v5
    v_mfma_f32_16x16x32_bf16 v[152:155], v[88:91], v[68:71], v[152:155]
    ds_read_b64_tr_b16 v[120:121], v6 offset:8192
    v_add_u32 v2, s55, v2
    v_mfma_f32_16x16x32_bf16 v[156:159], v[92:95], v[68:71], v[156:159]
    ds_read_b64_tr_b16 v[122:123], v6 offset:12288
    s_waitcnt lgkmcnt(9)
    v_mfma_f32_16x16x32_bf16 v[160:163], v[80:83], v[72:75], v[160:163]
    ds_read_b64_tr_b16 v[124:125], v7 offset:8192
    v_add_u32 v6, s55, v6
    v_mfma_f32_16x16x32_bf16 v[164:167], v[84:87], v[72:75], v[164:167]
    ds_read_b64_tr_b16 v[126:127], v7 offset:12288
    v_mfma_f32_16x16x32_bf16 v[168:171], v[88:91], v[72:75], v[168:171]
    ds_read_b128 v[104:107], v14 offset:8192
    v_add_u32 v7, s55, v7
    v_mfma_f32_16x16x32_bf16 v[172:175], v[92:95], v[72:75], v[172:175]
    ds_read_b128 v[108:111], v14 offset:9216
    s_waitcnt lgkmcnt(12)
    v_mfma_f32_16x16x32_bf16 v[176:179], v[80:83], v[76:79], v[176:179]
    v_add_u32 v14, s55, v14
    v_mfma_f32_16x16x32_bf16 v[180:183], v[84:87], v[76:79], v[180:183]
    s_cmp_gt_u32 s54, 2
    v_mfma_f32_16x16x32_bf16 v[184:187], v[88:91], v[76:79], v[184:187]
    s_waitcnt lgkmcnt(0)
    s_cbranch_scc0 C2_early_xr
C2_bar_xr:
    s_barrier
C2_nobar_xr:
    v_mfma_f32_16x16x32_bf16 v[188:191], v[92:95], v[76:79], v[188:191]
C2_mid:
    v_mfma_f32_16x16x32_bf16 v[128:131], v[112:115], v[96:99], v[128:131]
    ds_read_b128 v[64:67], v2 offset:0
    v_mfma_f32_16x16x32_bf16 v[132:135], v[116:119], v[96:99], v[132:135]
    ds_read_b64_tr_b16 v[80:81], v4 offset:0
    v_mfma_f32_16x16x32_bf16 v[136:139], v[120:123], v[96:99], v[136:139]
    ds_read_b64_tr_b16 v[82:83], v4 offset:4096
    v_mfma_f32_16x16x32_bf16 v[140:143], v[124:127], v[96:99], v[140:143]
    ds_read_b64_tr_b16 v[84:85], v5 offset:0
    v_mfma_f32_16x16x32_bf16 v[144:147], v[112:115], v[100:103], v[144:147]
    ds_read_b64_tr_b16 v[86:87], v5 offset:4096
    v_mfma_f32_16x16x32_bf16 v[148:151], v[116:119], v[100:103], v[148:151]
    ds_read_b128 v[68:71], v2 offset:1024
    v_mfma_f32_16x16x32_bf16 v[152:155], v[120:123], v[100:103], v[152:155]
    ds_read_b64_tr_b16 v[88:89], v6 offset:0
    v_mfma_f32_16x16x32_bf16 v[156:159], v[124:127], v[100:103], v[156:159]
    ds_read_b64_tr_b16 v[90:91], v6 offset:4096
    v_mfma_f32_16x16x32_bf16 v[160:163], v[112:115], v[104:107], v[160:163]
    ds_read_b64_tr_b16 v[92:93], v7 offset:0
    v_mfma_f32_16x16x32_bf16 v[164:167], v[116:119], v[104:107], v[164:167]
    ds_read_b64_tr_b16 v[94:95], v7 offset:4096
    v_mfma_f32_16x16x32_bf16 v[168:171], v[120:123], v[104:107], v[168:171]
    ds_read_b128 v[72:75], v14 offset:0
    v_mfma_f32_16x16x32_bf16 v[172:175], v[124:127], v[104:107], v[172:175]
    ds_read_b128 v[76:79], v14 offset:1024
    v_mfma_f32_16x16x32_bf16 v[176:179], v[112:115], v[108:111], v[176:179]
    s_add_u32 s54, s54, 1
    s_and_b32 s73, s54, 3
    v_mfma_f32_16x16x32_bf16 v[180:183], v[116:119], v[108:111], v[180:183]
    s_cmp_eq_u32 s73, 3
    s_cselect_b32 s55, s57, s58
    v_mfma_f32_16x16x32_bf16 v[184:187], v[120:123], v[108:111], v[184:187]
    v_mfma_f32_16x16x32_bf16 v[188:191], v[124:127], v[108:111], v[188:191]
    s_cmp_lt_u32 s54, 22
    s_cbranch_scc1 C2_loop
    s_waitcnt lgkmcnt(0)
    ds_read_b32 v23, v22
    ds_read2st64_b32 v[56:57], v13 offset0:0 offset1:4
    ds_read2st64_b32 v[58:59], v13 offset0:8 offset1:12
    ds_read2st64_b32 v[60:61], v13 offset0:32 offset1:36
    ds_read2st64_b32 v[62:63], v13 offset0:40 offset1:44
    ds_read2st64_b32 v[234:235], v11 offset0:44 offset1:40
    ds_read2st64_b32 v[236:237], v11 offset0:36 offset1:32
    ds_read2st64_b32 v[16:17], v11 offset0:12 offset1:8
    ds_read2st64_b32 v[18:19], v11 offset0:4 offset1:0
    v_subrev_u32 v2, 32768, v2
    v_subrev_u32 v14, 32768, v14
    v_subrev_u32 v4, 32768, v4
    v_subrev_u32 v5, 32768, v5
    v_subrev_u32 v6, 32768, v6
    v_subrev_u32 v7, 32768, v7
    s_waitcnt vmcnt(0)
C3_z:
    s_waitcnt lgkmcnt(0)
    v_readfirstlane_b32 s73, v23
    s_mov_b32 s58, 0
    s_cmp_lt_u32 s73, 2
    s_cbranch_scc1 C3_zr
    v_mfma_f32_32x32x16_bf16 v[96:111], v[56:59], v[24:27], 0
    v_mfma_f32_32x32x16_bf16 v[112:127], v[56:59], v[40:43], 0
    v_mfma_f32_32x32x16_bf16 v[96:111], v[60:63], v[28:31], v[96:111]
    v_mfma_f32_32x32x16_bf16 v[112:127], v[60:63], v[44:47], v[112:127]
    v_mfma_f32_32x32x16_bf16 v[96:111], v[234:237], v[32:35], v[96:111]
    v_mfma_f32_32x32x16_bf16 v[112:127], v[234:237], v[48:51], v[112:127]
    v_mfma_f32_32x32x16_bf16 v[96:111], v[16:19], v[36:39], v[96:111]
    v_mfma_f32_32x32x16_bf16 v[112:127], v[16:19], v[52:55], v[112:127]
    s_xor_b32 s52, s2, 2
    s_lshl_b32 s52, s52, 2
    s_add_u32 s52, s52, s3
    s_lshl_b32 s52, s52, 12
    s_add_u32 s52, s52, 50331648
    s_lshl_b32 s56, s2, 2
    s_add_u32 s56, s56, s3
    s_lshl_b32 s56, s56, 12
    s_add_u32 s56, s56, 50331648
    s_mov_b32 s54, 0xbfb8aa3b
    s_mov_b32 s55, s54
    s_mov_b32 s50, 1.0
    s_mov_b32 s51, 1.0
    s_mov_b32 s57, 0
    v_pk_mul_f32 v[20:21], v[96:97], v[192:193] op_sel:[0,0] op_sel_hi:[0,1] neg_hi:[0,1]
    v_pk_fma_f32 v[20:21], v[112:113], v[192:193], v[20:21] op_sel:[0,1,0] op_sel_hi:[0,0,1]
    v_cvt_pk_bf16_f32 v56, v20, v21
    v_pk_mul_f32 v[22:23], v[96:97], v[194:195] op_sel:[1,0] op_sel_hi:[1,1] neg_hi:[0,1]
    v_pk_fma_f32 v[22:23], v[112:113], v[194:195], v[22:23] op_sel:[1,1,0] op_sel_hi:[1,0,1]
    v_cvt_pk_bf16_f32 v57, v22, v23
    v_pk_mul_f32 v[20:21], v[98:99], v[196:197] op_sel:[0,0] op_sel_hi:[0,1] neg_hi:[0,1]
    v_pk_fma_f32 v[20:21], v[114:115], v[196:197], v[20:21] op_sel:[0,1,0] op_sel_hi:[0,0,1]
    v_cvt_pk_bf16_f32 v58, v20, v21
    v_pk_mul_f32 v[22:23], v[98:99], v[198:199] op_sel:[1,0] op_sel_hi:[1,1] neg_hi:[0,1]
    v_pk_fma_f32 v[22:23], v[114:115], v[198:199], v[22:23] op_sel:[1,1,0] op_sel_hi:[1,0,1]
    v_cvt_pk_bf16_f32 v59, v22, v23
    v_pk_mul_f32 v[20:21], v[100:101], v[200:201] op_sel:[0,0] op_sel_hi:[0,1] neg_hi:[0,1]
    v_pk_fma_f32 v[20:21], v[116:117], v[200:201], v[20:21] op_sel:[0,1,0] op_sel_hi:[0,0,1]
    v_cvt_pk_bf16_f32 v60, v20, v21
    v_pk_mul_f32 v[22:23], v[100:101], v[202:203] op_sel:[1,0] op_sel_hi:[1,1] neg_hi:[0,1]
    v_pk_fma_f32 v[22:23], v[116:117], v[202:203], v[22:23] op_sel:[1,1,0] op_sel_hi:[1,0,1]
    v_cvt_pk_bf16_f32 v61, v22, v23
    v_pk_mul_f32 v[20:21], v[102:103], v[204:205] op_sel:[0,0] op_sel_hi:[0,1] neg_hi:[0,1]
    v_pk_fma_f32 v[20:21], v[118:119], v[204:205], v[20:21] op_sel:[0,1,0] op_sel_hi:[0,0,1]
    v_cvt_pk_bf16_f32 v62, v20, v21
    v_pk_mul_f32 v[22:23], v[102:103], v[206:207] op_sel:[1,0] op_sel_hi:[1,1] neg_hi:[0,1]
    v_pk_fma_f32 v[22:23], v[118:119], v[206:207], v[22:23] op_sel:[1,1,0] op_sel_hi:[1,0,1]
    v_cvt_pk_bf16_f32 v63, v22, v23
    v_pk_mul_f32 v[20:21], v[104:105], v[208:209] op_sel:[0,0] op_sel_hi:[0,1] neg_hi:[0,1]
    v_pk_fma_f32 v[20:21], v[120:121], v[208:209], v[20:21] op_sel:[0,1,0] op_sel_hi:[0,0,1]
    v_cvt_pk_bf16_f32 v234, v20, v21
    v_pk_mul_f32 v[22:23], v[104:105], v[210:211] op_sel:[1,0] op_sel_hi:[1,1] neg_hi:[0,1]
    v_pk_fma_f32 v[22:23], v[120:121], v[210:211], v[22:23] op_sel:[1,1,0] op_sel_hi:[1,0,1]
    v_cvt_pk_bf16_f32 v235, v22, v23
    v_pk_mul_f32 v[20:21], v[106:107], v[212:213] op_sel:[0,0] op_sel_hi:[0,1] neg_hi:[0,1]
    v_pk_fma_f32 v[20:21], v[122:123], v[212:213], v[20:21] op_sel:[0,1,0] op_sel_hi:[0,0,1]
    v_cvt_pk_bf16_f32 v236, v20, v21
    v_pk_mul_f32 v[22:23], v[106:107], v[214:215] op_sel:[1,0] op_sel_hi:[1,1] neg_hi:[0,1]
    v_pk_fma_f32 v[22:23], v[122:123], v[214:215], v[22:23] op_sel:[1,1,0] op_sel_hi:[1,0,1]
    v_cvt_pk_bf16_f32 v237, v22, v23
    v_pk_mul_f32 v[20:21], v[108:109], v[216:217] op_sel:[0,0] op_sel_hi:[0,1] neg_hi:[0,1]
    v_pk_fma_f32 v[20:21], v[124:125], v[216:217], v[20:21] op_sel:[0,1,0] op_sel_hi:[0,0,1]
    v_cvt_pk_bf16_f32 v16, v20, v21
    v_pk_mul_f32 v[22:23], v[108:109], v[218:219] op_sel:[1,0] op_sel_hi:[1,1] neg_hi:[0,1]
    v_pk_fma_f32 v[22:23], v[124:125], v[218:219], v[22:23] op_sel:[1,1,0] op_sel_hi:[1,0,1]
    v_cvt_pk_bf16_f32 v17, v22, v23
    v_pk_mul_f32 v[20:21], v[110:111], v[220:221] op_sel:[0,0] op_sel_hi:[0,1] neg_hi:[0,1]
    v_pk_fma_f32 v[20:21], v[126:127], v[220:221], v[20:21] op_sel:[0,1,0] op_sel_hi:[0,0,1]
    v_cvt_pk_bf16_f32 v18, v20, v21
    v_pk_mul_f32 v[22:23], v[110:111], v[222:223] op_sel:[1,0] op_sel_hi:[1,1] neg_hi:[0,1]
    v_pk_fma_f32 v[22:23], v[126:127], v[222:223], v[22:23] op_sel:[1,1,0] op_sel_hi:[1,0,1]
    v_cvt_pk_bf16_f32 v19, v22, v23
    s_nop 1
    v_mfma_f32_32x32x16_bf16 v[96:111], v[56:59], v[24:27], 0
    ds_read_b128 v[208:211], v2 offset:40960
    ds_read_b64_tr_b16 v[192:193], v4 offset:40960
    v_mfma_f32_32x32x16_bf16 v[112:127], v[56:59], v[40:43], 0
    ds_read_b64_tr_b16 v[194:195], v4 offset:45056
    ds_read_b64_tr_b16 v[196:197], v5 offset:40960
    v_mfma_f32_32x32x16_bf16 v[96:111], v[60:63], v[28:31], v[96:111]
    ds_read_b64_tr_b16 v[198:199], v5 offset:45056
    ds_read_b128 v[212:215], v2 offset:41984
    v_mfma_f32_32x32x16_bf16 v[112:127], v[60:63], v[44:47], v[112:127]
    ds_read_b64_tr_b16 v[200:201], v6 offset:40960
    v_mfma_f32_32x32x16_bf16 v[96:111], v[234:237], v[32:35], v[96:111]
    ds_read_b64_tr_b16 v[202:203], v6 offset:45056
    ds_read_b64_tr_b16 v[204:205], v7 offset:40960
    v_mfma_f32_32x32x16_bf16 v[112:127], v[234:237], v[48:51], v[112:127]
    ds_read_b64_tr_b16 v[206:207], v7 offset:45056
    ds_read_b128 v[216:219], v14 offset:40960
    v_mfma_f32_32x32x16_bf16 v[96:111], v[16:19], v[36:39], v[96:111]
    ds_read_b128 v[220:223], v14 offset:41984
    v_mfma_f32_32x32x16_bf16 v[112:127], v[16:19], v[52:55], v[112:127]
    s_nop 9
    v_mfma_f32_16x16x32_bf16 v[128:131], v[80:83], v[64:67], v[128:131]
    v_cvt_pk_bf16_f32 v234, v96, v97
    v_cvt_pk_bf16_f32 v235, v98, v99
    v_mfma_f32_16x16x32_bf16 v[132:135], v[84:87], v[64:67], v[132:135]
    v_cvt_pk_bf16_f32 v236, v100, v101
    v_cvt_pk_bf16_f32 v237, v102, v103
    v_mfma_f32_16x16x32_bf16 v[136:139], v[88:91], v[64:67], v[136:139]
    v_cvt_pk_bf16_f32 v16, v104, v105
    v_cvt_pk_bf16_f32 v17, v106, v107
    v_mfma_f32_16x16x32_bf16 v[140:143], v[92:95], v[64:67], v[140:143]
    v_cvt_pk_bf16_f32 v18, v108, v109
    v_cvt_pk_bf16_f32 v19, v110, v111
    v_mfma_f32_16x16x32_bf16 v[144:147], v[80:83], v[68:71], v[144:147]
    v_permlane32_swap_b32 v234, v236
    v_permlane32_swap_b32 v235, v237
    v_mfma_f32_16x16x32_bf16 v[148:151], v[84:87], v[68:71], v[148:151]
    v_permlane32_swap_b32 v16, v18
    v_permlane32_swap_b32 v17, v19
    v_mfma_f32_16x16x32_bf16 v[152:155], v[88:91], v[68:71], v[152:155]
    v_permlane16_swap_b32 v234, v16
    v_permlane16_swap_b32 v235, v17
    v_mfma_f32_16x16x32_bf16 v[156:159], v[92:95], v[68:71], v[156:159]
    v_permlane16_swap_b32 v236, v18
    v_permlane16_swap_b32 v237, v19
    v_mfma_f32_16x16x32_bf16 v[160:163], v[80:83], v[72:75], v[160:163]
    v_cvt_pk_bf16_f32 v56, v112, v113
    v_cvt_pk_bf16_f32 v57, v114, v115
    buffer_store_dwordx4 v[234:237], v12, s[32:35], s68 offen offset:2048 sc1
    v_mfma_f32_16x16x32_bf16 v[164:167], v[84:87], v[72:75], v[164:167]
    v_cvt_pk_bf16_f32 v58, v116, v117
    v_cvt_pk_bf16_f32 v59, v118, v119
    v_mfma_f32_16x16x32_bf16 v[168:171], v[88:91], v[72:75], v[168:171]
    v_cvt_pk_bf16_f32 v60, v120, v121
    v_cvt_pk_bf16_f32 v61, v122, v123
    v_mfma_f32_16x16x32_bf16 v[172:175], v[92:95], v[72:75], v[172:175]
    v_cvt_pk_bf16_f32 v62, v124, v125
    v_cvt_pk_bf16_f32 v63, v126, v127
    v_mfma_f32_16x16x32_bf16 v[176:179], v[80:83], v[76:79], v[176:179]
    v_permlane32_swap_b32 v56, v58
    v_permlane32_swap_b32 v57, v59
    v_mfma_f32_16x16x32_bf16 v[180:183], v[84:87], v[76:79], v[180:183]
    v_permlane32_swap_b32 v60, v62
    v_permlane32_swap_b32 v61, v63
    v_mfma_f32_16x16x32_bf16 v[184:187], v[88:91], v[76:79], v[184:187]
    v_permlane16_swap_b32 v56, v60
    v_permlane16_swap_b32 v57, v61
    s_waitcnt lgkmcnt(0)
    s_barrier
    v_mfma_f32_16x16x32_bf16 v[188:191], v[92:95], v[76:79], v[188:191]
    v_permlane16_swap_b32 v58, v62
    v_permlane16_swap_b32 v59, v63
    v_mfma_f32_16x16x32_bf16 v[128:131], v[192:195], v[208:211], v[128:131]
    buffer_store_dwordx4 v[16:19], v12, s[32:35], s68 offen offset:3072 sc1
    ds_read_b128 v[64:67], v2 offset:49152
    v_mfma_f32_16x16x32_bf16 v[132:135], v[196:199], v[208:211], v[132:135]
    ds_read_b64_tr_b16 v[80:81], v4 offset:49152
    v_mfma_f32_16x16x32_bf16 v[136:139], v[200:203], v[208:211], v[136:139]
    ds_read_b64_tr_b16 v[82:83], v4 offset:53248
    v_mfma_f32_16x16x32_bf16 v[140:143], v[204:207], v[208:211], v[140:143]
    ds_read_b64_tr_b16 v[84:85], v5 offset:49152
    v_mfma_f32_16x16x32_bf16 v[144:147], v[192:195], v[212:215], v[144:147]
    ds_read_b64_tr_b16 v[86:87], v5 offset:53248
    v_mfma_f32_16x16x32_bf16 v[148:151], v[196:199], v[212:215], v[148:151]
    ds_read_b128 v[68:71], v2 offset:50176
    v_mfma_f32_16x16x32_bf16 v[152:155], v[200:203], v[212:215], v[152:155]
    ds_read_b64_tr_b16 v[88:89], v6 offset:49152
    v_mfma_f32_16x16x32_bf16 v[156:159], v[204:207], v[212:215], v[156:159]
    ds_read_b64_tr_b16 v[90:91], v6 offset:53248
    v_mfma_f32_16x16x32_bf16 v[160:163], v[192:195], v[216:219], v[160:163]
    buffer_store_dwordx4 v[56:59], v12, s[32:35], s68 offen offset:0 sc1
    ds_read_b64_tr_b16 v[92:93], v7 offset:49152
    v_mfma_f32_16x16x32_bf16 v[164:167], v[196:199], v[216:219], v[164:167]
    ds_read_b64_tr_b16 v[94:95], v7 offset:53248
    v_mfma_f32_16x16x32_bf16 v[168:171], v[200:203], v[216:219], v[168:171]
    ds_read_b128 v[72:75], v14 offset:49152
    v_mfma_f32_16x16x32_bf16 v[172:175], v[204:207], v[216:219], v[172:175]
    ds_read_b128 v[76:79], v14 offset:50176
    v_mfma_f32_16x16x32_bf16 v[176:179], v[192:195], v[220:223], v[176:179]
    v_mfma_f32_16x16x32_bf16 v[180:183], v[196:199], v[220:223], v[180:183]
    v_mfma_f32_16x16x32_bf16 v[184:187], v[200:203], v[220:223], v[184:187]
    v_mfma_f32_16x16x32_bf16 v[188:191], v[204:207], v[220:223], v[188:191]
    s_waitcnt lgkmcnt(9)
    v_mfma_f32_16x16x32_bf16 v[128:131], v[80:83], v[64:67], v[128:131]
    buffer_store_dwordx4 v[60:63], v12, s[32:35], s68 offen offset:1024 sc1
    ds_read_b128 v[208:211], v2 offset:57344
    s_waitcnt lgkmcnt(8)
    v_mfma_f32_16x16x32_bf16 v[132:135], v[84:87], v[64:67], v[132:135]
    ds_read_b64_tr_b16 v[192:193], v4 offset:57344
    s_waitcnt lgkmcnt(6)
    v_mfma_f32_16x16x32_bf16 v[136:139], v[88:91], v[64:67], v[136:139]
    ds_read_b64_tr_b16 v[194:195], v4 offset:61440
    s_waitcnt lgkmcnt(5)
    v_mfma_f32_16x16x32_bf16 v[140:143], v[92:95], v[64:67], v[140:143]
    ds_read_b64_tr_b16 v[196:197], v5 offset:57344
    v_mfma_f32_16x16x32_bf16 v[144:147], v[80:83], v[68:71], v[144:147]
    ds_read_b64_tr_b16 v[198:199], v5 offset:61440
    v_mfma_f32_16x16x32_bf16 v[148:151], v[84:87], v[68:71], v[148:151]
    ds_read_b128 v[212:215], v2 offset:58368
    v_mfma_f32_16x16x32_bf16 v[152:155], v[88:91], v[68:71], v[152:155]
    ds_read_b64_tr_b16 v[200:201], v6 offset:57344
    v_mfma_f32_16x16x32_bf16 v[156:159], v[92:95], v[68:71], v[156:159]
    ds_read_b64_tr_b16 v[202:203], v6 offset:61440
    s_waitcnt lgkmcnt(9)
    v_mfma_f32_16x16x32_bf16 v[160:163], v[80:83], v[72:75], v[160:163]
    ds_read_b64_tr_b16 v[204:205], v7 offset:57344
    v_mfma_f32_16x16x32_bf16 v[164:167], v[84:87], v[72:75], v[164:167]
    ds_read_b64_tr_b16 v[206:207], v7 offset:61440
    v_mfma_f32_16x16x32_bf16 v[168:171], v[88:91], v[72:75], v[168:171]
    ds_read_b128 v[216:219], v14 offset:57344
    v_mfma_f32_16x16x32_bf16 v[172:175], v[92:95], v[72:75], v[172:175]
    ds_read_b128 v[220:223], v14 offset:58368
    s_waitcnt lgkmcnt(12)
    v_mfma_f32_16x16x32_bf16 v[176:179], v[80:83], v[76:79], v[176:179]
    v_mfma_f32_16x16x32_bf16 v[180:183], v[84:87], v[76:79], v[180:183]
    v_mfma_f32_16x16x32_bf16 v[184:187], v[88:91], v[76:79], v[184:187]
    s_waitcnt lgkmcnt(0)
    s_barrier
    v_mfma_f32_16x16x32_bf16 v[188:191], v[92:95], v[76:79], v[188:191]
    v_mfma_f32_16x16x32_bf16 v[128:131], v[192:195], v[208:211], v[128:131]
    ds_read_b128 v[64:67], v2 offset:0
    v_mfma_f32_16x16x32_bf16 v[132:135], v[196:199], v[208:211], v[132:135]
    ds_read_b64_tr_b16 v[80:81], v4 offset:0
    v_mfma_f32_16x16x32_bf16 v[136:139], v[200:203], v[208:211], v[136:139]
    ds_read_b64_tr_b16 v[82:83], v4 offset:4096
    v_mfma_f32_16x16x32_bf16 v[140:143], v[204:207], v[208:211], v[140:143]
    ds_read_b64_tr_b16 v[84:85], v5 offset:0
    v_mfma_f32_16x16x32_bf16 v[144:147], v[192:195], v[212:215], v[144:147]
    ds_read_b64_tr_b16 v[86:87], v5 offset:4096
    v_mfma_f32_16x16x32_bf16 v[148:151], v[196:199], v[212:215], v[148:151]
    ds_read_b128 v[68:71], v2 offset:1024
    v_mfma_f32_16x16x32_bf16 v[152:155], v[200:203], v[212:215], v[152:155]
    ds_read_b64_tr_b16 v[88:89], v6 offset:0
    v_mfma_f32_16x16x32_bf16 v[156:159], v[204:207], v[212:215], v[156:159]
    ds_read_b64_tr_b16 v[90:91], v6 offset:4096
    v_mfma_f32_16x16x32_bf16 v[160:163], v[192:195], v[216:219], v[160:163]
    ds_read_b64_tr_b16 v[92:93], v7 offset:0
    v_mfma_f32_16x16x32_bf16 v[164:167], v[196:199], v[216:219], v[164:167]
    ds_read_b64_tr_b16 v[94:95], v7 offset:4096
    v_mfma_f32_16x16x32_bf16 v[168:171], v[200:203], v[216:219], v[168:171]
    ds_read_b128 v[72:75], v14 offset:0
    v_mfma_f32_16x16x32_bf16 v[172:175], v[204:207], v[216:219], v[172:175]
    ds_read_b128 v[76:79], v14 offset:1024
    v_mfma_f32_16x16x32_bf16 v[176:179], v[192:195], v[220:223], v[176:179]
    v_mfma_f32_16x16x32_bf16 v[180:183], v[196:199], v[220:223], v[180:183]
    v_mfma_f32_16x16x32_bf16 v[184:187], v[200:203], v[220:223], v[184:187]
    v_mfma_f32_16x16x32_bf16 v[188:191], v[204:207], v[220:223], v[188:191]
    s_waitcnt lgkmcnt(9)
    v_mfma_f32_16x16x32_bf16 v[128:131], v[80:83], v[64:67], v[128:131]
    ds_read_b128 v[208:211], v2 offset:8192
    s_waitcnt lgkmcnt(8)
    v_mfma_f32_16x16x32_bf16 v[132:135], v[84:87], v[64:67], v[132:135]
    ds_read_b64_tr_b16 v[192:193], v4 offset:8192
    s_waitcnt lgkmcnt(6)
    v_mfma_f32_16x16x32_bf16 v[136:139], v[88:91], v[64:67], v[136:139]
    ds_read_b64_tr_b16 v[194:195], v4 offset:12288
    s_waitcnt lgkmcnt(5)
    v_mfma_f32_16x16x32_bf16 v[140:143], v[92:95], v[64:67], v[140:143]
    ds_read_b64_tr_b16 v[196:197], v5 offset:8192
    v_mfma_f32_16x16x32_bf16 v[144:147], v[80:83], v[68:71], v[144:147]
    ds_read_b64_tr_b16 v[198:199], v5 offset:12288
    v_mfma_f32_16x16x32_bf16 v[148:151], v[84:87], v[68:71], v[148:151]
    ds_read_b128 v[212:215], v2 offset:9216
    v_mfma_f32_16x16x32_bf16 v[152:155], v[88:91], v[68:71], v[152:155]
    ds_read_b64_tr_b16 v[200:201], v6 offset:8192
    v_mfma_f32_16x16x32_bf16 v[156:159], v[92:95], v[68:71], v[156:159]
    ds_read_b64_tr_b16 v[202:203], v6 offset:12288
    s_waitcnt lgkmcnt(9)
    v_mfma_f32_16x16x32_bf16 v[160:163], v[80:83], v[72:75], v[160:163]
    ds_read_b64_tr_b16 v[204:205], v7 offset:8192
    v_mfma_f32_16x16x32_bf16 v[164:167], v[84:87], v[72:75], v[164:167]
    ds_read_b64_tr_b16 v[206:207], v7 offset:12288
    v_mfma_f32_16x16x32_bf16 v[168:171], v[88:91], v[72:75], v[168:171]
    ds_read_b128 v[216:219], v14 offset:8192
    v_mfma_f32_16x16x32_bf16 v[172:175], v[92:95], v[72:75], v[172:175]
    ds_read_b128 v[220:223], v14 offset:9216
    s_waitcnt lgkmcnt(12)
    v_mfma_f32_16x16x32_bf16 v[176:179], v[80:83], v[76:79], v[176:179]
    v_mfma_f32_16x16x32_bf16 v[180:183], v[84:87], v[76:79], v[180:183]
    v_mfma_f32_16x16x32_bf16 v[184:187], v[88:91], v[76:79], v[184:187]
    s_waitcnt lgkmcnt(0)
    s_barrier
    v_mfma_f32_16x16x32_bf16 v[188:191], v[92:95], v[76:79], v[188:191]
    v_mfma_f32_16x16x32_bf16 v[128:131], v[192:195], v[208:211], v[128:131]
    ds_read_b128 v[64:67], v2 offset:16384
    ds_read_b64_tr_b16 v[80:81], v4 offset:16384
    v_mfma_f32_16x16x32_bf16 v[132:135], v[196:199], v[208:211], v[132:135]
    ds_read_b64_tr_b16 v[82:83], v4 offset:20480
    v_mfma_f32_16x16x32_bf16 v[136:139], v[200:203], v[208:211], v[136:139]
    ds_read_b64_tr_b16 v[84:85], v5 offset:16384
    ds_read_b64_tr_b16 v[86:87], v5 offset:20480
    v_mfma_f32_16x16x32_bf16 v[140:143], v[204:207], v[208:211], v[140:143]
    ds_read_b128 v[68:71], v2 offset:17408
    v_mfma_f32_16x16x32_bf16 v[144:147], v[192:195], v[212:215], v[144:147]
    ds_read_b64_tr_b16 v[88:89], v6 offset:16384
    ds_read_b64_tr_b16 v[90:91], v6 offset:20480
    v_mfma_f32_16x16x32_bf16 v[148:151], v[196:199], v[212:215], v[148:151]
    ds_read_b64_tr_b16 v[92:93], v7 offset:16384
    v_mfma_f32_16x16x32_bf16 v[152:155], v[200:203], v[212:215], v[152:155]
    ds_read_b64_tr_b16 v[94:95], v7 offset:20480
    ds_read_b128 v[72:75], v14 offset:16384
    v_mfma_f32_16x16x32_bf16 v[156:159], v[204:207], v[212:215], v[156:159]
    ds_read_b128 v[76:79], v14 offset:17408
    v_mfma_f32_16x16x32_bf16 v[160:163], v[192:195], v[216:219], v[160:163]
    ds_read_b128 v[40:43], v14 offset:24576
    ds_read_b64_tr_b16 v[24:25], v4 offset:24576
    v_mfma_f32_16x16x32_bf16 v[164:167], v[196:199], v[216:219], v[164:167]
    ds_read_b64_tr_b16 v[26:27], v4 offset:28672
    v_mfma_f32_16x16x32_bf16 v[168:171], v[200:203], v[216:219], v[168:171]
    ds_read_b64_tr_b16 v[28:29], v5 offset:24576
    ds_read_b64_tr_b16 v[30:31], v5 offset:28672
    v_mfma_f32_16x16x32_bf16 v[172:175], v[204:207], v[216:219], v[172:175]
    ds_read_b64_tr_b16 v[32:33], v6 offset:24576
    v_mfma_f32_16x16x32_bf16 v[176:179], v[192:195], v[220:223], v[176:179]
    ds_read_b64_tr_b16 v[34:35], v6 offset:28672
    ds_read_b64_tr_b16 v[36:37], v7 offset:24576
    v_mfma_f32_16x16x32_bf16 v[180:183], v[196:199], v[220:223], v[180:183]
    ds_read_b64_tr_b16 v[38:39], v7 offset:28672
    v_mfma_f32_16x16x32_bf16 v[184:187], v[200:203], v[220:223], v[184:187]
    ds_read_b128 v[44:47], v14 offset:25600
    v_mfma_f32_16x16x32_bf16 v[188:191], v[204:207], v[220:223], v[188:191]
    s_barrier
    s_waitcnt lgkmcnt(11)
    v_mfma_f32_16x16x32_bf16 v[160:163], v[80:83], v[72:75], v[160:163]
    ds_read_b128 v[104:107], v14 offset:32768
    ds_read_b64_tr_b16 v[112:113], v4 offset:32768
    v_mfma_f32_16x16x32_bf16 v[164:167], v[84:87], v[72:75], v[164:167]
    ds_read_b64_tr_b16 v[114:115], v4 offset:36864
    v_mfma_f32_16x16x32_bf16 v[168:171], v[88:91], v[72:75], v[168:171]
    ds_read_b64_tr_b16 v[116:117], v5 offset:32768
    v_mfma_f32_16x16x32_bf16 v[172:175], v[92:95], v[72:75], v[172:175]
    ds_read_b64_tr_b16 v[118:119], v5 offset:36864
    s_waitcnt lgkmcnt(15)
    v_mfma_f32_16x16x32_bf16 v[176:179], v[80:83], v[76:79], v[176:179]
    ds_read_b64_tr_b16 v[120:121], v6 offset:32768
    ds_read_b64_tr_b16 v[122:123], v6 offset:36864
    v_mfma_f32_16x16x32_bf16 v[180:183], v[84:87], v[76:79], v[180:183]
    ds_read_b64_tr_b16 v[124:125], v7 offset:32768
    v_mfma_f32_16x16x32_bf16 v[184:187], v[88:91], v[76:79], v[184:187]
    ds_read_b64_tr_b16 v[126:127], v7 offset:36864
    v_mfma_f32_16x16x32_bf16 v[188:191], v[92:95], v[76:79], v[188:191]
    ds_read_b128 v[108:111], v14 offset:33792
    s_waitcnt lgkmcnt(15)
    v_mfma_f32_16x16x32_bf16 v[160:163], v[24:27], v[40:43], v[160:163]
    ds_read_b128 v[208:211], v14 offset:40960
    ds_read_b64_tr_b16 v[192:193], v4 offset:40960
    v_mfma_f32_16x16x32_bf16 v[164:167], v[28:31], v[40:43], v[164:167]
    ds_read_b64_tr_b16 v[194:195], v4 offset:45056
    s_waitcnt lgkmcnt(15)
    v_mfma_f32_16x16x32_bf16 v[168:171], v[32:35], v[40:43], v[168:171]
    ds_read_b64_tr_b16 v[196:197], v5 offset:40960
    s_waitcnt lgkmcnt(15)
    v_mfma_f32_16x16x32_bf16 v[172:175], v[36:39], v[40:43], v[172:175]
    ds_read_b64_tr_b16 v[198:199], v5 offset:45056
    s_waitcnt lgkmcnt(15)
    v_mfma_f32_16x16x32_bf16 v[176:179], v[24:27], v[44:47], v[176:179]
    ds_read_b64_tr_b16 v[200:201], v6 offset:40960
    ds_read_b64_tr_b16 v[202:203], v6 offset:45056
    v_mfma_f32_16x16x32_bf16 v[180:183], v[28:31], v[44:47], v[180:183]
    ds_read_b64_tr_b16 v[204:205], v7 offset:40960
    v_mfma_f32_16x16x32_bf16 v[184:187], v[32:35], v[44:47], v[184:187]
    ds_read_b64_tr_b16 v[206:207], v7 offset:45056
    v_mfma_f32_16x16x32_bf16 v[188:191], v[36:39], v[44:47], v[188:191]
    ds_read_b128 v[212:215], v14 offset:41984
    s_waitcnt lgkmcnt(15)
    v_mfma_f32_16x16x32_bf16 v[160:163], v[112:115], v[104:107], v[160:163]
    s_barrier
    v_mfma_f32_16x16x32_bf16 v[164:167], v[116:119], v[104:107], v[164:167]
    ds_read_b128 v[72:75], v14 offset:49152
    ds_read_b64_tr_b16 v[80:81], v4 offset:49152
    s_waitcnt lgkmcnt(15)
    v_mfma_f32_16x16x32_bf16 v[168:171], v[120:123], v[104:107], v[168:171]
    ds_read_b64_tr_b16 v[82:83], v4 offset:53248
    s_waitcnt lgkmcnt(14)
    v_mfma_f32_16x16x32_bf16 v[172:175], v[124:127], v[104:107], v[172:175]
    ds_read_b64_tr_b16 v[84:85], v5 offset:49152
    s_waitcnt lgkmcnt(14)
    v_mfma_f32_16x16x32_bf16 v[176:179], v[112:115], v[108:111], v[176:179]
    ds_read_b64_tr_b16 v[86:87], v5 offset:53248
    v_mfma_f32_16x16x32_bf16 v[180:183], v[116:119], v[108:111], v[180:183]
    ds_read_b64_tr_b16 v[88:89], v6 offset:49152
    v_mfma_f32_16x16x32_bf16 v[184:187], v[120:123], v[108:111], v[184:187]
    ds_read_b64_tr_b16 v[90:91], v6 offset:53248
    v_mfma_f32_16x16x32_bf16 v[188:191], v[124:127], v[108:111], v[188:191]
    ds_read_b64_tr_b16 v[92:93], v7 offset:49152
    s_waitcnt lgkmcnt(15)
    v_mfma_f32_16x16x32_bf16 v[160:163], v[192:195], v[208:211], v[160:163]
    ds_read_b64_tr_b16 v[94:95], v7 offset:53248
    s_waitcnt lgkmcnt(14)
    v_mfma_f32_16x16x32_bf16 v[164:167], v[196:199], v[208:211], v[164:167]
    ds_read_b128 v[76:79], v14 offset:50176
    s_waitcnt lgkmcnt(13)
    v_mfma_f32_16x16x32_bf16 v[168:171], v[200:203], v[208:211], v[168:171]
    ds_read_b128 v[40:43], v14 offset:57344
    ds_read_b64_tr_b16 v[24:25], v4 offset:57344
    s_waitcnt lgkmcnt(13)
    v_mfma_f32_16x16x32_bf16 v[172:175], v[204:207], v[208:211], v[172:175]
    ds_read_b64_tr_b16 v[26:27], v4 offset:61440
    s_waitcnt lgkmcnt(13)
    v_mfma_f32_16x16x32_bf16 v[176:179], v[192:195], v[212:215], v[176:179]
    ds_read_b64_tr_b16 v[28:29], v5 offset:57344
    v_mfma_f32_16x16x32_bf16 v[180:183], v[196:199], v[212:215], v[180:183]
    ds_read_b64_tr_b16 v[30:31], v5 offset:61440
    v_mfma_f32_16x16x32_bf16 v[184:187], v[200:203], v[212:215], v[184:187]
    ds_read_b64_tr_b16 v[32:33], v6 offset:57344
    ds_read_b64_tr_b16 v[34:35], v6 offset:61440
    v_mfma_f32_16x16x32_bf16 v[188:191], v[204:207], v[212:215], v[188:191]
    ds_read_b64_tr_b16 v[36:37], v7 offset:57344
    s_waitcnt lgkmcnt(15)
    v_mfma_f32_16x16x32_bf16 v[160:163], v[80:83], v[72:75], v[160:163]
    ds_read_b64_tr_b16 v[38:39], v7 offset:61440
    s_waitcnt lgkmcnt(14)
    v_mfma_f32_16x16x32_bf16 v[164:167], v[84:87], v[72:75], v[164:167]
    ds_read_b128 v[44:47], v14 offset:58368
    s_waitcnt lgkmcnt(13)
    v_mfma_f32_16x16x32_bf16 v[168:171], v[88:91], v[72:75], v[168:171]
    ds_read_b128 v[48:51], v2 offset:57344
    s_waitcnt lgkmcnt(12)
    v_mfma_f32_16x16x32_bf16 v[172:175], v[92:95], v[72:75], v[172:175]
    ds_read_b128 v[52:55], v2 offset:58368
    s_waitcnt lgkmcnt(12)
    v_mfma_f32_16x16x32_bf16 v[176:179], v[80:83], v[76:79], v[176:179]
    ds_read_b128 v[216:219], v2 offset:40960
    v_mfma_f32_16x16x32_bf16 v[180:183], v[84:87], v[76:79], v[180:183]
    v_mfma_f32_16x16x32_bf16 v[184:187], v[88:91], v[76:79], v[184:187]
    ds_read_b128 v[220:223], v2 offset:41984
    v_mfma_f32_16x16x32_bf16 v[188:191], v[92:95], v[76:79], v[188:191]
    ds_read_b128 v[96:99], v2 offset:32768
    s_waitcnt lgkmcnt(12)
    v_mfma_f32_16x16x32_bf16 v[160:163], v[24:27], v[40:43], v[160:163]
    ds_read_b128 v[100:103], v2 offset:33792
    s_waitcnt lgkmcnt(11)
    v_mfma_f32_16x16x32_bf16 v[164:167], v[28:31], v[40:43], v[164:167]
    s_waitcnt lgkmcnt(9)
    v_mfma_f32_16x16x32_bf16 v[168:171], v[32:35], v[40:43], v[168:171]
    ds_read_b128 v[72:75], v2 offset:49152
    s_waitcnt lgkmcnt(8)
    v_mfma_f32_16x16x32_bf16 v[172:175], v[36:39], v[40:43], v[172:175]
    ds_read_b128 v[76:79], v2 offset:50176
    s_waitcnt lgkmcnt(8)
    v_mfma_f32_16x16x32_bf16 v[176:179], v[24:27], v[44:47], v[176:179]
    v_mfma_f32_16x16x32_bf16 v[180:183], v[28:31], v[44:47], v[180:183]
    v_mfma_f32_16x16x32_bf16 v[184:187], v[32:35], v[44:47], v[184:187]
    v_cvt_pk_bf16_f32 v160, v160, v161
    v_cvt_pk_bf16_f32 v161, v162, v163
    v_mfma_f32_16x16x32_bf16 v[188:191], v[36:39], v[44:47], v[188:191]
    v_cvt_pk_bf16_f32 v162, v164, v165
    v_cvt_pk_bf16_f32 v163, v166, v167
    s_waitcnt lgkmcnt(7)
    v_mfma_f32_16x16x32_bf16 v[128:131], v[24:27], v[48:51], v[128:131]
    v_cvt_pk_bf16_f32 v168, v168, v169
    v_cvt_pk_bf16_f32 v169, v170, v171
    v_mfma_f32_16x16x32_bf16 v[132:135], v[28:31], v[48:51], v[132:135]
    v_permlane16_swap_b32 v160, v162
    v_permlane16_swap_b32 v161, v163
    v_cvt_pk_bf16_f32 v170, v172, v173
    v_cvt_pk_bf16_f32 v171, v174, v175
    v_mfma_f32_16x16x32_bf16 v[136:139], v[32:35], v[48:51], v[136:139]
    buffer_store_dwordx4 v[160:163], v8, s[32:35], s52 offen offset:0 sc1
    v_mfma_f32_16x16x32_bf16 v[140:143], v[36:39], v[48:51], v[140:143]
    v_permlane16_swap_b32 v168, v170
    v_permlane16_swap_b32 v169, v171
    v_cvt_pk_bf16_f32 v176, v176, v177
    v_cvt_pk_bf16_f32 v177, v178, v179
    s_waitcnt lgkmcnt(6)
    v_mfma_f32_16x16x32_bf16 v[144:147], v[24:27], v[52:55], v[144:147]
    v_cvt_pk_bf16_f32 v178, v180, v181
    v_cvt_pk_bf16_f32 v179, v182, v183
    v_mfma_f32_16x16x32_bf16 v[148:151], v[28:31], v[52:55], v[148:151]
    v_cvt_pk_bf16_f32 v184, v184, v185
    v_cvt_pk_bf16_f32 v185, v186, v187
    v_mfma_f32_16x16x32_bf16 v[152:155], v[32:35], v[52:55], v[152:155]
    buffer_store_dwordx4 v[168:171], v8, s[32:35], s52 offen offset:1024 sc1
    v_permlane16_swap_b32 v176, v178
    v_permlane16_swap_b32 v177, v179
    v_cvt_pk_bf16_f32 v186, v188, v189
    v_cvt_pk_bf16_f32 v187, v190, v191
    v_mfma_f32_16x16x32_bf16 v[156:159], v[36:39], v[52:55], v[156:159]
    s_waitcnt lgkmcnt(1)
    v_mfma_f32_16x16x32_bf16 v[128:131], v[80:83], v[72:75], v[128:131]
    v_permlane16_swap_b32 v184, v186
    v_permlane16_swap_b32 v185, v187
    v_mfma_f32_16x16x32_bf16 v[132:135], v[84:87], v[72:75], v[132:135]
    v_mfma_f32_16x16x32_bf16 v[136:139], v[88:91], v[72:75], v[136:139]
    buffer_store_dwordx4 v[176:179], v8, s[32:35], s52 offen offset:2048 sc1
    v_mfma_f32_16x16x32_bf16 v[140:143], v[92:95], v[72:75], v[140:143]
    s_waitcnt lgkmcnt(0)
    v_mfma_f32_16x16x32_bf16 v[144:147], v[80:83], v[76:79], v[144:147]
    ds_read_b128 v[40:43], v2 offset:24576
    v_mfma_f32_16x16x32_bf16 v[148:151], v[84:87], v[76:79], v[148:151]
    ds_read_b128 v[44:47], v2 offset:25600
    v_mfma_f32_16x16x32_bf16 v[152:155], v[88:91], v[76:79], v[152:155]
    ds_read_b64_tr_b16 v[24:25], v4 offset:24576
    buffer_store_dwordx4 v[184:187], v8, s[32:35], s52 offen offset:3072 sc1
    v_mfma_f32_16x16x32_bf16 v[156:159], v[92:95], v[76:79], v[156:159]
    ds_read_b64_tr_b16 v[26:27], v4 offset:28672
    v_mfma_f32_16x16x32_bf16 v[128:131], v[192:195], v[216:219], v[128:131]
    ds_read_b64_tr_b16 v[28:29], v5 offset:24576
    v_mfma_f32_16x16x32_bf16 v[132:135], v[196:199], v[216:219], v[132:135]
    ds_read_b64_tr_b16 v[30:31], v5 offset:28672
    v_mfma_f32_16x16x32_bf16 v[136:139], v[200:203], v[216:219], v[136:139]
    ds_read_b64_tr_b16 v[32:33], v6 offset:24576
    v_mfma_f32_16x16x32_bf16 v[140:143], v[204:207], v[216:219], v[140:143]
    ds_read_b64_tr_b16 v[34:35], v6 offset:28672
    v_mfma_f32_16x16x32_bf16 v[144:147], v[192:195], v[220:223], v[144:147]
    ds_read_b64_tr_b16 v[36:37], v7 offset:24576
    v_mfma_f32_16x16x32_bf16 v[148:151], v[196:199], v[220:223], v[148:151]
    ds_read_b64_tr_b16 v[38:39], v7 offset:28672
    v_mfma_f32_16x16x32_bf16 v[152:155], v[200:203], v[220:223], v[152:155]
    ds_read_b64_tr_b16 v[80:81], v4 offset:16384
    v_mfma_f32_16x16x32_bf16 v[156:159], v[204:207], v[220:223], v[156:159]
    ds_read_b64_tr_b16 v[82:83], v4 offset:20480
    v_mfma_f32_16x16x32_bf16 v[128:131], v[112:115], v[96:99], v[128:131]
    ds_read_b64_tr_b16 v[84:85], v5 offset:16384
    v_lshlrev_b32 v192, 16, v240
    v_and_b32 v193, 0xffff0000, v240
    v_mfma_f32_16x16x32_bf16 v[132:135], v[116:119], v[96:99], v[132:135]
    ds_read_b64_tr_b16 v[86:87], v5 offset:20480
    v_lshlrev_b32 v194, 16, v241
    v_and_b32 v195, 0xffff0000, v241
    v_mfma_f32_16x16x32_bf16 v[136:139], v[120:123], v[96:99], v[136:139]
    ds_read_b64_tr_b16 v[88:89], v6 offset:16384
    v_lshlrev_b32 v196, 16, v242
    v_and_b32 v197, 0xffff0000, v242
    v_mfma_f32_16x16x32_bf16 v[140:143], v[124:127], v[96:99], v[140:143]
    ds_read_b64_tr_b16 v[90:91], v6 offset:20480
    v_lshlrev_b32 v198, 16, v243
    v_and_b32 v199, 0xffff0000, v243
    v_mfma_f32_16x16x32_bf16 v[144:147], v[112:115], v[100:103], v[144:147]
    ds_read_b64_tr_b16 v[92:93], v7 offset:16384
    v_lshlrev_b32 v200, 16, v244
    v_and_b32 v201, 0xffff0000, v244
    v_mfma_f32_16x16x32_bf16 v[148:151], v[116:119], v[100:103], v[148:151]
    ds_read_b64_tr_b16 v[94:95], v7 offset:20480
    v_lshlrev_b32 v202, 16, v245
    v_and_b32 v203, 0xffff0000, v245
    v_mfma_f32_16x16x32_bf16 v[152:155], v[120:123], v[100:103], v[152:155]
    v_lshlrev_b32 v204, 16, v246
    v_and_b32 v205, 0xffff0000, v246
    v_mfma_f32_16x16x32_bf16 v[156:159], v[124:127], v[100:103], v[156:159]
    v_lshlrev_b32 v206, 16, v247
    v_and_b32 v207, 0xffff0000, v247
    s_waitcnt lgkmcnt(14)
    v_mfma_f32_16x16x32_bf16 v[128:131], v[24:27], v[40:43], v[128:131]
    v_lshlrev_b32 v208, 16, v248
    v_and_b32 v209, 0xffff0000, v248
    s_waitcnt lgkmcnt(12)
    v_mfma_f32_16x16x32_bf16 v[132:135], v[28:31], v[40:43], v[132:135]
    v_lshlrev_b32 v210, 16, v249
    v_and_b32 v211, 0xffff0000, v249
    s_waitcnt lgkmcnt(10)
    v_mfma_f32_16x16x32_bf16 v[136:139], v[32:35], v[40:43], v[136:139]
    v_lshlrev_b32 v212, 16, v250
    v_and_b32 v213, 0xffff0000, v250
    s_waitcnt lgkmcnt(8)
    v_mfma_f32_16x16x32_bf16 v[140:143], v[36:39], v[40:43], v[140:143]
    v_lshlrev_b32 v214, 16, v251
    v_and_b32 v215, 0xffff0000, v251
    v_mfma_f32_16x16x32_bf16 v[144:147], v[24:27], v[44:47], v[144:147]
    v_lshlrev_b32 v216, 16, v252
    v_and_b32 v217, 0xffff0000, v252
    v_mfma_f32_16x16x32_bf16 v[148:151], v[28:31], v[44:47], v[148:151]
    v_lshlrev_b32 v218, 16, v253
    v_and_b32 v219, 0xffff0000, v253
    v_mfma_f32_16x16x32_bf16 v[152:155], v[32:35], v[44:47], v[152:155]
    v_lshlrev_b32 v220, 16, v254
    v_and_b32 v221, 0xffff0000, v254
    v_mfma_f32_16x16x32_bf16 v[156:159], v[36:39], v[44:47], v[156:159]
    v_lshlrev_b32 v222, 16, v255
    v_and_b32 v223, 0xffff0000, v255
    s_waitcnt lgkmcnt(6)
    v_mfma_f32_16x16x32_bf16 v[128:131], v[80:83], v[64:67], v[128:131]
    v_lshlrev_b32 v112, 16, v224
    v_and_b32 v113, 0xffff0000, v224
    buffer_load_dwordx4 v[56:59], v3, s[32:35], s69 offen offset:0 sc1
    s_waitcnt lgkmcnt(4)
    v_mfma_f32_16x16x32_bf16 v[132:135], v[84:87], v[64:67], v[132:135]
    v_lshlrev_b32 v114, 16, v225
    v_and_b32 v115, 0xffff0000, v225
    buffer_load_dwordx4 v[60:63], v3, s[32:35], s69 offen offset:64 sc1
    s_waitcnt lgkmcnt(2)
    v_mfma_f32_16x16x32_bf16 v[136:139], v[88:91], v[64:67], v[136:139]
    v_lshlrev_b32 v116, 16, v226
    v_and_b32 v117, 0xffff0000, v226
    buffer_load_dwordx4 v[234:237], v3, s[32:35], s70 offen offset:0 sc1
    s_waitcnt lgkmcnt(0)
    v_mfma_f32_16x16x32_bf16 v[140:143], v[92:95], v[64:67], v[140:143]
    v_lshlrev_b32 v118, 16, v227
    v_and_b32 v119, 0xffff0000, v227
    buffer_load_dwordx4 v[16:19], v3, s[32:35], s70 offen offset:64 sc1
    v_mfma_f32_16x16x32_bf16 v[144:147], v[80:83], v[68:71], v[144:147]
    v_lshlrev_b32 v120, 16, v228
    v_and_b32 v121, 0xffff0000, v228
    v_mfma_f32_16x16x32_bf16 v[148:151], v[84:87], v[68:71], v[148:151]
    v_lshlrev_b32 v122, 16, v229
    v_and_b32 v123, 0xffff0000, v229
    v_mfma_f32_16x16x32_bf16 v[152:155], v[88:91], v[68:71], v[152:155]
    v_lshlrev_b32 v124, 16, v230
    v_and_b32 v125, 0xffff0000, v230
    v_mfma_f32_16x16x32_bf16 v[156:159], v[92:95], v[68:71], v[156:159]
    v_lshlrev_b32 v126, 16, v231
    v_and_b32 v127, 0xffff0000, v231
    s_nop 3
    v_permlane16_swap_b32 v128, v132
    v_permlane16_swap_b32 v129, v133
    v_permlane16_swap_b32 v130, v134
    v_permlane16_swap_b32 v131, v135
    v_permlane16_swap_b32 v136, v140
    v_permlane16_swap_b32 v137, v141
    v_permlane16_swap_b32 v138, v142
    v_permlane16_swap_b32 v139, v143
    v_permlane16_swap_b32 v144, v148
    v_permlane16_swap_b32 v145, v149
    v_permlane16_swap_b32 v146, v150
    v_permlane16_swap_b32 v147, v151
    v_permlane16_swap_b32 v152, v156
    v_permlane16_swap_b32 v153, v157
    v_permlane16_swap_b32 v154, v158
    v_permlane16_swap_b32 v155, v159
    v_pk_fma_f32 v[128:129], v[128:129], v[232:233], v[112:113] op_sel:[0,0,0] op_sel_hi:[1,0,1]
    v_pk_fma_f32 v[130:131], v[130:131], v[232:233], v[114:115] op_sel:[0,0,0] op_sel_hi:[1,0,1]
    v_pk_fma_f32 v[132:133], v[132:133], v[232:233], v[116:117] op_sel:[0,0,0] op_sel_hi:[1,0,1]
    v_pk_fma_f32 v[134:135], v[134:135], v[232:233], v[118:119] op_sel:[0,0,0] op_sel_hi:[1,0,1]
    v_pk_fma_f32 v[136:137], v[136:137], v[232:233], v[120:121] op_sel:[0,0,0] op_sel_hi:[1,0,1]
    v_pk_fma_f32 v[138:139], v[138:139], v[232:233], v[122:123] op_sel:[0,0,0] op_sel_hi:[1,0,1]
    v_pk_fma_f32 v[140:141], v[140:141], v[232:233], v[124:125] op_sel:[0,0,0] op_sel_hi:[1,0,1]
    v_pk_fma_f32 v[142:143], v[142:143], v[232:233], v[126:127] op_sel:[0,0,0] op_sel_hi:[1,0,1]
    v_pk_fma_f32 v[144:145], v[144:145], v[232:233], v[112:113] op_sel:[0,1,0] op_sel_hi:[1,1,1]
    v_pk_fma_f32 v[146:147], v[146:147], v[232:233], v[114:115] op_sel:[0,1,0] op_sel_hi:[1,1,1]
    v_pk_fma_f32 v[148:149], v[148:149], v[232:233], v[116:117] op_sel:[0,1,0] op_sel_hi:[1,1,1]
    v_pk_fma_f32 v[150:151], v[150:151], v[232:233], v[118:119] op_sel:[0,1,0] op_sel_hi:[1,1,1]
    v_pk_fma_f32 v[152:153], v[152:153], v[232:233], v[120:121] op_sel:[0,1,0] op_sel_hi:[1,1,1]
    v_pk_fma_f32 v[154:155], v[154:155], v[232:233], v[122:123] op_sel:[0,1,0] op_sel_hi:[1,1,1]
    v_pk_fma_f32 v[156:157], v[156:157], v[232:233], v[124:125] op_sel:[0,1,0] op_sel_hi:[1,1,1]
    v_pk_fma_f32 v[158:159], v[158:159], v[232:233], v[126:127] op_sel:[0,1,0] op_sel_hi:[1,1,1]
    s_waitcnt vmcnt(4)
    buffer_load_dwordx4 v[96:99], v8, s[32:35], s56 offen offset:0 sc1
    buffer_load_dwordx4 v[100:103], v8, s[32:35], s56 offen offset:1024 sc1
    buffer_load_dwordx4 v[104:107], v8, s[32:35], s56 offen offset:2048 sc1
    buffer_load_dwordx4 v[108:111], v8, s[32:35], s56 offen offset:3072 sc1
    s_waitcnt vmcnt(4)
    v_max3_u32 v9, v56, v57, v58
    v_max3_u32 v10, v59, v60, v61
    v_max3_u32 v10, v10, v62, v63
    v_max3_u32 v9, v9, v234, v235
    v_max3_u32 v10, v10, v236, v237
    v_max3_u32 v9, v9, v16, v17
    v_max3_u32 v10, v10, v18, v19
    v_max_u32 v9, v9, v10
    s_nop 0
    v_cmp_eq_u32 vcc, -1, v9
    s_cbranch_vccnz C3_sr
    v_lshlrev_b32 v64, 16, v56
    v_and_b32 v65, 0xffff0000, v56
    v_lshlrev_b32 v66, 16, v57
    v_and_b32 v67, 0xffff0000, v57
    v_lshlrev_b32 v68, 16, v58
    v_and_b32 v69, 0xffff0000, v58
    v_lshlrev_b32 v70, 16, v59
    v_and_b32 v71, 0xffff0000, v59
    v_lshlrev_b32 v72, 16, v60
    v_and_b32 v73, 0xffff0000, v60
    v_lshlrev_b32 v74, 16, v61
    v_and_b32 v75, 0xffff0000, v61
    v_lshlrev_b32 v76, 16, v62
    v_and_b32 v77, 0xffff0000, v62
    v_lshlrev_b32 v78, 16, v63
    v_and_b32 v79, 0xffff0000, v63
    v_lshlrev_b32 v80, 16, v234
    v_and_b32 v81, 0xffff0000, v234
    v_lshlrev_b32 v82, 16, v235
    v_and_b32 v83, 0xffff0000, v235
    v_lshlrev_b32 v84, 16, v236
    v_and_b32 v85, 0xffff0000, v236
    v_lshlrev_b32 v86, 16, v237
    v_and_b32 v87, 0xffff0000, v237
    v_lshlrev_b32 v88, 16, v16
    v_and_b32 v89, 0xffff0000, v16
    v_lshlrev_b32 v90, 16, v17
    v_and_b32 v91, 0xffff0000, v17
    v_lshlrev_b32 v92, 16, v18
    v_and_b32 v93, 0xffff0000, v18
    v_lshlrev_b32 v94, 16, v19
    v_and_b32 v95, 0xffff0000, v19
    s_mov_b32 s57, 1
C3_w:
    s_waitcnt vmcnt(0)
    v_max3_u32 v9, v96, v97, v98
    v_max3_u32 v10, v99, v100, v101
    v_max3_u32 v10, v10, v102, v103
    v_max3_u32 v9, v9, v104, v105
    v_max3_u32 v10, v10, v106, v107
    v_max3_u32 v9, v9, v108, v109
    v_max3_u32 v10, v10, v110, v111
    v_max_u32 v9, v9, v10
    s_nop 0
    v_cmp_eq_u32 vcc, -1, v9
    s_add_u32 s58, s58, 1
    s_cbranch_vccnz C3_pr
    s_cmp_eq_u32 s57, 0
    s_cbranch_scc1 C3_s0
C3_ok:
    v_lshlrev_b32 v160, 16, v96
    v_and_b32 v161, 0xffff0000, v96
    v_lshlrev_b32 v162, 16, v97
    v_and_b32 v163, 0xffff0000, v97
    v_lshlrev_b32 v164, 16, v98
    v_and_b32 v165, 0xffff0000, v98
    v_lshlrev_b32_e64 v166, 16, v99
    v_and_b32 v167, 0xffff0000, v99
    v_pk_fma_f32 v[128:129], v[160:161], v[232:233], v[128:129] op_sel:[0,0,0] op_sel_hi:[1,0,1]
    v_pk_fma_f32 v[130:131], v[162:163], v[232:233], v[130:131] op_sel:[0,0,0] op_sel_hi:[1,0,1]
    v_pk_fma_f32 v[132:133], v[164:165], v[232:233], v[132:133] op_sel:[0,0,0] op_sel_hi:[1,0,1]
    v_pk_fma_f32 v[134:135], v[166:167], v[232:233], v[134:135] op_sel:[0,0,0] op_sel_hi:[1,0,1]
    v_pk_mul_f32 v[160:161], v[128:129], s[54:55]
    v_pk_mul_f32 v[162:163], v[130:131], s[54:55]
    v_pk_mul_f32 v[164:165], v[132:133], s[54:55]
    v_pk_mul_f32 v[166:167], v[134:135], s[54:55]
    v_exp_f32 v160, v160
    v_exp_f32 v161, v161
    v_exp_f32 v162, v162
    v_exp_f32 v163, v163
    v_exp_f32 v164, v164
    v_exp_f32 v165, v165
    v_exp_f32 v166, v166
    v_exp_f32 v167, v167
    v_pk_add_f32 v[160:161], v[160:161], s[50:51]
    v_pk_add_f32 v[162:163], v[162:163], s[50:51]
    v_pk_add_f32 v[164:165], v[164:165], s[50:51]
    v_pk_add_f32 v[166:167], v[166:167], s[50:51]
    v_rcp_f32 v160, v160
    v_rcp_f32 v161, v161
    v_rcp_f32 v162, v162
    v_rcp_f32 v163, v163
    v_rcp_f32 v164, v164
    v_rcp_f32 v165, v165
    v_rcp_f32 v166, v166
    v_rcp_f32 v167, v167
    v_pk_mul_f32 v[128:129], v[128:129], v[160:161]
    v_pk_mul_f32 v[130:131], v[130:131], v[162:163]
    v_pk_mul_f32 v[132:133], v[132:133], v[164:165]
    v_pk_mul_f32 v[134:135], v[134:135], v[166:167]
    v_pk_fma_f32 v[128:129], v[128:129], v[64:65], v[192:193]
    v_pk_fma_f32 v[130:131], v[130:131], v[66:67], v[194:195]
    v_pk_fma_f32 v[132:133], v[132:133], v[68:69], v[196:197]
    v_pk_fma_f32 v[134:135], v[134:135], v[70:71], v[198:199]
    v_cvt_pk_bf16_f32 v240, v128, v129
    v_cvt_pk_bf16_f32 v241, v130, v131
    v_cvt_pk_bf16_f32 v242, v132, v133
    v_cvt_pk_bf16_f32 v243, v134, v135
    buffer_store_dwordx4 v[240:243], v3, s[40:43], s66 offen offset:0 sc0 sc1
    v_lshlrev_b32 v168, 16, v100
    v_and_b32 v169, 0xffff0000, v100
    v_lshlrev_b32 v170, 16, v101
    v_and_b32 v171, 0xffff0000, v101
    v_lshlrev_b32 v172, 16, v102
    v_and_b32 v173, 0xffff0000, v102
    v_lshlrev_b32 v174, 16, v103
    v_and_b32 v175, 0xffff0000, v103
    v_pk_fma_f32 v[136:137], v[168:169], v[232:233], v[136:137] op_sel:[0,0,0] op_sel_hi:[1,0,1]
    v_pk_fma_f32 v[138:139], v[170:171], v[232:233], v[138:139] op_sel:[0,0,0] op_sel_hi:[1,0,1]
    v_pk_fma_f32 v[140:141], v[172:173], v[232:233], v[140:141] op_sel:[0,0,0] op_sel_hi:[1,0,1]
    v_pk_fma_f32 v[142:143], v[174:175], v[232:233], v[142:143] op_sel:[0,0,0] op_sel_hi:[1,0,1]
    v_pk_mul_f32 v[168:169], v[136:137], s[54:55]
    v_pk_mul_f32 v[170:171], v[138:139], s[54:55]
    v_pk_mul_f32 v[172:173], v[140:141], s[54:55]
    v_pk_mul_f32 v[174:175], v[142:143], s[54:55]
    v_exp_f32 v168, v168
    v_exp_f32 v169, v169
    v_exp_f32 v170, v170
    v_exp_f32 v171, v171
    v_exp_f32 v172, v172
    v_exp_f32 v173, v173
    v_exp_f32 v174, v174
    v_exp_f32 v175, v175
    v_pk_add_f32 v[168:169], v[168:169], s[50:51]
    v_pk_add_f32 v[170:171], v[170:171], s[50:51]
    v_pk_add_f32 v[172:173], v[172:173], s[50:51]
    v_pk_add_f32 v[174:175], v[174:175], s[50:51]
    v_rcp_f32 v168, v168
    v_rcp_f32 v169, v169
    v_rcp_f32 v170, v170
    v_rcp_f32 v171, v171
    v_rcp_f32 v172, v172
    v_rcp_f32 v173, v173
    v_rcp_f32 v174, v174
    v_rcp_f32 v175, v175
    v_pk_mul_f32 v[136:137], v[136:137], v[168:169]
    v_pk_mul_f32 v[138:139], v[138:139], v[170:171]
    v_pk_mul_f32 v[140:141], v[140:141], v[172:173]
    v_pk_mul_f32 v[142:143], v[142:143], v[174:175]
    v_pk_fma_f32 v[136:137], v[136:137], v[72:73], v[200:201]
    v_pk_fma_f32 v[138:139], v[138:139], v[74:75], v[202:203]
    v_pk_fma_f32 v[140:141], v[140:141], v[76:77], v[204:205]
    v_pk_fma_f32 v[142:143], v[142:143], v[78:79], v[206:207]
    v_cvt_pk_bf16_f32 v244, v136, v137
    v_cvt_pk_bf16_f32 v245, v138, v139
    v_cvt_pk_bf16_f32 v246, v140, v141
    v_cvt_pk_bf16_f32 v247, v142, v143
    buffer_store_dwordx4 v[244:247], v3, s[40:43], s66 offen offset:64 sc0 sc1
    v_lshlrev_b32 v176, 16, v104
    v_and_b32 v177, 0xffff0000, v104
    v_lshlrev_b32 v178, 16, v105
    v_and_b32 v179, 0xffff0000, v105
    v_lshlrev_b32 v180, 16, v106
    v_and_b32 v181, 0xffff0000, v106
    v_lshlrev_b32 v182, 16, v107
    v_and_b32 v183, 0xffff0000, v107
    v_pk_fma_f32 v[144:145], v[176:177], v[232:233], v[144:145] op_sel:[0,1,0] op_sel_hi:[1,1,1]
    v_pk_fma_f32 v[146:147], v[178:179], v[232:233], v[146:147] op_sel:[0,1,0] op_sel_hi:[1,1,1]
    v_pk_fma_f32 v[148:149], v[180:181], v[232:233], v[148:149] op_sel:[0,1,0] op_sel_hi:[1,1,1]
    v_pk_fma_f32 v[150:151], v[182:183], v[232:233], v[150:151] op_sel:[0,1,0] op_sel_hi:[1,1,1]
    v_pk_mul_f32 v[176:177], v[144:145], s[54:55]
    v_pk_mul_f32 v[178:179], v[146:147], s[54:55]
    v_pk_mul_f32 v[180:181], v[148:149], s[54:55]
    v_pk_mul_f32 v[182:183], v[150:151], s[54:55]
    v_exp_f32 v176, v176
    v_exp_f32 v177, v177
    v_exp_f32 v178, v178
    v_exp_f32 v179, v179
    v_exp_f32 v180, v180
    v_exp_f32 v181, v181
    v_exp_f32 v182, v182
    v_exp_f32 v183, v183
    v_pk_add_f32 v[176:177], v[176:177], s[50:51]
    v_pk_add_f32 v[178:179], v[178:179], s[50:51]
    v_pk_add_f32 v[180:181], v[180:181], s[50:51]
    v_pk_add_f32 v[182:183], v[182:183], s[50:51]
    v_rcp_f32 v176, v176
    v_rcp_f32 v177, v177
    v_rcp_f32 v178, v178
    v_rcp_f32 v179, v179
    v_rcp_f32 v180, v180
    v_rcp_f32 v181, v181
    v_rcp_f32 v182, v182
    v_rcp_f32 v183, v183
    v_pk_mul_f32 v[144:145], v[144:145], v[176:177]
    v_pk_mul_f32 v[146:147], v[146:147], v[178:179]
    v_pk_mul_f32 v[148:149], v[148:149], v[180:181]
    v_pk_mul_f32 v[150:151], v[150:151], v[182:183]
    v_pk_fma_f32 v[144:145], v[144:145], v[80:81], v[208:209]
    v_pk_fma_f32 v[146:147], v[146:147], v[82:83], v[210:211]
    v_pk_fma_f32 v[148:149], v[148:149], v[84:85], v[212:213]
    v_pk_fma_f32 v[150:151], v[150:151], v[86:87], v[214:215]
    v_cvt_pk_bf16_f32 v248, v144, v145
    v_cvt_pk_bf16_f32 v249, v146, v147
    v_cvt_pk_bf16_f32 v250, v148, v149
    v_cvt_pk_bf16_f32 v251, v150, v151
    buffer_store_dwordx4 v[248:251], v3, s[40:43], s67 offen offset:0 sc0 sc1
    v_lshlrev_b32 v184, 16, v108
    v_and_b32 v185, 0xffff0000, v108
    v_lshlrev_b32 v186, 16, v109
    v_and_b32 v187, 0xffff0000, v109
    v_lshlrev_b32 v188, 16, v110
    v_and_b32 v189, 0xffff0000, v110
    v_lshlrev_b32 v190, 16, v111
    v_and_b32 v191, 0xffff0000, v111
    v_pk_fma_f32 v[152:153], v[184:185], v[232:233], v[152:153] op_sel:[0,1,0] op_sel_hi:[1,1,1]
    v_pk_fma_f32 v[154:155], v[186:187], v[232:233], v[154:155] op_sel:[0,1,0] op_sel_hi:[1,1,1]
    v_pk_fma_f32 v[156:157], v[188:189], v[232:233], v[156:157] op_sel:[0,1,0] op_sel_hi:[1,1,1]
    v_pk_fma_f32 v[158:159], v[190:191], v[232:233], v[158:159] op_sel:[0,1,0] op_sel_hi:[1,1,1]
    v_pk_mul_f32 v[184:185], v[152:153], s[54:55]
    v_pk_mul_f32 v[186:187], v[154:155], s[54:55]
    v_pk_mul_f32 v[188:189], v[156:157], s[54:55]
    v_pk_mul_f32 v[190:191], v[158:159], s[54:55]
    v_exp_f32 v184, v184
    v_exp_f32 v185, v185
    v_exp_f32 v186, v186
    v_exp_f32 v187, v187
    v_exp_f32 v188, v188
    v_exp_f32 v189, v189
    v_exp_f32 v190, v190
    v_exp_f32 v191, v191
    v_pk_add_f32 v[184:185], v[184:185], s[50:51]
    v_pk_add_f32 v[186:187], v[186:187], s[50:51]
    v_pk_add_f32 v[188:189], v[188:189], s[50:51]
    v_pk_add_f32 v[190:191], v[190:191], s[50:51]
    v_rcp_f32 v184, v184
    v_rcp_f32 v185, v185
    v_rcp_f32 v186, v186
    v_rcp_f32 v187, v187
    v_rcp_f32 v188, v188
    v_rcp_f32 v189, v189
    v_rcp_f32 v190, v190
    v_rcp_f32 v191, v191
    v_pk_mul_f32 v[152:153], v[152:153], v[184:185]
    v_pk_mul_f32 v[154:155], v[154:155], v[186:187]
    v_pk_mul_f32 v[156:157], v[156:157], v[188:189]
    v_pk_mul_f32 v[158:159], v[158:159], v[190:191]
    v_pk_fma_f32 v[152:153], v[152:153], v[88:89], v[216:217]
    v_pk_fma_f32 v[154:155], v[154:155], v[90:91], v[218:219]
    v_pk_fma_f32 v[156:157], v[156:157], v[92:93], v[220:221]
    v_pk_fma_f32 v[158:159], v[158:159], v[94:95], v[222:223]
    v_cvt_pk_bf16_f32 v252, v152, v153
    v_cvt_pk_bf16_f32 v253, v154, v155
    v_cvt_pk_bf16_f32 v254, v156, v157
    v_cvt_pk_bf16_f32 v255, v158, v159
    buffer_store_dwordx4 v[252:255], v3, s[40:43], s67 offen offset:64 sc0 sc1
    s_endpgm
C3_pr:
    s_cmp_ge_u32 s58, 0x4000
    s_cbranch_scc1 C3_ok
    s_mov_b64 exec, vcc
    buffer_load_dwordx4 v[96:99], v8, s[32:35], s56 offen offset:0 sc1
    buffer_load_dwordx4 v[100:103], v8, s[32:35], s56 offen offset:1024 sc1
    buffer_load_dwordx4 v[104:107], v8, s[32:35], s56 offen offset:2048 sc1
    buffer_load_dwordx4 v[108:111], v8, s[32:35], s56 offen offset:3072 sc1
    s_mov_b64 exec, -1
    s_cmp_eq_u32 s57, 0
    s_cbranch_scc0 C3_w
    s_branch C3_s
C3_s0:
    s_cmp_ge_u32 s58, 0x4000
    s_cbranch_scc1 C3_ok
C3_s:
    v_max3_u32 v9, v56, v57, v58
    v_max3_u32 v10, v59, v60, v61
    v_max3_u32 v10, v10, v62, v63
    v_max3_u32 v9, v9, v234, v235
    v_max3_u32 v10, v10, v236, v237
    v_max3_u32 v9, v9, v16, v17
    v_max3_u32 v10, v10, v18, v19
    v_max_u32 v9, v9, v10
    s_nop 0
    v_cmp_eq_u32 vcc, -1, v9
    s_cbranch_vccnz C3_sr
    v_lshlrev_b32 v64, 16, v56
    v_and_b32 v65, 0xffff0000, v56
    v_lshlrev_b32 v66, 16, v57
    v_and_b32 v67, 0xffff0000, v57
    v_lshlrev_b32 v68, 16, v58
    v_and_b32 v69, 0xffff0000, v58
    v_lshlrev_b32 v70, 16, v59
    v_and_b32 v71, 0xffff0000, v59
    v_lshlrev_b32 v72, 16, v60
    v_and_b32 v73, 0xffff0000, v60
    v_lshlrev_b32 v74, 16, v61
    v_and_b32 v75, 0xffff0000, v61
    v_lshlrev_b32 v76, 16, v62
    v_and_b32 v77, 0xffff0000, v62
    v_lshlrev_b32 v78, 16, v63
    v_and_b32 v79, 0xffff0000, v63
    v_lshlrev_b32 v80, 16, v234
    v_and_b32 v81, 0xffff0000, v234
    v_lshlrev_b32 v82, 16, v235
    v_and_b32 v83, 0xffff0000, v235
    v_lshlrev_b32 v84, 16, v236
    v_and_b32 v85, 0xffff0000, v236
    v_lshlrev_b32 v86, 16, v237
    v_and_b32 v87, 0xffff0000, v237
    v_lshlrev_b32 v88, 16, v16
    v_and_b32 v89, 0xffff0000, v16
    v_lshlrev_b32 v90, 16, v17
    v_and_b32 v91, 0xffff0000, v17
    v_lshlrev_b32 v92, 16, v18
    v_and_b32 v93, 0xffff0000, v18
    v_lshlrev_b32 v94, 16, v19
    v_and_b32 v95, 0xffff0000, v19
    s_mov_b32 s57, 1
    s_branch C3_w
C3_sr:
    s_mov_b64 exec, vcc
    buffer_load_dwordx4 v[56:59], v3, s[32:35], s69 offen offset:0 sc1
    buffer_load_dwordx4 v[60:63], v3, s[32:35], s69 offen offset:64 sc1
    buffer_load_dwordx4 v[234:237], v3, s[32:35], s70 offen offset:0 sc1
    buffer_load_dwordx4 v[16:19], v3, s[32:35], s70 offen offset:64 sc1
    s_mov_b64 exec, -1
    s_branch C3_w
C3_zr:
    s_sleep 1
    ds_read_b32 v23, v22
    ds_read2st64_b32 v[56:57], v13 offset0:0 offset1:4
    ds_read2st64_b32 v[58:59], v13 offset0:8 offset1:12
    ds_read2st64_b32 v[60:61], v13 offset0:32 offset1:36
    ds_read2st64_b32 v[62:63], v13 offset0:40 offset1:44
    ds_read2st64_b32 v[234:235], v11 offset0:44 offset1:40
    ds_read2st64_b32 v[236:237], v11 offset0:36 offset1:32
    ds_read2st64_b32 v[16:17], v11 offset0:12 offset1:8
    ds_read2st64_b32 v[18:19], v11 offset0:4 offset1:0
    s_sub_u32 s79, s79, 1
    s_cbranch_scc0 C3_z
    s_movk_i32 s78, 3
    s_branch K_bail
C2_early_xq:
    s_mov_b64 exec, 1
    ds_add_u32 v10, v9
    s_mov_b64 exec, -1
    s_branch C2_nobar_xq
C2_early_xr:
    s_cmp_lt_u32 s54, 2
    s_cbranch_scc0 C2_e2
    s_mov_b64 exec, 1
    ds_add_u32 v10, v9 offset:112
    s_mov_b64 exec, -1
    s_branch C2_nobar_xr
C2_e2:
    v_add_u32 v9, 138496, v8
    s_setprio 2
    ds_read_b128 v[24:27], v9 offset:0
    ds_read_b128 v[28:31], v9 offset:1024
    ds_read_b128 v[32:35], v9 offset:2048
    ds_read_b128 v[36:39], v9 offset:3072
    ds_read_b128 v[40:43], v9 offset:4096
    ds_read_b128 v[44:47], v9 offset:5120
    ds_read_b128 v[48:51], v9 offset:6144
    ds_read_b128 v[52:55], v9 offset:7168
    ds_read_b128 v[192:195], v9 offset:8192
    ds_read_b128 v[196:199], v9 offset:9216
    ds_read_b128 v[200:203], v9 offset:10240
    ds_read_b128 v[204:207], v9 offset:11264
    ds_read_b128 v[208:211], v9 offset:12288
    ds_read_b128 v[212:215], v9 offset:13312
    ds_read_b128 v[216:219], v9 offset:14336
    ds_read_b128 v[220:223], v9 offset:15360
    s_waitcnt lgkmcnt(0)
    s_branch C2_bar_xr
K_loader:
    s_sub_u32 s3, s3, 4
    s_setprio 0
    s_mov_b32 s28, s4
    s_and_b32 s29, s5, 0xffff
    s_mov_b32 s30, 0x400000
    s_mov_b32 s31, 0x20000
    s_mov_b32 s36, s12
    s_and_b32 s37, s13, 0xffff
    s_mov_b32 s38, 0x700000
    s_mov_b32 s39, 0x20000
    v_and_b32 v1, 63, v0
    v_lshrrev_b32 v2, 3, v1
    v_lshrrev_b32 v3, 4, v1
    v_and_b32 v4, 7, v1
    v_xor_b32 v4, v4, v3
    v_lshlrev_b32 v4, 4, v4
    v_lshl_add_u32 v240, v2, 11, v4
    v_xor_b32 v241, 64, v240
    v_add_u32 v241, 15360, v241
    v_add_u32 v242, 30720, v240
    v_add_u32 v243, 30720, v241
    s_mov_b32 s50, 2341
    s_mov_b32 s51, 7168
    v_add_u32 v2, 0, v1
    v_mul_u32_u24 v3, s50, v2
    v_lshrrev_b32 v3, 16, v3
    v_mul_u32_u24 v4, 28, v3
    v_sub_u32 v4, v2, v4
    v_lshrrev_b32 v5, 3, v3
    v_lshlrev_b32 v5, 1, v5
    v_xor_b32 v4, v4, v5
    v_lshlrev_b32 v4, 4, v4
    v_mad_u32_u24 v244, v3, s51, v4
    v_subrev_u32 v244, 0, v244
    v_add_u32 v2, 64, v1
    v_mul_u32_u24 v3, s50, v2
    v_lshrrev_b32 v3, 16, v3
    v_mul_u32_u24 v4, 28, v3
    v_sub_u32 v4, v2, v4
    v_lshrrev_b32 v5, 3, v3
    v_lshlrev_b32 v5, 1, v5
    v_xor_b32 v4, v4, v5
    v_lshlrev_b32 v4, 4, v4
    v_mad_u32_u24 v245, v3, s51, v4
    v_subrev_u32 v245, 1024, v245
    v_add_u32 v2, 128, v1
    v_mul_u32_u24 v3, s50, v2
    v_lshrrev_b32 v3, 16, v3
    v_mul_u32_u24 v4, 28, v3
    v_sub_u32 v4, v2, v4
    v_lshrrev_b32 v5, 3, v3
    v_lshlrev_b32 v5, 1, v5
    v_xor_b32 v4, v4, v5
    v_lshlrev_b32 v4, 4, v4
    v_mad_u32_u24 v246, v3, s51, v4
    v_subrev_u32 v246, 2048, v246
    v_add_u32 v2, 192, v1
    v_mul_u32_u24 v3, s50, v2
    v_lshrrev_b32 v3, 16, v3
    v_mul_u32_u24 v4, 28, v3
    v_sub_u32 v4, v2, v4
    v_lshrrev_b32 v5, 3, v3
    v_lshlrev_b32 v5, 1, v5
    v_xor_b32 v4, v4, v5
    v_lshlrev_b32 v4, 4, v4
    v_mad_u32_u24 v247, v3, s51, v4
    v_subrev_u32 v247, 3072, v247
    v_add_u32 v2, 256, v1
    v_mul_u32_u24 v3, s50, v2
    v_lshrrev_b32 v3, 16, v3
    v_mul_u32_u24 v4, 28, v3
    v_sub_u32 v4, v2, v4
    v_lshrrev_b32 v5, 3, v3
    v_lshlrev_b32 v5, 1, v5
    v_xor_b32 v4, v4, v5
    v_lshlrev_b32 v4, 4, v4
    v_mad_u32_u24 v248, v3, s51, v4
    v_subrev_u32 v248, 0, v248
    v_add_u32 v2, 320, v1
    v_mul_u32_u24 v3, s50, v2
    v_lshrrev_b32 v3, 16, v3
    v_mul_u32_u24 v4, 28, v3
    v_sub_u32 v4, v2, v4
    v_lshrrev_b32 v5, 3, v3
    v_lshlrev_b32 v5, 1, v5
    v_xor_b32 v4, v4, v5
    v_lshlrev_b32 v4, 4, v4
    v_mad_u32_u24 v249, v3, s51, v4
    v_subrev_u32 v249, 1024, v249
    v_add_u32 v2, 384, v1
    v_mul_u32_u24 v3, s50, v2
    v_lshrrev_b32 v3, 16, v3
    v_mul_u32_u24 v4, 28, v3
    v_sub_u32 v4, v2, v4
    v_lshrrev_b32 v5, 3, v3
    v_lshlrev_b32 v5, 1, v5
    v_xor_b32 v4, v4, v5
    v_lshlrev_b32 v4, 4, v4
    v_mad_u32_u24 v250, v3, s51, v4
    v_subrev_u32 v250, 2048, v250
    s_lshl_b32 s52, s60, 18
    s_lshl_b32 s50, s3, 17
    s_add_u32 s52, s52, s50
    s_mul_i32 s53, s61, 448
    s_mul_i32 s50, s3, 32*7168
    s_add_u32 s53, s53, s50
    s_lshl_b32 s54, s3, 13
    s_mul_i32 s55, s3, 14336
    s_add_u32 s55, s55, 16384
    v_lshlrev_b32 v251, 4, v1
    s_add_u32 m0, s54, 0
    s_add_u32 s57, s52, 65536
    buffer_load_dwordx4 v240, s[28:31], s52 offen offset:0 lds
    buffer_load_dwordx4 v241, s[28:31], s52 offen offset:1024 lds
    buffer_load_dwordx4 v242, s[28:31], s52 offen offset:2048 lds
    buffer_load_dwordx4 v243, s[28:31], s52 offen offset:3072 lds
    s_add_u32 m0, m0, 4096
    s_nop 0
    buffer_load_dwordx4 v240, s[28:31], s57 offen offset:0 lds
    buffer_load_dwordx4 v241, s[28:31], s57 offen offset:1024 lds
    buffer_load_dwordx4 v242, s[28:31], s57 offen offset:2048 lds
    buffer_load_dwordx4 v243, s[28:31], s57 offen offset:3072 lds
    s_add_u32 m0, s55, 0
    s_add_u32 s57, s53, 114688
    buffer_load_dwordx4 v244, s[36:39], s53 offen offset:0 lds
    buffer_load_dwordx4 v245, s[36:39], s53 offen offset:1024 lds
    buffer_load_dwordx4 v246, s[36:39], s53 offen offset:2048 lds
    buffer_load_dwordx4 v247, s[36:39], s53 offen offset:3072 lds
    s_add_u32 m0, m0, 4096
    s_nop 0
    buffer_load_dwordx4 v248, s[36:39], s53 offen offset:0 lds
    buffer_load_dwordx4 v249, s[36:39], s53 offen offset:1024 lds
    buffer_load_dwordx4 v250, s[36:39], s53 offen offset:2048 lds
    s_add_u32 m0, m0, 3072
    s_nop 0
    buffer_load_dwordx4 v244, s[36:39], s57 offen offset:0 lds
    buffer_load_dwordx4 v245, s[36:39], s57 offen offset:1024 lds
    buffer_load_dwordx4 v246, s[36:39], s57 offen offset:2048 lds
    buffer_load_dwordx4 v247, s[36:39], s57 offen offset:3072 lds
    s_add_u32 m0, m0, 4096
    s_nop 0
    buffer_load_dwordx4 v248, s[36:39], s57 offen offset:0 lds
    buffer_load_dwordx4 v249, s[36:39], s57 offen offset:1024 lds
    buffer_load_dwordx4 v250, s[36:39], s57 offen offset:2048 lds
    s_add_u32 s52, s52, 128
    s_add_u32 s53, s53, 458752
    s_add_u32 m0, s54, 45056
    s_add_u32 s57, s52, 65536
    buffer_load_dwordx4 v240, s[28:31], s52 offen offset:0 lds
    buffer_load_dwordx4 v241, s[28:31], s52 offen offset:1024 lds
    buffer_load_dwordx4 v242, s[28:31], s52 offen offset:2048 lds
    buffer_load_dwordx4 v243, s[28:31], s52 offen offset:3072 lds
    s_add_u32 m0, m0, 4096
    s_nop 0
    buffer_load_dwordx4 v240, s[28:31], s57 offen offset:0 lds
    buffer_load_dwordx4 v241, s[28:31], s57 offen offset:1024 lds
    buffer_load_dwordx4 v242, s[28:31], s57 offen offset:2048 lds
    buffer_load_dwordx4 v243, s[28:31], s57 offen offset:3072 lds
    s_add_u32 m0, s55, 45056
    s_add_u32 s57, s53, 114688
    buffer_load_dwordx4 v244, s[36:39], s53 offen offset:0 lds
    buffer_load_dwordx4 v245, s[36:39], s53 offen offset:1024 lds
    buffer_load_dwordx4 v246, s[36:39], s53 offen offset:2048 lds
    buffer_load_dwordx4 v247, s[36:39], s53 offen offset:3072 lds
    s_add_u32 m0, m0, 4096
    s_nop 0
    buffer_load_dwordx4 v248, s[36:39], s53 offen offset:0 lds
    buffer_load_dwordx4 v249, s[36:39], s53 offen offset:1024 lds
    buffer_load_dwordx4 v250, s[36:39], s53 offen offset:2048 lds
    s_add_u32 m0, m0, 3072
    s_nop 0
    buffer_load_dwordx4 v244, s[36:39], s57 offen offset:0 lds
    buffer_load_dwordx4 v245, s[36:39], s57 offen offset:1024 lds
    buffer_load_dwordx4 v246, s[36:39], s57 offen offset:2048 lds
    buffer_load_dwordx4 v247, s[36:39], s57 offen offset:3072 lds
    s_add_u32 m0, m0, 4096
    s_nop 0
    buffer_load_dwordx4 v248, s[36:39], s57 offen offset:0 lds
    buffer_load_dwordx4 v249, s[36:39], s57 offen offset:1024 lds
    buffer_load_dwordx4 v250, s[36:39], s57 offen offset:2048 lds
    s_add_u32 s52, s52, 128
    s_add_u32 s53, s53, 458752
    v_and_b32 v2, 15, v1
    v_lshrrev_b32 v3, 4, v1
    s_mov_b32 s50, 7168
    v_lshlrev_b32 v4, 4, v2
    v_mad_u32_u24 v252, v3, s50, v4
    v_cmp_gt_u32 vcc, 14, v2
    v_mov_b32 v4, 0x7ff00000
    s_mul_i32 s65, s60, 32*7168
    v_cndmask_b32 v252, v4, v252, vcc
    s_mul_i32 s51, s61, 448
    s_add_u32 s65, s65, s51
    s_mul_i32 s51, s3, 224
    s_add_u32 s65, s65, s51
    buffer_load_dwordx4 v[80:83], v252, s[36:39], s65 offen
    s_add_u32 s65, s65, 28672
    buffer_load_dwordx4 v[84:87], v252, s[36:39], s65 offen
    s_add_u32 s65, s65, 28672
    buffer_load_dwordx4 v[88:91], v252, s[36:39], s65 offen
    s_add_u32 s65, s65, 28672
    buffer_load_dwordx4 v[92:95], v252, s[36:39], s65 offen
    s_add_u32 s65, s65, 28672
    buffer_load_dwordx4 v[96:99], v252, s[36:39], s65 offen
    s_add_u32 s65, s65, 28672
    buffer_load_dwordx4 v[100:103], v252, s[36:39], s65 offen
    s_add_u32 s65, s65, 28672
    buffer_load_dwordx4 v[104:107], v252, s[36:39], s65 offen
    s_add_u32 s65, s65, 28672
    buffer_load_dwordx4 v[108:111], v252, s[36:39], s65 offen
    s_add_u32 s65, s65, 3469312
    s_setprio 3
    s_mov_b32 s32, s24
    s_and_b32 s33, s25, 0xffff
    s_mov_b32 s34, 0x10000000
    s_mov_b32 s35, 0x20000
    s_mov_b32 s44, s16
    s_and_b32 s45, s17, 0xffff
    s_mov_b32 s46, 0x700000
    s_mov_b32 s47, 0x20000
    s_mov_b32 s40, s22
    s_and_b32 s41, s23, 0xffff
    s_mov_b32 s42, 0x100
    s_mov_b32 s43, 0x20000
    v_lshlrev_b32 v2, 2, v1
    v_mov_b32 v3, 0
    v_add_u32 v2, 155904, v2
    s_mov_b64 exec, 0xffff
    ds_write_b32 v2, v3
    ds_write_b32 v2, v3 offset:128
    s_mov_b64 exec, -1
    s_mul_i32 s48, s2, 28672
    s_mul_i32 s50, s3, 0
    s_add_u32 s48, s48, s50
    s_add_u32 s48, s16, s48
    s_addc_u32 s49, s17, 0
    s_lshl_b32 s77, s2, 1
    s_add_u32 s77, s77, s3
    s_cmp_lg_u32 s77, 3
    s_cbranch_scc1 L_nc
    v_and_b32 v1, 31, v0
    v_bfe_u32 v2, v0, 5, 1
    v_lshlrev_b32 v4, 2, v2
    v_mul_u32_u24 v4, v4, v1
    v_mad_u32_u24 v6, v1, 0, v4
    v_cvt_f32_u32 v6, v6
    v_mul_f32 v7, 0x3d000000, v6
    v_mul_f32 v6, 0x3a800000, v6
    v_fract_f32 v7, v7
    v_cos_f32 v8, v7
    v_sin_f32 v9, v7
    v_cos_f32 v48, v6
    v_sin_f32 v49, v6
    v_cvt_pk_bf16_f32 v16, v8, v9
    v_cvt_pk_bf16_f32 v32, -v9, v8
    v_mad_u32_u24 v10, v1, 1, v4
    v_cvt_f32_u32 v10, v10
    v_mul_f32 v11, 0x3d000000, v10
    v_mul_f32 v10, 0x3a800000, v10
    v_fract_f32 v11, v11
    v_cos_f32 v12, v11
    v_sin_f32 v13, v11
    v_cos_f32 v50, v10
    v_sin_f32 v51, v10
    v_cvt_pk_bf16_f32 v17, v12, v13
    v_cvt_pk_bf16_f32 v33, -v13, v12
    v_mad_u32_u24 v6, v1, 2, v4
    v_cvt_f32_u32 v6, v6
    v_mul_f32 v7, 0x3d000000, v6
    v_mul_f32 v6, 0x3a800000, v6
    v_fract_f32 v7, v7
    v_cos_f32 v8, v7
    v_sin_f32 v9, v7
    v_cos_f32 v52, v6
    v_sin_f32 v53, v6
    v_cvt_pk_bf16_f32 v18, v8, v9
    v_cvt_pk_bf16_f32 v34, -v9, v8
    v_mad_u32_u24 v10, v1, 3, v4
    v_cvt_f32_u32 v10, v10
    v_mul_f32 v11, 0x3d000000, v10
    v_mul_f32 v10, 0x3a800000, v10
    v_fract_f32 v11, v11
    v_cos_f32 v12, v11
    v_sin_f32 v13, v11
    v_cos_f32 v54, v10
    v_sin_f32 v55, v10
    v_cvt_pk_bf16_f32 v19, v12, v13
    v_cvt_pk_bf16_f32 v35, -v13, v12
    v_mad_u32_u24 v6, v1, 8, v4
    v_cvt_f32_u32 v6, v6
    v_mul_f32 v7, 0x3d000000, v6
    v_mul_f32 v6, 0x3a800000, v6
    v_fract_f32 v7, v7
    v_cos_f32 v8, v7
    v_sin_f32 v9, v7
    v_cos_f32 v56, v6
    v_sin_f32 v57, v6
    v_cvt_pk_bf16_f32 v20, v8, v9
    v_cvt_pk_bf16_f32 v36, -v9, v8
    v_mad_u32_u24 v10, v1, 9, v4
    v_cvt_f32_u32 v10, v10
    v_mul_f32 v11, 0x3d000000, v10
    v_mul_f32 v10, 0x3a800000, v10
    v_fract_f32 v11, v11
    v_cos_f32 v12, v11
    v_sin_f32 v13, v11
    v_cos_f32 v58, v10
    v_sin_f32 v59, v10
    v_cvt_pk_bf16_f32 v21, v12, v13
    v_cvt_pk_bf16_f32 v37, -v13, v12
    v_mad_u32_u24 v6, v1, 10, v4
    v_cvt_f32_u32 v6, v6
    v_mul_f32 v7, 0x3d000000, v6
    v_mul_f32 v6, 0x3a800000, v6
    v_fract_f32 v7, v7
    v_cos_f32 v8, v7
    v_sin_f32 v9, v7
    v_cos_f32 v60, v6
    v_sin_f32 v61, v6
    v_cvt_pk_bf16_f32 v22, v8, v9
    v_cvt_pk_bf16_f32 v38, -v9, v8
    v_mad_u32_u24 v10, v1, 11, v4
    v_cvt_f32_u32 v10, v10
    v_mul_f32 v11, 0x3d000000, v10
    v_mul_f32 v10, 0x3a800000, v10
    v_fract_f32 v11, v11
    v_cos_f32 v12, v11
    v_sin_f32 v13, v11
    v_cos_f32 v62, v10
    v_sin_f32 v63, v10
    v_cvt_pk_bf16_f32 v23, v12, v13
    v_cvt_pk_bf16_f32 v39, -v13, v12
    v_mad_u32_u24 v6, v1, 16, v4
    v_cvt_f32_u32 v6, v6
    v_mul_f32 v7, 0x3d000000, v6
    v_mul_f32 v6, 0x3a800000, v6
    v_fract_f32 v7, v7
    v_cos_f32 v8, v7
    v_sin_f32 v9, v7
    v_cos_f32 v64, v6
    v_sin_f32 v65, v6
    v_cvt_pk_bf16_f32 v24, v8, v9
    v_cvt_pk_bf16_f32 v40, -v9, v8
    v_mad_u32_u24 v10, v1, 17, v4
    v_cvt_f32_u32 v10, v10
    v_mul_f32 v11, 0x3d000000, v10
    v_mul_f32 v10, 0x3a800000, v10
    v_fract_f32 v11, v11
    v_cos_f32 v12, v11
    v_sin_f32 v13, v11
    v_cos_f32 v66, v10
    v_sin_f32 v67, v10
    v_cvt_pk_bf16_f32 v25, v12, v13
    v_cvt_pk_bf16_f32 v41, -v13, v12
    v_mad_u32_u24 v6, v1, 18, v4
    v_cvt_f32_u32 v6, v6
    v_mul_f32 v7, 0x3d000000, v6
    v_mul_f32 v6, 0x3a800000, v6
    v_fract_f32 v7, v7
    v_cos_f32 v8, v7
    v_sin_f32 v9, v7
    v_cos_f32 v68, v6
    v_sin_f32 v69, v6
    v_cvt_pk_bf16_f32 v26, v8, v9
    v_cvt_pk_bf16_f32 v42, -v9, v8
    v_mad_u32_u24 v10, v1, 19, v4
    v_cvt_f32_u32 v10, v10
    v_mul_f32 v11, 0x3d000000, v10
    v_mul_f32 v10, 0x3a800000, v10
    v_fract_f32 v11, v11
    v_cos_f32 v12, v11
    v_sin_f32 v13, v11
    v_cos_f32 v70, v10
    v_sin_f32 v71, v10
    v_cvt_pk_bf16_f32 v27, v12, v13
    v_cvt_pk_bf16_f32 v43, -v13, v12
    v_mad_u32_u24 v6, v1, 24, v4
    v_cvt_f32_u32 v6, v6
    v_mul_f32 v7, 0x3d000000, v6
    v_mul_f32 v6, 0x3a800000, v6
    v_fract_f32 v7, v7
    v_cos_f32 v8, v7
    v_sin_f32 v9, v7
    v_cos_f32 v72, v6
    v_sin_f32 v73, v6
    v_cvt_pk_bf16_f32 v28, v8, v9
    v_cvt_pk_bf16_f32 v44, -v9, v8
    v_mad_u32_u24 v10, v1, 25, v4
    v_cvt_f32_u32 v10, v10
    v_mul_f32 v11, 0x3d000000, v10
    v_mul_f32 v10, 0x3a800000, v10
    v_fract_f32 v11, v11
    v_cos_f32 v12, v11
    v_sin_f32 v13, v11
    v_cos_f32 v74, v10
    v_sin_f32 v75, v10
    v_cvt_pk_bf16_f32 v29, v12, v13
    v_cvt_pk_bf16_f32 v45, -v13, v12
    v_mad_u32_u24 v6, v1, 26, v4
    v_cvt_f32_u32 v6, v6
    v_mul_f32 v7, 0x3d000000, v6
    v_mul_f32 v6, 0x3a800000, v6
    v_fract_f32 v7, v7
    v_cos_f32 v8, v7
    v_sin_f32 v9, v7
    v_cos_f32 v76, v6
    v_sin_f32 v77, v6
    v_cvt_pk_bf16_f32 v30, v8, v9
    v_cvt_pk_bf16_f32 v46, -v9, v8
    v_mad_u32_u24 v10, v1, 27, v4
    v_cvt_f32_u32 v10, v10
    v_mul_f32 v11, 0x3d000000, v10
    v_mul_f32 v10, 0x3a800000, v10
    v_fract_f32 v11, v11
    v_cos_f32 v12, v11
    v_sin_f32 v13, v11
    v_cos_f32 v78, v10
    v_sin_f32 v79, v10
    v_cvt_pk_bf16_f32 v31, v12, v13
    v_cvt_pk_bf16_f32 v47, -v13, v12
    v_lshl_add_u32 v5, v2, 7, v1
    v_cvt_f32_u32 v5, v5
    v_mul_f32 v5, 0x3a000000, v5
    v_add_f32 v6, 0x0, v5
    v_cos_f32 v208, v6
    v_sin_f32 v209, v6
    v_add_f32 v7, 0x3c800000, v5
    v_cos_f32 v210, v7
    v_sin_f32 v211, v7
    v_add_f32 v8, 0x3d000000, v5
    v_cos_f32 v212, v8
    v_sin_f32 v213, v8
    v_add_f32 v9, 0x3d400000, v5
    v_cos_f32 v214, v9
    v_sin_f32 v215, v9
    v_add_f32 v6, 0x3e000000, v5
    v_cos_f32 v216, v6
    v_sin_f32 v217, v6
    v_add_f32 v7, 0x3e100000, v5
    v_cos_f32 v218, v7
    v_sin_f32 v219, v7
    v_add_f32 v8, 0x3e200000, v5
    v_cos_f32 v220, v8
    v_sin_f32 v221, v8
    v_add_f32 v9, 0x3e300000, v5
    v_cos_f32 v222, v9
    v_sin_f32 v223, v9
    v_add_f32 v6, 0x3e800000, v5
    v_cos_f32 v224, v6
    v_sin_f32 v225, v6
    v_add_f32 v7, 0x3e880000, v5
    v_cos_f32 v226, v7
    v_sin_f32 v227, v7
    v_add_f32 v8, 0x3e900000, v5
    v_cos_f32 v228, v8
    v_sin_f32 v229, v8
    v_add_f32 v9, 0x3e980000, v5
    v_cos_f32 v230, v9
    v_sin_f32 v231, v9
    v_add_f32 v6, 0x3ec00000, v5
    v_cos_f32 v232, v6
    v_sin_f32 v233, v6
    v_add_f32 v7, 0x3ec80000, v5
    v_cos_f32 v234, v7
    v_sin_f32 v235, v7
    v_add_f32 v8, 0x3ed00000, v5
    v_cos_f32 v236, v8
    v_sin_f32 v237, v8
    v_add_f32 v9, 0x3ed80000, v5
    v_cos_f32 v238, v9
    v_sin_f32 v239, v9
    v_and_b32 v1, 63, v0
L_nc:
    s_waitcnt lgkmcnt(0)
    s_waitcnt vmcnt(30)
    s_barrier
    v_mov_b32 v2, 155920
L_yr:
    ds_read_b32 v3, v2
    s_waitcnt lgkmcnt(0)
    v_readfirstlane_b32 s50, v3
    s_nop 0
    s_cmp_ge_u32 s50, 2
    s_cbranch_scc1 L_yr_ok
    s_sub_u32 s79, s79, 1
    s_cbranch_scc0 L_yr
    s_movk_i32 s78, 5
    s_branch K_bail
L_yr_ok:
    s_add_u32 m0, s54, 90112
    s_add_u32 s57, s52, 65536
    buffer_load_dwordx4 v240, s[28:31], s52 offen offset:0 lds
    buffer_load_dwordx4 v241, s[28:31], s52 offen offset:1024 lds
    buffer_load_dwordx4 v242, s[28:31], s52 offen offset:2048 lds
    buffer_load_dwordx4 v243, s[28:31], s52 offen offset:3072 lds
    s_add_u32 m0, m0, 4096
    s_nop 0
    buffer_load_dwordx4 v240, s[28:31], s57 offen offset:0 lds
    buffer_load_dwordx4 v241, s[28:31], s57 offen offset:1024 lds
    buffer_load_dwordx4 v242, s[28:31], s57 offen offset:2048 lds
    buffer_load_dwordx4 v243, s[28:31], s57 offen offset:3072 lds
    s_add_u32 m0, s55, 90112
    s_add_u32 s57, s53, 114688
    buffer_load_dwordx4 v244, s[36:39], s53 offen offset:0 lds
    buffer_load_dwordx4 v245, s[36:39], s53 offen offset:1024 lds
    buffer_load_dwordx4 v246, s[36:39], s53 offen offset:2048 lds
    buffer_load_dwordx4 v247, s[36:39], s53 offen offset:3072 lds
    s_add_u32 m0, m0, 4096
    s_nop 0
    buffer_load_dwordx4 v248, s[36:39], s53 offen offset:0 lds
    buffer_load_dwordx4 v249, s[36:39], s53 offen offset:1024 lds
    buffer_load_dwordx4 v250, s[36:39], s53 offen offset:2048 lds
    s_add_u32 m0, m0, 3072
    s_nop 0
    buffer_load_dwordx4 v244, s[36:39], s57 offen offset:0 lds
    buffer_load_dwordx4 v245, s[36:39], s57 offen offset:1024 lds
    buffer_load_dwordx4 v246, s[36:39], s57 offen offset:2048 lds
    buffer_load_dwordx4 v247, s[36:39], s57 offen offset:3072 lds
    s_add_u32 m0, m0, 4096
    s_nop 0
    buffer_load_dwordx4 v248, s[36:39], s57 offen offset:0 lds
    buffer_load_dwordx4 v249, s[36:39], s57 offen offset:1024 lds
    buffer_load_dwordx4 v250, s[36:39], s57 offen offset:2048 lds
    s_add_u32 s52, s52, 128
    s_add_u32 s53, s53, 458752
    buffer_load_dwordx4 v[112:115], v252, s[36:39], s65 offen
    s_add_u32 s65, s65, 28672
    buffer_load_dwordx4 v[116:119], v252, s[36:39], s65 offen
    s_add_u32 s65, s65, 28672
    buffer_load_dwordx4 v[120:123], v252, s[36:39], s65 offen
    s_add_u32 s65, s65, 28672
    buffer_load_dwordx4 v[124:127], v252, s[36:39], s65 offen
    s_add_u32 s65, s65, 28672
    buffer_load_dwordx4 v[128:131], v252, s[36:39], s65 offen
    s_add_u32 s65, s65, 28672
    buffer_load_dwordx4 v[132:135], v252, s[36:39], s65 offen
    s_add_u32 s65, s65, 28672
    buffer_load_dwordx4 v[136:139], v252, s[36:39], s65 offen
    s_add_u32 s65, s65, 28672
    buffer_load_dwordx4 v[140:143], v252, s[36:39], s65 offen
    s_add_u32 s65, s65, 28672
    s_waitcnt vmcnt(38)
    s_barrier
    s_waitcnt vmcnt(34)
    s_add_u32 m0, s54, 0
    s_add_u32 s57, s52, 65536
    v_lshlrev_b32 v144, 16, v80
    v_and_b32 v145, 0xffff0000, v80
    buffer_load_dwordx4 v240, s[28:31], s52 offen offset:0 lds
    v_lshlrev_b32 v146, 16, v81
    v_and_b32 v147, 0xffff0000, v81
    buffer_load_dwordx4 v241, s[28:31], s52 offen offset:1024 lds
    v_lshlrev_b32 v148, 16, v82
    v_and_b32 v149, 0xffff0000, v82
    v_lshlrev_b32 v150, 16, v83
    buffer_load_dwordx4 v242, s[28:31], s52 offen offset:2048 lds
    v_and_b32 v151, 0xffff0000, v83
    v_lshlrev_b32 v152, 16, v84
    buffer_load_dwordx4 v243, s[28:31], s52 offen offset:3072 lds
    s_add_u32 m0, m0, 4096
    s_nop 0
    v_and_b32 v153, 0xffff0000, v84
    v_add_f32 v144, v144, v152
    v_add_f32 v145, v145, v153
    buffer_load_dwordx4 v240, s[28:31], s57 offen offset:0 lds
    v_lshlrev_b32 v154, 16, v85
    v_and_b32 v155, 0xffff0000, v85
    buffer_load_dwordx4 v241, s[28:31], s57 offen offset:1024 lds
    v_add_f32 v146, v146, v154
    v_add_f32 v147, v147, v155
    v_lshlrev_b32 v152, 16, v86
    buffer_load_dwordx4 v242, s[28:31], s57 offen offset:2048 lds
    v_and_b32 v153, 0xffff0000, v86
    v_add_f32 v148, v148, v152
    buffer_load_dwordx4 v243, s[28:31], s57 offen offset:3072 lds
    s_add_u32 m0, s55, 0
    s_add_u32 s57, s53, 114688
    v_add_f32 v149, v149, v153
    v_lshlrev_b32 v154, 16, v87
    buffer_load_dwordx4 v244, s[36:39], s53 offen offset:0 lds
    v_and_b32 v155, 0xffff0000, v87
    v_add_f32 v150, v150, v154
    v_add_f32 v151, v151, v155
    buffer_load_dwordx4 v245, s[36:39], s53 offen offset:1024 lds
    v_lshlrev_b32 v152, 16, v88
    v_and_b32 v153, 0xffff0000, v88
    buffer_load_dwordx4 v246, s[36:39], s53 offen offset:2048 lds
    v_add_f32 v144, v144, v152
    v_add_f32 v145, v145, v153
    v_lshlrev_b32 v154, 16, v89
    buffer_load_dwordx4 v247, s[36:39], s53 offen offset:3072 lds
    s_add_u32 m0, m0, 4096
    s_nop 0
    v_and_b32 v155, 0xffff0000, v89
    v_add_f32 v146, v146, v154
    buffer_load_dwordx4 v248, s[36:39], s53 offen offset:0 lds
    v_add_f32 v147, v147, v155
    v_lshlrev_b32 v152, 16, v90
    v_and_b32 v153, 0xffff0000, v90
    buffer_load_dwordx4 v249, s[36:39], s53 offen offset:1024 lds
    v_add_f32 v148, v148, v152
    v_add_f32 v149, v149, v153
    buffer_load_dwordx4 v250, s[36:39], s53 offen offset:2048 lds
    s_add_u32 m0, m0, 3072
    s_nop 0
    v_lshlrev_b32 v154, 16, v91
    v_and_b32 v155, 0xffff0000, v91
    buffer_load_dwordx4 v244, s[36:39], s57 offen offset:0 lds
    v_add_f32 v150, v150, v154
    v_add_f32 v151, v151, v155
    v_lshlrev_b32 v152, 16, v92
    buffer_load_dwordx4 v245, s[36:39], s57 offen offset:1024 lds
    v_and_b32 v153, 0xffff0000, v92
    v_add_f32 v144, v144, v152
    buffer_load_dwordx4 v246, s[36:39], s57 offen offset:2048 lds
    v_add_f32 v145, v145, v153
    v_lshlrev_b32 v154, 16, v93
    v_and_b32 v155, 0xffff0000, v93
    buffer_load_dwordx4 v247, s[36:39], s57 offen offset:3072 lds
    s_add_u32 m0, m0, 4096
    s_nop 0
    v_add_f32 v146, v146, v154
    v_add_f32 v147, v147, v155
    buffer_load_dwordx4 v248, s[36:39], s57 offen offset:0 lds
    v_lshlrev_b32 v152, 16, v94
    v_and_b32 v153, 0xffff0000, v94
    v_add_f32 v148, v148, v152
    buffer_load_dwordx4 v249, s[36:39], s57 offen offset:1024 lds
    v_add_f32 v149, v149, v153
    v_lshlrev_b32 v154, 16, v95
    buffer_load_dwordx4 v250, s[36:39], s57 offen offset:2048 lds
    s_add_u32 s52, s52, 128
    s_add_u32 s53, s53, 458752
    v_and_b32 v155, 0xffff0000, v95
    v_add_f32 v150, v150, v154
    v_add_f32 v151, v151, v155
    s_waitcnt vmcnt(30)
    s_barrier
    s_waitcnt vmcnt(52)
    s_add_u32 m0, s54, 45056
    s_add_u32 s57, s52, 65536
    v_lshlrev_b32 v152, 16, v96
    v_and_b32 v153, 0xffff0000, v96
    buffer_load_dwordx4 v240, s[28:31], s52 offen offset:0 lds
    v_add_f32 v144, v144, v152
    v_add_f32 v145, v145, v153
    v_lshlrev_b32 v154, 16, v97
    buffer_load_dwordx4 v241, s[28:31], s52 offen offset:1024 lds
    v_and_b32 v155, 0xffff0000, v97
    v_add_f32 v146, v146, v154
    v_add_f32 v147, v147, v155
    buffer_load_dwordx4 v242, s[28:31], s52 offen offset:2048 lds
    v_lshlrev_b32 v152, 16, v98
    v_and_b32 v153, 0xffff0000, v98
    v_add_f32 v148, v148, v152
    buffer_load_dwordx4 v243, s[28:31], s52 offen offset:3072 lds
    s_add_u32 m0, m0, 4096
    s_nop 0
    v_add_f32 v149, v149, v153
    v_lshlrev_b32 v154, 16, v99
    buffer_load_dwordx4 v240, s[28:31], s57 offen offset:0 lds
    v_and_b32 v155, 0xffff0000, v99
    v_add_f32 v150, v150, v154
    v_add_f32 v151, v151, v155
    buffer_load_dwordx4 v241, s[28:31], s57 offen offset:1024 lds
    v_lshlrev_b32 v152, 16, v100
    v_and_b32 v153, 0xffff0000, v100
    v_add_f32 v144, v144, v152
    buffer_load_dwordx4 v242, s[28:31], s57 offen offset:2048 lds
    v_add_f32 v145, v145, v153
    v_lshlrev_b32 v154, 16, v101
    v_and_b32 v155, 0xffff0000, v101
    buffer_load_dwordx4 v243, s[28:31], s57 offen offset:3072 lds
    s_add_u32 m0, s55, 45056
    s_add_u32 s57, s53, 114688
    v_add_f32 v146, v146, v154
    v_add_f32 v147, v147, v155
    v_lshlrev_b32 v152, 16, v102
    buffer_load_dwordx4 v244, s[36:39], s53 offen offset:0 lds
    v_and_b32 v153, 0xffff0000, v102
    v_add_f32 v148, v148, v152
    buffer_load_dwordx4 v245, s[36:39], s53 offen offset:1024 lds
    v_add_f32 v149, v149, v153
    v_lshlrev_b32 v154, 16, v103
    v_and_b32 v155, 0xffff0000, v103
    buffer_load_dwordx4 v246, s[36:39], s53 offen offset:2048 lds
    v_add_f32 v150, v150, v154
    v_add_f32 v151, v151, v155
    v_lshlrev_b32 v152, 16, v104
    buffer_load_dwordx4 v247, s[36:39], s53 offen offset:3072 lds
    s_add_u32 m0, m0, 4096
    s_nop 0
    v_and_b32 v153, 0xffff0000, v104
    v_add_f32 v144, v144, v152
    v_add_f32 v145, v145, v153
    buffer_load_dwordx4 v248, s[36:39], s53 offen offset:0 lds
    v_lshlrev_b32 v154, 16, v105
    v_and_b32 v155, 0xffff0000, v105
    buffer_load_dwordx4 v249, s[36:39], s53 offen offset:1024 lds
    v_add_f32 v146, v146, v154
    v_add_f32 v147, v147, v155
    v_lshlrev_b32 v152, 16, v106
    buffer_load_dwordx4 v250, s[36:39], s53 offen offset:2048 lds
    s_add_u32 m0, m0, 3072
    s_nop 0
    v_and_b32 v153, 0xffff0000, v106
    v_add_f32 v148, v148, v152
    v_add_f32 v149, v149, v153
    buffer_load_dwordx4 v244, s[36:39], s57 offen offset:0 lds
    v_lshlrev_b32 v154, 16, v107
    v_and_b32 v155, 0xffff0000, v107
    v_add_f32 v150, v150, v154
    buffer_load_dwordx4 v245, s[36:39], s57 offen offset:1024 lds
    v_add_f32 v151, v151, v155
    v_lshlrev_b32 v152, 16, v108
    v_and_b32 v153, 0xffff0000, v108
    buffer_load_dwordx4 v246, s[36:39], s57 offen offset:2048 lds
    v_add_f32 v144, v144, v152
    v_add_f32 v145, v145, v153
    buffer_load_dwordx4 v247, s[36:39], s57 offen offset:3072 lds
    s_add_u32 m0, m0, 4096
    s_nop 0
    v_lshlrev_b32 v154, 16, v109
    v_and_b32 v155, 0xffff0000, v109
    v_add_f32 v146, v146, v154
    buffer_load_dwordx4 v248, s[36:39], s57 offen offset:0 lds
    v_add_f32 v147, v147, v155
    v_lshlrev_b32 v152, 16, v110
    v_and_b32 v153, 0xffff0000, v110
    buffer_load_dwordx4 v249, s[36:39], s57 offen offset:1024 lds
    v_add_f32 v148, v148, v152
    v_add_f32 v149, v149, v153
    v_lshlrev_b32 v154, 16, v111
    buffer_load_dwordx4 v250, s[36:39], s57 offen offset:2048 lds
    s_add_u32 s52, s52, 128
    s_add_u32 s53, s53, 458752
    v_and_b32 v155, 0xffff0000, v111
    v_add_f32 v150, v150, v154
    v_add_f32 v151, v151, v155
    s_waitcnt vmcnt(22)
    s_barrier
    s_waitcnt vmcnt(48)
    s_add_u32 m0, s54, 90112
    s_add_u32 s57, s52, 65536
    v_lshlrev_b32 v152, 16, v112
    v_and_b32 v153, 0xffff0000, v112
    buffer_load_dwordx4 v240, s[28:31], s52 offen offset:0 lds
    v_add_f32 v144, v144, v152
    v_add_f32 v145, v145, v153
    v_lshlrev_b32 v154, 16, v113
    buffer_load_dwordx4 v241, s[28:31], s52 offen offset:1024 lds
    v_and_b32 v155, 0xffff0000, v113
    v_add_f32 v146, v146, v154
    v_add_f32 v147, v147, v155
    buffer_load_dwordx4 v242, s[28:31], s52 offen offset:2048 lds
    v_lshlrev_b32 v152, 16, v114
    v_and_b32 v153, 0xffff0000, v114
    v_add_f32 v148, v148, v152
    buffer_load_dwordx4 v243, s[28:31], s52 offen offset:3072 lds
    s_add_u32 m0, m0, 4096
    s_nop 0
    v_add_f32 v149, v149, v153
    v_lshlrev_b32 v154, 16, v115
    buffer_load_dwordx4 v240, s[28:31], s57 offen offset:0 lds
    v_and_b32 v155, 0xffff0000, v115
    v_add_f32 v150, v150, v154
    v_add_f32 v151, v151, v155
    buffer_load_dwordx4 v241, s[28:31], s57 offen offset:1024 lds
    v_lshlrev_b32 v152, 16, v116
    v_and_b32 v153, 0xffff0000, v116
    v_add_f32 v144, v144, v152
    buffer_load_dwordx4 v242, s[28:31], s57 offen offset:2048 lds
    v_add_f32 v145, v145, v153
    v_lshlrev_b32 v154, 16, v117
    v_and_b32 v155, 0xffff0000, v117
    buffer_load_dwordx4 v243, s[28:31], s57 offen offset:3072 lds
    s_add_u32 m0, s55, 90112
    s_add_u32 s57, s53, 114688
    v_add_f32 v146, v146, v154
    v_add_f32 v147, v147, v155
    v_lshlrev_b32 v152, 16, v118
    buffer_load_dwordx4 v244, s[36:39], s53 offen offset:0 lds
    v_and_b32 v153, 0xffff0000, v118
    v_add_f32 v148, v148, v152
    buffer_load_dwordx4 v245, s[36:39], s53 offen offset:1024 lds
    v_add_f32 v149, v149, v153
    v_lshlrev_b32 v154, 16, v119
    v_and_b32 v155, 0xffff0000, v119
    buffer_load_dwordx4 v246, s[36:39], s53 offen offset:2048 lds
    v_add_f32 v150, v150, v154
    v_add_f32 v151, v151, v155
    v_lshlrev_b32 v152, 16, v120
    buffer_load_dwordx4 v247, s[36:39], s53 offen offset:3072 lds
    s_add_u32 m0, m0, 4096
    s_nop 0
    v_and_b32 v153, 0xffff0000, v120
    v_add_f32 v144, v144, v152
    v_add_f32 v145, v145, v153
    buffer_load_dwordx4 v248, s[36:39], s53 offen offset:0 lds
    v_lshlrev_b32 v154, 16, v121
    v_and_b32 v155, 0xffff0000, v121
    buffer_load_dwordx4 v249, s[36:39], s53 offen offset:1024 lds
    v_add_f32 v146, v146, v154
    v_add_f32 v147, v147, v155
    v_lshlrev_b32 v152, 16, v122
    buffer_load_dwordx4 v250, s[36:39], s53 offen offset:2048 lds
    s_add_u32 m0, m0, 3072
    s_nop 0
    v_and_b32 v153, 0xffff0000, v122
    v_add_f32 v148, v148, v152
    v_add_f32 v149, v149, v153
    buffer_load_dwordx4 v244, s[36:39], s57 offen offset:0 lds
    v_lshlrev_b32 v154, 16, v123
    v_and_b32 v155, 0xffff0000, v123
    v_add_f32 v150, v150, v154
    buffer_load_dwordx4 v245, s[36:39], s57 offen offset:1024 lds
    v_add_f32 v151, v151, v155
    v_lshlrev_b32 v152, 16, v124
    v_and_b32 v153, 0xffff0000, v124
    buffer_load_dwordx4 v246, s[36:39], s57 offen offset:2048 lds
    v_add_f32 v144, v144, v152
    v_add_f32 v145, v145, v153
    buffer_load_dwordx4 v247, s[36:39], s57 offen offset:3072 lds
    s_add_u32 m0, m0, 4096
    s_nop 0
    v_lshlrev_b32 v154, 16, v125
    v_and_b32 v155, 0xffff0000, v125
    v_add_f32 v146, v146, v154
    buffer_load_dwordx4 v248, s[36:39], s57 offen offset:0 lds
    v_add_f32 v147, v147, v155
    v_lshlrev_b32 v152, 16, v126
    v_and_b32 v153, 0xffff0000, v126
    buffer_load_dwordx4 v249, s[36:39], s57 offen offset:1024 lds
    v_add_f32 v148, v148, v152
    v_add_f32 v149, v149, v153
    v_lshlrev_b32 v154, 16, v127
    buffer_load_dwordx4 v250, s[36:39], s57 offen offset:2048 lds
    s_add_u32 s52, s52, 128
    s_add_u32 s53, s53, 458752
    v_and_b32 v155, 0xffff0000, v127
    v_add_f32 v150, v150, v154
    v_add_f32 v151, v151, v155
    s_waitcnt vmcnt(22)
    s_barrier
    s_waitcnt vmcnt(63)
    s_add_u32 m0, s54, 0
    s_add_u32 s57, s52, 65536
    v_lshlrev_b32 v152, 16, v128
    v_and_b32 v153, 0xffff0000, v128
    buffer_load_dwordx4 v240, s[28:31], s52 offen offset:0 lds
    v_add_f32 v144, v144, v152
    v_add_f32 v145, v145, v153
    v_lshlrev_b32 v154, 16, v129
    buffer_load_dwordx4 v241, s[28:31], s52 offen offset:1024 lds
    v_and_b32 v155, 0xffff0000, v129
    v_add_f32 v146, v146, v154
    v_add_f32 v147, v147, v155
    buffer_load_dwordx4 v242, s[28:31], s52 offen offset:2048 lds
    v_lshlrev_b32 v152, 16, v130
    v_and_b32 v153, 0xffff0000, v130
    v_add_f32 v148, v148, v152
    buffer_load_dwordx4 v243, s[28:31], s52 offen offset:3072 lds
    s_add_u32 m0, m0, 4096
    s_nop 0
    v_add_f32 v149, v149, v153
    v_lshlrev_b32 v154, 16, v131
    buffer_load_dwordx4 v240, s[28:31], s57 offen offset:0 lds
    v_and_b32 v155, 0xffff0000, v131
    v_add_f32 v150, v150, v154
    v_add_f32 v151, v151, v155
    buffer_load_dwordx4 v241, s[28:31], s57 offen offset:1024 lds
    v_lshlrev_b32 v152, 16, v132
    v_and_b32 v153, 0xffff0000, v132
    v_add_f32 v144, v144, v152
    buffer_load_dwordx4 v242, s[28:31], s57 offen offset:2048 lds
    v_add_f32 v145, v145, v153
    v_lshlrev_b32 v154, 16, v133
    v_and_b32 v155, 0xffff0000, v133
    buffer_load_dwordx4 v243, s[28:31], s57 offen offset:3072 lds
    s_add_u32 m0, s55, 0
    s_add_u32 s57, s53, 114688
    v_add_f32 v146, v146, v154
    v_add_f32 v147, v147, v155
    v_lshlrev_b32 v152, 16, v134
    buffer_load_dwordx4 v244, s[36:39], s53 offen offset:0 lds
    v_and_b32 v153, 0xffff0000, v134
    v_add_f32 v148, v148, v152
    buffer_load_dwordx4 v245, s[36:39], s53 offen offset:1024 lds
    v_add_f32 v149, v149, v153
    v_lshlrev_b32 v154, 16, v135
    v_and_b32 v155, 0xffff0000, v135
    buffer_load_dwordx4 v246, s[36:39], s53 offen offset:2048 lds
    v_add_f32 v150, v150, v154
    v_add_f32 v151, v151, v155
    v_lshlrev_b32 v152, 16, v136
    buffer_load_dwordx4 v247, s[36:39], s53 offen offset:3072 lds
    s_add_u32 m0, m0, 4096
    s_nop 0
    v_and_b32 v153, 0xffff0000, v136
    v_add_f32 v144, v144, v152
    v_add_f32 v145, v145, v153
    buffer_load_dwordx4 v248, s[36:39], s53 offen offset:0 lds
    v_lshlrev_b32 v154, 16, v137
    v_and_b32 v155, 0xffff0000, v137
    buffer_load_dwordx4 v249, s[36:39], s53 offen offset:1024 lds
    v_add_f32 v146, v146, v154
    v_add_f32 v147, v147, v155
    v_lshlrev_b32 v152, 16, v138
    buffer_load_dwordx4 v250, s[36:39], s53 offen offset:2048 lds
    s_add_u32 m0, m0, 3072
    s_nop 0
    v_and_b32 v153, 0xffff0000, v138
    v_add_f32 v148, v148, v152
    v_add_f32 v149, v149, v153
    buffer_load_dwordx4 v244, s[36:39], s57 offen offset:0 lds
    v_lshlrev_b32 v154, 16, v139
    v_and_b32 v155, 0xffff0000, v139
    v_add_f32 v150, v150, v154
    buffer_load_dwordx4 v245, s[36:39], s57 offen offset:1024 lds
    v_add_f32 v151, v151, v155
    v_lshlrev_b32 v152, 16, v140
    v_and_b32 v153, 0xffff0000, v140
    buffer_load_dwordx4 v246, s[36:39], s57 offen offset:2048 lds
    v_add_f32 v144, v144, v152
    v_add_f32 v145, v145, v153
    buffer_load_dwordx4 v247, s[36:39], s57 offen offset:3072 lds
    s_add_u32 m0, m0, 4096
    s_nop 0
    v_lshlrev_b32 v154, 16, v141
    v_and_b32 v155, 0xffff0000, v141
    v_add_f32 v146, v146, v154
    buffer_load_dwordx4 v248, s[36:39], s57 offen offset:0 lds
    v_add_f32 v147, v147, v155
    v_lshlrev_b32 v152, 16, v142
    v_and_b32 v153, 0xffff0000, v142
    buffer_load_dwordx4 v249, s[36:39], s57 offen offset:1024 lds
    v_add_f32 v148, v148, v152
    v_add_f32 v149, v149, v153
    v_lshlrev_b32 v154, 16, v143
    buffer_load_dwordx4 v250, s[36:39], s57 offen offset:2048 lds
    s_add_u32 s52, s52, 128
    s_add_u32 s53, s53, 458752
    v_and_b32 v155, 0xffff0000, v143
    v_add_f32 v150, v150, v154
    v_add_f32 v151, v151, v155
    s_waitcnt vmcnt(22)
    s_barrier
    s_add_u32 m0, s54, 45056
    s_add_u32 s57, s52, 65536
    v_mov_b32 v152, v144
    v_mov_b32 v153, v145
    buffer_load_dwordx4 v240, s[28:31], s52 offen offset:0 lds
    v_mov_b32 v154, v146
    v_mov_b32 v155, v147
    buffer_load_dwordx4 v241, s[28:31], s52 offen offset:1024 lds
    v_mov_b32 v156, v148
    v_mov_b32 v157, v149
    buffer_load_dwordx4 v242, s[28:31], s52 offen offset:2048 lds
    v_mov_b32 v158, v150
    v_mov_b32 v159, v151
    buffer_load_dwordx4 v243, s[28:31], s52 offen offset:3072 lds
    s_add_u32 m0, m0, 4096
    s_nop 0
    s_nop 0
    v_permlane16_swap_b32 v144, v152
    buffer_load_dwordx4 v240, s[28:31], s57 offen offset:0 lds
    v_permlane16_swap_b32 v145, v153
    v_permlane16_swap_b32 v146, v154
    v_permlane16_swap_b32 v147, v155
    buffer_load_dwordx4 v241, s[28:31], s57 offen offset:1024 lds
    v_permlane16_swap_b32 v148, v156
    v_permlane16_swap_b32 v149, v157
    buffer_load_dwordx4 v242, s[28:31], s57 offen offset:2048 lds
    v_permlane16_swap_b32 v150, v158
    v_permlane16_swap_b32 v151, v159
    buffer_load_dwordx4 v243, s[28:31], s57 offen offset:3072 lds
    s_add_u32 m0, s55, 45056
    s_add_u32 s57, s53, 114688
    v_add_f32 v144, v144, v152
    v_add_f32 v145, v145, v153
    buffer_load_dwordx4 v244, s[36:39], s53 offen offset:0 lds
    v_add_f32 v146, v146, v154
    v_add_f32 v147, v147, v155
    buffer_load_dwordx4 v245, s[36:39], s53 offen offset:1024 lds
    v_add_f32 v148, v148, v156
    v_add_f32 v149, v149, v157
    buffer_load_dwordx4 v246, s[36:39], s53 offen offset:2048 lds
    v_add_f32 v150, v150, v158
    v_add_f32 v151, v151, v159
    v_mov_b32 v152, v144
    buffer_load_dwordx4 v247, s[36:39], s53 offen offset:3072 lds
    s_add_u32 m0, m0, 4096
    s_nop 0
    v_mov_b32 v153, v145
    v_mov_b32 v154, v146
    buffer_load_dwordx4 v248, s[36:39], s53 offen offset:0 lds
    v_mov_b32 v155, v147
    v_mov_b32 v156, v148
    buffer_load_dwordx4 v249, s[36:39], s53 offen offset:1024 lds
    v_mov_b32 v157, v149
    v_mov_b32 v158, v150
    buffer_load_dwordx4 v250, s[36:39], s53 offen offset:2048 lds
    s_add_u32 m0, m0, 3072
    s_nop 0
    v_mov_b32 v159, v151
    s_nop 0
    buffer_load_dwordx4 v244, s[36:39], s57 offen offset:0 lds
    v_permlane32_swap_b32 v144, v152
    v_permlane32_swap_b32 v145, v153
    buffer_load_dwordx4 v245, s[36:39], s57 offen offset:1024 lds
    v_permlane32_swap_b32 v146, v154
    v_permlane32_swap_b32 v147, v155
    v_permlane32_swap_b32 v148, v156
    buffer_load_dwordx4 v246, s[36:39], s57 offen offset:2048 lds
    v_permlane32_swap_b32 v149, v157
    v_permlane32_swap_b32 v150, v158
    buffer_load_dwordx4 v247, s[36:39], s57 offen offset:3072 lds
    s_add_u32 m0, m0, 4096
    s_nop 0
    v_permlane32_swap_b32 v151, v159
    v_add_f32 v144, v144, v152
    buffer_load_dwordx4 v248, s[36:39], s57 offen offset:0 lds
    v_add_f32 v145, v145, v153
    v_add_f32 v146, v146, v154
    buffer_load_dwordx4 v249, s[36:39], s57 offen offset:1024 lds
    v_add_f32 v147, v147, v155
    v_add_f32 v148, v148, v156
    buffer_load_dwordx4 v250, s[36:39], s57 offen offset:2048 lds
    s_add_u32 s52, s52, 128
    s_add_u32 s53, s53, 458752
    v_add_f32 v149, v149, v157
    v_add_f32 v150, v150, v158
    v_add_f32 v151, v151, v159
    s_lshl_b32 s50, s61, 4
    s_add_u32 s50, s50, s60
    s_lshl_b32 s50, s50, 10
    s_mul_i32 s51, s3, 448
    s_add_u32 s50, s50, s51
    s_add_u32 s50, s50, 58785792
    v_lshlrev_b32 v3, 5, v1
    s_mov_b64 exec, 0x3fff
    buffer_store_dwordx4 v[144:147], v3, s[32:35], s50 offen sc1
    buffer_store_dwordx4 v[148:151], v3, s[32:35], s50 offen offset:16 sc1
    s_mov_b64 exec, -1
    buffer_load_dword v253, off, s[40:43], 0 sc1
    s_waitcnt vmcnt(25)
    s_barrier
    s_add_u32 m0, s54, 90112
    s_add_u32 s57, s52, 65536
    buffer_load_dwordx4 v240, s[28:31], s52 offen offset:0 lds
    buffer_load_dwordx4 v241, s[28:31], s52 offen offset:1024 lds
    buffer_load_dwordx4 v242, s[28:31], s52 offen offset:2048 lds
    buffer_load_dwordx4 v243, s[28:31], s52 offen offset:3072 lds
    s_add_u32 m0, m0, 4096
    s_nop 0
    buffer_load_dwordx4 v240, s[28:31], s57 offen offset:0 lds
    buffer_load_dwordx4 v241, s[28:31], s57 offen offset:1024 lds
    buffer_load_dwordx4 v242, s[28:31], s57 offen offset:2048 lds
    buffer_load_dwordx4 v243, s[28:31], s57 offen offset:3072 lds
    s_add_u32 m0, s55, 90112
    s_add_u32 s57, s53, 114688
    buffer_load_dwordx4 v244, s[36:39], s53 offen offset:0 lds
    buffer_load_dwordx4 v245, s[36:39], s53 offen offset:1024 lds
    buffer_load_dwordx4 v246, s[36:39], s53 offen offset:2048 lds
    buffer_load_dwordx4 v247, s[36:39], s53 offen offset:3072 lds
    s_add_u32 m0, m0, 4096
    s_nop 0
    buffer_load_dwordx4 v248, s[36:39], s53 offen offset:0 lds
    buffer_load_dwordx4 v249, s[36:39], s53 offen offset:1024 lds
    buffer_load_dwordx4 v250, s[36:39], s53 offen offset:2048 lds
    s_add_u32 m0, m0, 3072
    s_nop 0
    buffer_load_dwordx4 v244, s[36:39], s57 offen offset:0 lds
    buffer_load_dwordx4 v245, s[36:39], s57 offen offset:1024 lds
    buffer_load_dwordx4 v246, s[36:39], s57 offen offset:2048 lds
    buffer_load_dwordx4 v247, s[36:39], s57 offen offset:3072 lds
    s_add_u32 m0, m0, 4096
    s_nop 0
    buffer_load_dwordx4 v248, s[36:39], s57 offen offset:0 lds
    buffer_load_dwordx4 v249, s[36:39], s57 offen offset:1024 lds
    buffer_load_dwordx4 v250, s[36:39], s57 offen offset:2048 lds
    s_add_u32 s52, s52, 128
    s_add_u32 s53, s53, 458752
    s_waitcnt vmcnt(22)
L_non:
    v_readfirstlane_b32 s64, v253
    s_nop 0
    s_cmp_lg_u32 s64, 0
    s_cbranch_scc1 L_nok
    buffer_load_dword v253, off, s[40:43], 0 sc1
    s_waitcnt vmcnt(0)
    s_sub_u32 s79, s79, 1
    s_cbranch_scc0 L_non
    s_movk_i32 s78, 6
    s_branch K_bail
L_nok:
    s_lshl_b32 s50, s61, 1
    s_add_u32 s50, s50, s3
    s_lshl_b32 s50, s50, 4
    s_add_u32 s50, s50, s60
    s_lshl_b32 s50, s50, 7
    s_add_u32 s50, s50, 59899904
    s_mov_b64 exec, 1
    buffer_store_dword v253, off, s[32:35], s50 sc0 sc1
    s_mov_b64 exec, -1
    s_waitcnt vmcnt(26)
    s_barrier
    s_add_u32 m0, s54, 0
    s_add_u32 s57, s52, 65536
    buffer_load_dwordx4 v240, s[28:31], s52 offen offset:0 lds
    buffer_load_dwordx4 v241, s[28:31], s52 offen offset:1024 lds
    buffer_load_dwordx4 v242, s[28:31], s52 offen offset:2048 lds
    buffer_load_dwordx4 v243, s[28:31], s52 offen offset:3072 lds
    s_add_u32 m0, m0, 4096
    s_nop 0
    buffer_load_dwordx4 v240, s[28:31], s57 offen offset:0 lds
    buffer_load_dwordx4 v241, s[28:31], s57 offen offset:1024 lds
    buffer_load_dwordx4 v242, s[28:31], s57 offen offset:2048 lds
    buffer_load_dwordx4 v243, s[28:31], s57 offen offset:3072 lds
    s_add_u32 m0, s55, 0
    s_add_u32 s57, s53, 114688
    buffer_load_dwordx4 v244, s[36:39], s53 offen offset:0 lds
    buffer_load_dwordx4 v245, s[36:39], s53 offen offset:1024 lds
    buffer_load_dwordx4 v246, s[36:39], s53 offen offset:2048 lds
    buffer_load_dwordx4 v247, s[36:39], s53 offen offset:3072 lds
    s_add_u32 m0, m0, 4096
    s_nop 0
    buffer_load_dwordx4 v248, s[36:39], s53 offen offset:0 lds
    buffer_load_dwordx4 v249, s[36:39], s53 offen offset:1024 lds
    buffer_load_dwordx4 v250, s[36:39], s53 offen offset:2048 lds
    s_add_u32 m0, m0, 3072
    s_nop 0
    buffer_load_dwordx4 v244, s[36:39], s57 offen offset:0 lds
    buffer_load_dwordx4 v245, s[36:39], s57 offen offset:1024 lds
    buffer_load_dwordx4 v246, s[36:39], s57 offen offset:2048 lds
    buffer_load_dwordx4 v247, s[36:39], s57 offen offset:3072 lds
    s_add_u32 m0, m0, 4096
    s_nop 0
    buffer_load_dwordx4 v248, s[36:39], s57 offen offset:0 lds
    buffer_load_dwordx4 v249, s[36:39], s57 offen offset:1024 lds
    buffer_load_dwordx4 v250, s[36:39], s57 offen offset:2048 lds
    s_add_u32 s52, s52, 128
    s_add_u32 s53, s53, 458752
    s_waitcnt vmcnt(23)
    s_barrier
    s_add_u32 m0, s54, 45056
    s_add_u32 s57, s52, 65536
    buffer_load_dwordx4 v240, s[28:31], s52 offen offset:0 lds
    buffer_load_dwordx4 v241, s[28:31], s52 offen offset:1024 lds
    buffer_load_dwordx4 v242, s[28:31], s52 offen offset:2048 lds
    buffer_load_dwordx4 v243, s[28:31], s52 offen offset:3072 lds
    s_add_u32 m0, m0, 4096
    s_nop 0
    buffer_load_dwordx4 v240, s[28:31], s57 offen offset:0 lds
    buffer_load_dwordx4 v241, s[28:31], s57 offen offset:1024 lds
    buffer_load_dwordx4 v242, s[28:31], s57 offen offset:2048 lds
    buffer_load_dwordx4 v243, s[28:31], s57 offen offset:3072 lds
    s_add_u32 m0, s55, 45056
    s_add_u32 s57, s53, 114688
    buffer_load_dwordx4 v244, s[36:39], s53 offen offset:0 lds
    buffer_load_dwordx4 v245, s[36:39], s53 offen offset:1024 lds
    buffer_load_dwordx4 v246, s[36:39], s53 offen offset:2048 lds
    buffer_load_dwordx4 v247, s[36:39], s53 offen offset:3072 lds
    s_add_u32 m0, m0, 4096
    s_nop 0
    buffer_load_dwordx4 v248, s[36:39], s53 offen offset:0 lds
    buffer_load_dwordx4 v249, s[36:39], s53 offen offset:1024 lds
    buffer_load_dwordx4 v250, s[36:39], s53 offen offset:2048 lds
    s_add_u32 m0, m0, 3072
    s_nop 0
    buffer_load_dwordx4 v244, s[36:39], s57 offen offset:0 lds
    buffer_load_dwordx4 v245, s[36:39], s57 offen offset:1024 lds
    buffer_load_dwordx4 v246, s[36:39], s57 offen offset:2048 lds
    buffer_load_dwordx4 v247, s[36:39], s57 offen offset:3072 lds
    s_add_u32 m0, m0, 4096
    s_nop 0
    buffer_load_dwordx4 v248, s[36:39], s57 offen offset:0 lds
    buffer_load_dwordx4 v249, s[36:39], s57 offen offset:1024 lds
    buffer_load_dwordx4 v250, s[36:39], s57 offen offset:2048 lds
    s_add_u32 s52, s52, 128
    s_add_u32 s53, s53, 458752
    s_waitcnt vmcnt(22)
    s_barrier
    s_add_u32 m0, s54, 90112
    s_add_u32 s57, s52, 65536
    buffer_load_dwordx4 v240, s[28:31], s52 offen offset:0 lds
    buffer_load_dwordx4 v241, s[28:31], s52 offen offset:1024 lds
    buffer_load_dwordx4 v242, s[28:31], s52 offen offset:2048 lds
    buffer_load_dwordx4 v243, s[28:31], s52 offen offset:3072 lds
    s_add_u32 m0, m0, 4096
    s_nop 0
    buffer_load_dwordx4 v240, s[28:31], s57 offen offset:0 lds
    buffer_load_dwordx4 v241, s[28:31], s57 offen offset:1024 lds
    buffer_load_dwordx4 v242, s[28:31], s57 offen offset:2048 lds
    buffer_load_dwordx4 v243, s[28:31], s57 offen offset:3072 lds
    s_add_u32 m0, s55, 90112
    s_add_u32 s57, s53, 114688
    buffer_load_dwordx4 v244, s[36:39], s53 offen offset:0 lds
    buffer_load_dwordx4 v245, s[36:39], s53 offen offset:1024 lds
    buffer_load_dwordx4 v246, s[36:39], s53 offen offset:2048 lds
    buffer_load_dwordx4 v247, s[36:39], s53 offen offset:3072 lds
    s_add_u32 m0, m0, 4096
    s_nop 0
    buffer_load_dwordx4 v248, s[36:39], s53 offen offset:0 lds
    buffer_load_dwordx4 v249, s[36:39], s53 offen offset:1024 lds
    buffer_load_dwordx4 v250, s[36:39], s53 offen offset:2048 lds
    s_add_u32 m0, m0, 3072
    s_nop 0
    buffer_load_dwordx4 v244, s[36:39], s57 offen offset:0 lds
    buffer_load_dwordx4 v245, s[36:39], s57 offen offset:1024 lds
    buffer_load_dwordx4 v246, s[36:39], s57 offen offset:2048 lds
    buffer_load_dwordx4 v247, s[36:39], s57 offen offset:3072 lds
    s_add_u32 m0, m0, 4096
    s_nop 0
    buffer_load_dwordx4 v248, s[36:39], s57 offen offset:0 lds
    buffer_load_dwordx4 v249, s[36:39], s57 offen offset:1024 lds
    buffer_load_dwordx4 v250, s[36:39], s57 offen offset:2048 lds
    s_add_u32 s52, s52, 128
    s_add_u32 s53, s53, 458752
    s_waitcnt vmcnt(22)
    s_barrier
    s_add_u32 m0, s54, 0
    s_add_u32 s57, s52, 65536
    buffer_load_dwordx4 v240, s[28:31], s52 offen offset:0 lds
    buffer_load_dwordx4 v241, s[28:31], s52 offen offset:1024 lds
    buffer_load_dwordx4 v242, s[28:31], s52 offen offset:2048 lds
    buffer_load_dwordx4 v243, s[28:31], s52 offen offset:3072 lds
    s_add_u32 m0, m0, 4096
    s_nop 0
    buffer_load_dwordx4 v240, s[28:31], s57 offen offset:0 lds
    buffer_load_dwordx4 v241, s[28:31], s57 offen offset:1024 lds
    buffer_load_dwordx4 v242, s[28:31], s57 offen offset:2048 lds
    buffer_load_dwordx4 v243, s[28:31], s57 offen offset:3072 lds
    s_add_u32 m0, s55, 0
    s_add_u32 s57, s53, 114688
    buffer_load_dwordx4 v244, s[36:39], s53 offen offset:0 lds
    buffer_load_dwordx4 v245, s[36:39], s53 offen offset:1024 lds
    buffer_load_dwordx4 v246, s[36:39], s53 offen offset:2048 lds
    buffer_load_dwordx4 v247, s[36:39], s53 offen offset:3072 lds
    s_add_u32 m0, m0, 4096
    s_nop 0
    buffer_load_dwordx4 v248, s[36:39], s53 offen offset:0 lds
    buffer_load_dwordx4 v249, s[36:39], s53 offen offset:1024 lds
    buffer_load_dwordx4 v250, s[36:39], s53 offen offset:2048 lds
    s_add_u32 m0, m0, 3072
    s_nop 0
    buffer_load_dwordx4 v244, s[36:39], s57 offen offset:0 lds
    buffer_load_dwordx4 v245, s[36:39], s57 offen offset:1024 lds
    buffer_load_dwordx4 v246, s[36:39], s57 offen offset:2048 lds
    buffer_load_dwordx4 v247, s[36:39], s57 offen offset:3072 lds
    s_add_u32 m0, m0, 4096
    s_nop 0
    buffer_load_dwordx4 v248, s[36:39], s57 offen offset:0 lds
    buffer_load_dwordx4 v249, s[36:39], s57 offen offset:1024 lds
    buffer_load_dwordx4 v250, s[36:39], s57 offen offset:2048 lds
    s_add_u32 s52, s52, 128
    s_add_u32 s53, s53, 458752
    s_waitcnt vmcnt(22)
    s_barrier
    s_add_u32 m0, s54, 45056
    s_add_u32 s57, s52, 65536
    s_and_b32 s51, s61, 3
    buffer_load_dwordx4 v240, s[28:31], s52 offen offset:0 lds
    s_mov_b32 s69, 0x321
    s_cmp_eq_u32 s51, 1
    s_cselect_b32 s69, 0x320, s69
    buffer_load_dwordx4 v241, s[28:31], s52 offen offset:1024 lds
    s_cmp_eq_u32 s51, 2
    s_cselect_b32 s69, 0x310, s69
    s_cmp_eq_u32 s51, 3
    s_cselect_b32 s69, 0x210, s69
    buffer_load_dwordx4 v242, s[28:31], s52 offen offset:2048 lds
    s_lshl_b32 s69, s69, 20
    buffer_load_dwordx4 v243, s[28:31], s52 offen offset:3072 lds
    s_add_u32 m0, m0, 4096
    s_nop 0
    s_mov_b32 s51, 484672
    s_bitcmp1_b32 s61, 2
    s_cselect_b32 s51, 1145250048, s51
    buffer_load_dwordx4 v240, s[28:31], s57 offen offset:0 lds
    s_add_u32 s69, s69, s51
    s_and_b32 s51, s61, 7
    buffer_load_dwordx4 v241, s[28:31], s57 offen offset:1024 lds
    s_add_u32 s69, s69, s51
    buffer_load_dwordx4 v242, s[28:31], s57 offen offset:2048 lds
    s_mul_i32 s59, s63, 56
    s_mul_i32 s74, s60, 112
    buffer_load_dwordx4 v243, s[28:31], s57 offen offset:3072 lds
    s_add_u32 m0, s55, 45056
    s_add_u32 s57, s53, 114688
    s_add_u32 s74, s74, s59
    s_lshl_b32 s74, s74, 13
    buffer_load_dwordx4 v244, s[36:39], s53 offen offset:0 lds
    s_add_u32 s74, s74, 0
    buffer_load_dwordx4 v245, s[36:39], s53 offen offset:1024 lds
    s_lshl_b32 s59, s59, 16
    s_lshr_b32 s51, s62, 0
    buffer_load_dwordx4 v246, s[36:39], s53 offen offset:2048 lds
    s_lshl_b32 s51, s51, 1
    s_lshl_b32 s51, s51, 7
    buffer_load_dwordx4 v247, s[36:39], s53 offen offset:3072 lds
    s_add_u32 m0, m0, 4096
    s_nop 0
    s_add_u32 s59, s59, s51
    s_lshl_b32 s68, s3, 13
    buffer_load_dwordx4 v248, s[36:39], s53 offen offset:0 lds
    s_mov_b32 s71, s68
    buffer_load_dwordx4 v249, s[36:39], s53 offen offset:1024 lds
    s_lshl_b32 s72, s60, 1
    s_add_u32 s72, s72, s63
    buffer_load_dwordx4 v250, s[36:39], s53 offen offset:2048 lds
    s_add_u32 m0, m0, 3072
    s_nop 0
    s_lshl_b32 s72, s72, 12
    s_add_u32 s72, s72, 60030976
    buffer_load_dwordx4 v244, s[36:39], s57 offen offset:0 lds
    s_mov_b32 s70, 0
    buffer_load_dwordx4 v245, s[36:39], s57 offen offset:1024 lds
    s_lshl_b32 s73, s3, 2
    s_sub_u32 s73, 4, s73
    buffer_load_dwordx4 v246, s[36:39], s57 offen offset:2048 lds
    v_and_b32 v1, 63, v0
    v_lshlrev_b32 v251, 4, v1
    buffer_load_dwordx4 v247, s[36:39], s57 offen offset:3072 lds
    s_add_u32 m0, m0, 4096
    s_nop 0
    v_lshrrev_b32 v2, 4, v1
    buffer_load_dwordx4 v248, s[36:39], s57 offen offset:0 lds
    v_bfe_u32 v3, v1, 1, 3
    v_xor_b32 v3, v3, v2
    buffer_load_dwordx4 v249, s[36:39], s57 offen offset:1024 lds
    v_lshlrev_b32 v3, 5, v3
    v_and_b32_e64 v4, 1, v1
    buffer_load_dwordx4 v250, s[36:39], s57 offen offset:2048 lds
    s_add_u32 s52, s52, 128
    s_add_u32 s53, s53, 458752
    v_lshl_add_u32 v3, v4, 4, v3
    v_lshl_add_u32 v196, v2, 11, v3
    s_waitcnt vmcnt(22)
    s_barrier
    s_add_u32 m0, s54, 90112
    s_add_u32 s57, s52, 65536
    v_xor_b32 v197, 128, v196
    buffer_load_dwordx4 v240, s[28:31], s52 offen offset:0 lds
    v_add_u32 v197, 7168, v197
    v_add_u32 v198, 14336, v196
    buffer_load_dwordx4 v241, s[28:31], s52 offen offset:1024 lds
    v_add_u32 v199, 14336, v197
    v_add_u32 v200, 32768, v196
    buffer_load_dwordx4 v242, s[28:31], s52 offen offset:2048 lds
    v_add_u32 v201, 32768, v197
    buffer_load_dwordx4 v243, s[28:31], s52 offen offset:3072 lds
    s_add_u32 m0, m0, 4096
    s_nop 0
    v_add_u32 v202, 32768, v198
    v_add_u32 v203, 32768, v199
    buffer_load_dwordx4 v240, s[28:31], s57 offen offset:0 lds
    v_add_u32 v195, 4096, v251
    v_lshl_add_u32 v2, v1, 1, s3
    buffer_load_dwordx4 v241, s[28:31], s57 offen offset:1024 lds
    v_subrev_u32 v3, 21, v2
    buffer_load_dwordx4 v242, s[28:31], s57 offen offset:2048 lds
    v_mul_u32_u24 v4, 52, v3
    v_lshrrev_b32 v4, 8, v4
    buffer_load_dwordx4 v243, s[28:31], s57 offen offset:3072 lds
    s_add_u32 m0, s55, 90112
    s_add_u32 s57, s53, 114688
    v_mul_u32_u24 v5, 5, v4
    v_sub_u32 v5, v3, v5
    buffer_load_dwordx4 v244, s[36:39], s53 offen offset:0 lds
    v_lshlrev_b32 v5, 2, v5
    buffer_load_dwordx4 v245, s[36:39], s53 offen offset:1024 lds
    s_mov_b32 s51, 0x36251
    v_lshrrev_b32 v5, v5, s51
    buffer_load_dwordx4 v246, s[36:39], s53 offen offset:2048 lds
    v_and_b32 v5, 15, v5
    v_add_u32 v4, 1, v4
    buffer_load_dwordx4 v247, s[36:39], s53 offen offset:3072 lds
    s_add_u32 m0, m0, 4096
    s_nop 0
    v_mov_b32 v194, 8
    v_mov_b32 v6, s73
    buffer_load_dwordx4 v248, s[36:39], s53 offen offset:0 lds
    v_subrev_u32 v3, 5, v2
    buffer_load_dwordx4 v249, s[36:39], s53 offen offset:1024 lds
    v_lshrrev_b32 v3, 1, v3
    v_cmp_gt_u32 vcc, 21, v2
    s_nop 1
    v_cndmask_b32 v4, v4, v3, vcc
    buffer_load_dwordx4 v250, s[36:39], s53 offen offset:2048 lds
    s_add_u32 m0, m0, 3072
    s_nop 0
    v_cndmask_b32 v5, v5, v6, vcc
    v_cndmask_b32 v194, v194, 0, vcc
    buffer_load_dwordx4 v244, s[36:39], s57 offen offset:0 lds
    v_cmp_gt_u32 vcc, 7, v2
    s_nop 1
    v_cndmask_b32 v4, v4, 0, vcc
    buffer_load_dwordx4 v245, s[36:39], s57 offen offset:1024 lds
    v_cndmask_b32 v5, v5, v2, vcc
    v_lshlrev_b32 v4, 2, v4
    buffer_load_dwordx4 v246, s[36:39], s57 offen offset:2048 lds
    v_lshrrev_b32 v4, v4, s69
    v_and_b32 v4, 15, v4
    buffer_load_dwordx4 v247, s[36:39], s57 offen offset:3072 lds
    s_add_u32 m0, m0, 4096
    s_nop 0
    s_and_b32 s51, s69, 7
    buffer_load_dwordx4 v248, s[36:39], s57 offen offset:0 lds
    v_xor_b32 v3, s51, v4
    v_cmp_gt_u32 vcc, 21, v2
    s_nop 1
    v_cndmask_b32 v3, v3, v4, vcc
    buffer_load_dwordx4 v249, s[36:39], s57 offen offset:1024 lds
    v_add_u32_e64 v194, v194, v3
    v_mad_u32_u24 v4, v4, 7, v5
    buffer_load_dwordx4 v250, s[36:39], s57 offen offset:2048 lds
    s_add_u32 s52, s52, 128
    s_add_u32 s53, s53, 458752
    v_lshl_add_u32 v192, v4, 13, s74
    v_lshl_add_u32 v193, v4, 16, s59
    s_waitcnt vmcnt(22)
    s_barrier
    s_add_u32 m0, s54, 0
    s_add_u32 s57, s52, 65536
    buffer_load_dwordx4 v240, s[28:31], s52 offen offset:0 lds
    buffer_load_dwordx4 v241, s[28:31], s52 offen offset:1024 lds
    buffer_load_dwordx4 v242, s[28:31], s52 offen offset:2048 lds
    buffer_load_dwordx4 v243, s[28:31], s52 offen offset:3072 lds
    s_add_u32 m0, m0, 4096
    s_nop 0
    buffer_load_dwordx4 v240, s[28:31], s57 offen offset:0 lds
    buffer_load_dwordx4 v241, s[28:31], s57 offen offset:1024 lds
    buffer_load_dwordx4 v242, s[28:31], s57 offen offset:2048 lds
    buffer_load_dwordx4 v243, s[28:31], s57 offen offset:3072 lds
    s_add_u32 m0, s55, 0
    s_add_u32 s57, s53, 114688
    buffer_load_dwordx4 v244, s[36:39], s53 offen offset:0 lds
    buffer_load_dwordx4 v245, s[36:39], s53 offen offset:1024 lds
    buffer_load_dwordx4 v246, s[36:39], s53 offen offset:2048 lds
    buffer_load_dwordx4 v247, s[36:39], s53 offen offset:3072 lds
    s_add_u32 m0, m0, 4096
    s_nop 0
    buffer_load_dwordx4 v248, s[36:39], s53 offen offset:0 lds
    buffer_load_dwordx4 v249, s[36:39], s53 offen offset:1024 lds
    buffer_load_dwordx4 v250, s[36:39], s53 offen offset:2048 lds
    s_add_u32 m0, m0, 3072
    s_nop 0
    buffer_load_dwordx4 v244, s[36:39], s57 offen offset:0 lds
    buffer_load_dwordx4 v245, s[36:39], s57 offen offset:1024 lds
    buffer_load_dwordx4 v246, s[36:39], s57 offen offset:2048 lds
    buffer_load_dwordx4 v247, s[36:39], s57 offen offset:3072 lds
    s_add_u32 m0, m0, 4096
    s_nop 0
    buffer_load_dwordx4 v248, s[36:39], s57 offen offset:0 lds
    buffer_load_dwordx4 v249, s[36:39], s57 offen offset:1024 lds
    buffer_load_dwordx4 v250, s[36:39], s57 offen offset:2048 lds
    s_add_u32 s52, s52, 128
    s_add_u32 s53, s53, 458752
    s_mov_b32 s54, s64
    s_mov_b32 s55, s64
    s_and_b32 s65, s69, 7
    s_lshl_b32 s65, s65, 9
    s_add_u32 s65, s65, s72
    s_nop 0
    v_readlane_b32 s67, v193, 0
    s_nop 1
    s_waitcnt vmcnt(22)
    s_barrier
    s_add_u32 m0, s68, 65536
    s_nop 0
    buffer_load_dwordx4 v196, s[44:47], s67 offen offset:0 lds
    buffer_load_dwordx4 v197, s[44:47], s67 offen offset:1024 lds
    buffer_load_dwordx4 v198, s[44:47], s67 offen offset:2048 lds
    buffer_load_dwordx4 v199, s[44:47], s67 offen offset:3072 lds
    s_add_u32 m0, m0, 4096
    s_nop 0
    buffer_load_dwordx4 v200, s[44:47], s67 offen offset:0 lds
    buffer_load_dwordx4 v201, s[44:47], s67 offen offset:1024 lds
    buffer_load_dwordx4 v202, s[44:47], s67 offen offset:2048 lds
    buffer_load_dwordx4 v203, s[44:47], s67 offen offset:3072 lds
    v_readlane_b32 s67, v193, 1
    s_nop 1
    v_mov_b32 v160, -1
    v_mov_b32 v161, -1
    v_mov_b32 v162, -1
    v_mov_b32 v163, -1
    s_lshl_b32 s75, s77, 13
    s_add_u32 s75, s75, 50331648
    buffer_store_dwordx4 v[160:163], v251, s[32:35], s75 offen offset:0 sc1
    buffer_store_dwordx4 v[160:163], v251, s[32:35], s75 offen offset:1024 sc1
    buffer_store_dwordx4 v[160:163], v251, s[32:35], s75 offen offset:2048 sc1
    buffer_store_dwordx4 v[160:163], v251, s[32:35], s75 offen offset:3072 sc1
    s_waitcnt vmcnt(12)
    s_barrier
    s_add_u32 m0, s68, 81920
    s_nop 0
    buffer_load_dwordx4 v196, s[44:47], s67 offen offset:0 lds
    buffer_load_dwordx4 v197, s[44:47], s67 offen offset:1024 lds
    buffer_load_dwordx4 v198, s[44:47], s67 offen offset:2048 lds
    buffer_load_dwordx4 v199, s[44:47], s67 offen offset:3072 lds
    s_add_u32 m0, m0, 4096
    s_nop 0
    buffer_load_dwordx4 v200, s[44:47], s67 offen offset:0 lds
    buffer_load_dwordx4 v201, s[44:47], s67 offen offset:1024 lds
    buffer_load_dwordx4 v202, s[44:47], s67 offen offset:2048 lds
    buffer_load_dwordx4 v203, s[44:47], s67 offen offset:3072 lds
    v_readlane_b32 s67, v193, 2
    s_nop 2
    s_lshl_b32 s75, s77, 13
    s_add_u32 s75, s75, 50335744
    buffer_store_dwordx4 v[160:163], v251, s[32:35], s75 offen offset:0 sc1
    buffer_store_dwordx4 v[160:163], v251, s[32:35], s75 offen offset:1024 sc1
    buffer_store_dwordx4 v[160:163], v251, s[32:35], s75 offen offset:2048 sc1
    buffer_store_dwordx4 v[160:163], v251, s[32:35], s75 offen offset:3072 sc1
    s_barrier
    s_add_u32 m0, s68, 98304
    s_nop 0
    buffer_load_dwordx4 v196, s[44:47], s67 offen offset:0 lds
    buffer_load_dwordx4 v197, s[44:47], s67 offen offset:1024 lds
    buffer_load_dwordx4 v198, s[44:47], s67 offen offset:2048 lds
    buffer_load_dwordx4 v199, s[44:47], s67 offen offset:3072 lds
    s_add_u32 m0, m0, 4096
    s_nop 0
    buffer_load_dwordx4 v200, s[44:47], s67 offen offset:0 lds
    buffer_load_dwordx4 v201, s[44:47], s67 offen offset:1024 lds
    buffer_load_dwordx4 v202, s[44:47], s67 offen offset:2048 lds
    buffer_load_dwordx4 v203, s[44:47], s67 offen offset:3072 lds
    v_readlane_b32 s67, v193, 3
    s_nop 2
    s_add_u32 m0, s68, 114688
    s_nop 0
    buffer_load_dwordx4 v196, s[44:47], s67 offen offset:0 lds
    buffer_load_dwordx4 v197, s[44:47], s67 offen offset:1024 lds
    buffer_load_dwordx4 v198, s[44:47], s67 offen offset:2048 lds
    buffer_load_dwordx4 v199, s[44:47], s67 offen offset:3072 lds
    s_add_u32 m0, m0, 4096
    s_nop 0
    buffer_load_dwordx4 v200, s[44:47], s67 offen offset:0 lds
    buffer_load_dwordx4 v201, s[44:47], s67 offen offset:1024 lds
    buffer_load_dwordx4 v202, s[44:47], s67 offen offset:2048 lds
    buffer_load_dwordx4 v203, s[44:47], s67 offen offset:3072 lds
    v_readlane_b32 s67, v193, 4
    s_nop 2
    s_lshl_b32 s75, s77, 13
    s_add_u32 s75, s75, 41943040
    buffer_store_dwordx4 v[160:163], v251, s[32:35], s75 offen offset:0 sc1
    buffer_store_dwordx4 v[160:163], v251, s[32:35], s75 offen offset:1024 sc1
    buffer_store_dwordx4 v[160:163], v251, s[32:35], s75 offen offset:2048 sc1
    buffer_store_dwordx4 v[160:163], v251, s[32:35], s75 offen offset:3072 sc1
    s_lshl_b32 s75, s77, 13
    s_add_u32 s75, s75, 41947136
    buffer_store_dwordx4 v[160:163], v251, s[32:35], s75 offen offset:0 sc1
    buffer_store_dwordx4 v[160:163], v251, s[32:35], s75 offen offset:1024 sc1
    buffer_store_dwordx4 v[160:163], v251, s[32:35], s75 offen offset:2048 sc1
    buffer_store_dwordx4 v[160:163], v251, s[32:35], s75 offen offset:3072 sc1
    s_cmp_eq_u32 s77, 3
    s_cbranch_scc1 L_f2
    s_waitcnt vmcnt(16)
    v_mov_b32 v2, 155924
    v_mov_b32 v3, 1
    s_mov_b64 exec, 1
    ds_add_u32 v2, v3
    s_mov_b64 exec, -1
    s_mul_i32 s52, s60, 112
    s_mul_i32 s53, s61, 7
    s_add_u32 s52, s52, s53
    s_lshl_b32 s52, s52, 13
    s_add_u32 s52, s52, 0
    s_mov_b32 s53, s3
L_st0:
    s_lshl_b32 s50, s53, 2
    s_add_u32 s50, s50, 155940
    v_mov_b32 v2, s50
    s_lshl_b32 s50, s53, 15
    v_add_u32 v4, s50, v251
    s_add_u32 s50, s50, s52
L_sp0:
    ds_read_b32 v3, v2
    s_waitcnt lgkmcnt(0)
    v_readfirstlane_b32 s51, v3
    s_add_u32 s57, s50, 0
    s_cmp_ge_u32 s51, 2
    s_cbranch_scc1 L_sp0_ok
    s_sub_u32 s79, s79, 1
    s_cbranch_scc0 L_sp0
    s_movk_i32 s78, 7
    s_branch K_bail
L_sp0_ok:
    ds_read_b128 v[64:67], v4 offset:0
    ds_read_b128 v[68:71], v4 offset:1024
    ds_read_b128 v[72:75], v4 offset:2048
    ds_read_b128 v[76:79], v4 offset:3072
    ds_read_b128 v[80:83], v4 offset:4096
    ds_read_b128 v[84:87], v4 offset:5120
    ds_read_b128 v[88:91], v4 offset:6144
    ds_read_b128 v[92:95], v4 offset:7168
    s_waitcnt lgkmcnt(7)
    buffer_store_dwordx4 v[64:67], v251, s[32:35], s57 offen offset:0 sc1
    s_waitcnt lgkmcnt(6)
    buffer_store_dwordx4 v[68:71], v251, s[32:35], s57 offen offset:1024 sc1
    s_waitcnt lgkmcnt(5)
    buffer_store_dwordx4 v[72:75], v251, s[32:35], s57 offen offset:2048 sc1
    s_waitcnt lgkmcnt(4)
    buffer_store_dwordx4 v[76:79], v251, s[32:35], s57 offen offset:3072 sc1
    s_add_u32 s57, s57, 4096
    s_waitcnt lgkmcnt(3)
    buffer_store_dwordx4 v[80:83], v251, s[32:35], s57 offen offset:0 sc1
    s_waitcnt lgkmcnt(2)
    buffer_store_dwordx4 v[84:87], v251, s[32:35], s57 offen offset:1024 sc1
    s_waitcnt lgkmcnt(1)
    buffer_store_dwordx4 v[88:91], v251, s[32:35], s57 offen offset:2048 sc1
    s_waitcnt lgkmcnt(0)
    buffer_store_dwordx4 v[92:95], v251, s[32:35], s57 offen offset:3072 sc1
    s_cmp_eq_u32 s77, 2
    s_cbranch_scc0 L_sn0
    s_xor_b32 s53, s53, 1
    s_cbranch_scc1 L_st0
L_sn0:
L_st1:
    s_lshl_b32 s50, s53, 2
    s_add_u32 s50, s50, 155948
    v_mov_b32 v2, s50
    s_lshl_b32 s50, s53, 15
    v_add_u32 v4, s50, v251
    s_add_u32 s50, s50, s52
L_sp1:
    ds_read_b32 v3, v2
    s_waitcnt lgkmcnt(0)
    v_readfirstlane_b32 s51, v3
    s_add_u32 s57, s50, 8192
    s_cmp_ge_u32 s51, 2
    s_cbranch_scc1 L_sp1_ok
    s_sub_u32 s79, s79, 1
    s_cbranch_scc0 L_sp1
    s_movk_i32 s78, 8
    s_branch K_bail
L_sp1_ok:
    ds_read_b128 v[96:99], v4 offset:8192
    ds_read_b128 v[100:103], v4 offset:9216
    ds_read_b128 v[104:107], v4 offset:10240
    ds_read_b128 v[108:111], v4 offset:11264
    ds_read_b128 v[112:115], v4 offset:12288
    ds_read_b128 v[116:119], v4 offset:13312
    ds_read_b128 v[120:123], v4 offset:14336
    ds_read_b128 v[124:127], v4 offset:15360
    s_waitcnt lgkmcnt(7)
    buffer_store_dwordx4 v[96:99], v251, s[32:35], s57 offen offset:0 sc1
    s_waitcnt lgkmcnt(6)
    buffer_store_dwordx4 v[100:103], v251, s[32:35], s57 offen offset:1024 sc1
    s_waitcnt lgkmcnt(5)
    buffer_store_dwordx4 v[104:107], v251, s[32:35], s57 offen offset:2048 sc1
    s_waitcnt lgkmcnt(4)
    buffer_store_dwordx4 v[108:111], v251, s[32:35], s57 offen offset:3072 sc1
    s_add_u32 s57, s57, 4096
    s_waitcnt lgkmcnt(3)
    buffer_store_dwordx4 v[112:115], v251, s[32:35], s57 offen offset:0 sc1
    s_waitcnt lgkmcnt(2)
    buffer_store_dwordx4 v[116:119], v251, s[32:35], s57 offen offset:1024 sc1
    s_waitcnt lgkmcnt(1)
    buffer_store_dwordx4 v[120:123], v251, s[32:35], s57 offen offset:2048 sc1
    s_waitcnt lgkmcnt(0)
    buffer_store_dwordx4 v[124:127], v251, s[32:35], s57 offen offset:3072 sc1
    s_cmp_eq_u32 s77, 2
    s_cbranch_scc0 L_sn1
    s_xor_b32 s53, s53, 1
    s_cbranch_scc1 L_st1
L_sn1:
    s_and_b32 s50, s61, 7
    s_lshl_b32 s50, s50, 9
    s_add_u32 s50, s50, s72
    s_lshl_b32 s51, s3, 7
    s_add_u32 s37, s50, s51
    v_mov_b32 v2, s64
    v_lshlrev_b32 v3, 7, v1
    s_cmp_eq_u32 s77, 2
    s_cselect_b32 s36, 3, 1
    s_cbranch_scc1 L_fx
    s_waitcnt vmcnt(8)
L_fx:
    s_waitcnt vmcnt(16)
    s_mov_b32 exec_lo, s36
    s_mov_b32 exec_hi, 0
    buffer_store_dword v2, v3, s[32:35], s37 offen sc0 sc1
    s_mov_b64 exec, -1
L_st2:
    s_lshl_b32 s50, s53, 2
    s_add_u32 s50, s50, 155956
    v_mov_b32 v2, s50
    s_lshl_b32 s50, s53, 15
    v_add_u32 v4, s50, v251
    s_add_u32 s50, s50, s52
L_sp2:
    ds_read_b32 v3, v2
    s_waitcnt lgkmcnt(0)
    v_readfirstlane_b32 s51, v3
    s_add_u32 s57, s50, 16384
    s_cmp_ge_u32 s51, 2
    s_cbranch_scc1 L_sp2_ok
    s_sub_u32 s79, s79, 1
    s_cbranch_scc0 L_sp2
    s_movk_i32 s78, 9
    s_branch K_bail
L_sp2_ok:
    ds_read_b128 v[128:131], v4 offset:16384
    ds_read_b128 v[132:135], v4 offset:17408
    ds_read_b128 v[136:139], v4 offset:18432
    ds_read_b128 v[140:143], v4 offset:19456
    ds_read_b128 v[144:147], v4 offset:20480
    ds_read_b128 v[148:151], v4 offset:21504
    ds_read_b128 v[152:155], v4 offset:22528
    ds_read_b128 v[156:159], v4 offset:23552
    s_waitcnt lgkmcnt(7)
    buffer_store_dwordx4 v[128:131], v251, s[32:35], s57 offen offset:0 sc1
    s_waitcnt lgkmcnt(6)
    buffer_store_dwordx4 v[132:135], v251, s[32:35], s57 offen offset:1024 sc1
    s_waitcnt lgkmcnt(5)
    buffer_store_dwordx4 v[136:139], v251, s[32:35], s57 offen offset:2048 sc1
    s_waitcnt lgkmcnt(4)
    buffer_store_dwordx4 v[140:143], v251, s[32:35], s57 offen offset:3072 sc1
    s_add_u32 s57, s57, 4096
    s_waitcnt lgkmcnt(3)
    buffer_store_dwordx4 v[144:147], v251, s[32:35], s57 offen offset:0 sc1
    s_waitcnt lgkmcnt(2)
    buffer_store_dwordx4 v[148:151], v251, s[32:35], s57 offen offset:1024 sc1
    s_waitcnt lgkmcnt(1)
    buffer_store_dwordx4 v[152:155], v251, s[32:35], s57 offen offset:2048 sc1
    s_waitcnt lgkmcnt(0)
    buffer_store_dwordx4 v[156:159], v251, s[32:35], s57 offen offset:3072 sc1
    s_cmp_eq_u32 s77, 2
    s_cbranch_scc0 L_sn2
    s_xor_b32 s53, s53, 1
    s_cbranch_scc1 L_st2
L_sn2:
L_st3:
    v_mov_b32 v2, 155924
    s_lshl_b32 s50, s53, 12
    v_add_u32_e64 v4, s50, v251
    s_add_u32 s50, s50, s52
L_sp3:
    ds_read_b32 v3, v2
    s_waitcnt lgkmcnt(0)
    v_readfirstlane_b32 s51, v3
    s_add_u32 s57, s50, 24576
    s_cmp_ge_u32 s51, 8
    s_cbranch_scc1 L_sp3_ok
    s_sub_u32 s79, s79, 1
    s_cbranch_scc0 L_sp3
    s_movk_i32 s78, 10
    s_branch K_bail
L_sp3_ok:
    ds_read_b128 v[160:163], v4 offset:24576
    ds_read_b128 v[164:167], v4 offset:25600
    ds_read_b128 v[168:171], v4 offset:26624
    ds_read_b128 v[172:175], v4 offset:27648
    s_waitcnt lgkmcnt(0)
    s_xor_b32 s51, s3, 1
    s_lshl_b32 s51, s51, 7
    s_add_u32 s51, s51, s72
    s_load_dword s4, s[24:25], s51 offset:0 glc
    s_load_dword s5, s[24:25], s51 offset:512 glc
    s_load_dword s6, s[24:25], s51 offset:1024 glc
    s_load_dword s7, s[24:25], s51 offset:1536 glc
    s_load_dword s8, s[24:25], s51 offset:2048 glc
    s_load_dword s9, s[24:25], s51 offset:2560 glc
    s_load_dword s10, s[24:25], s51 offset:3072 glc
    s_load_dword s11, s[24:25], s51 offset:3584 glc
    buffer_store_dwordx4 v[160:163], v251, s[32:35], s57 offen offset:0 sc1
    buffer_store_dwordx4 v[164:167], v251, s[32:35], s57 offen offset:1024 sc1
    buffer_store_dwordx4 v[168:171], v251, s[32:35], s57 offen offset:2048 sc1
    buffer_store_dwordx4 v[172:175], v251, s[32:35], s57 offen offset:3072 sc1
    v_mov_b32 v2, 155928
    v_mov_b32 v3, 1
    s_mov_b64 exec, 1
    ds_add_u32 v2, v3
    s_mov_b64 exec, -1
    s_cmp_eq_u32 s77, 2
    s_cbranch_scc0 L_sn3
    s_xor_b32 s53, s53, 1
    s_cbranch_scc1 L_st3
L_sn3:
    s_and_b32 s50, s61, 7
    s_lshl_b32 s50, s50, 9
    s_add_u32 s50, s50, s72
    s_lshl2_add_u32 s37, s3, s50
    s_add_u32 s37, s37, 256
    v_mov_b32 v2, s64
    v_lshlrev_b32_e64 v3, 2, v1
L_f2back:
    v_readlane_b32 s67, v193, 4
    v_readlane_b32 s40, v192, 3
    v_readlane_b32 s28, v194, 3
    v_readlane_b32 s41, v192, 4
    v_readlane_b32 s29, v194, 4
    v_readlane_b32 s42, v192, 5
    v_readlane_b32 s30, v194, 5
    s_waitcnt lgkmcnt(0)
    s_mov_b32 s51, 0
    s_cmp_eq_u32 s11, s64
    s_addc_u32 s51, s51, s51
    s_cmp_eq_u32 s10, s64
    s_addc_u32 s51, s51, s51
    s_cmp_eq_u32 s9, s64
    s_addc_u32 s51, s51, s51
    s_cmp_eq_u32 s8, s64
    s_addc_u32 s51, s51, s51
    s_cmp_eq_u32 s7, s64
    s_addc_u32 s51, s51, s51
    s_cmp_eq_u32 s6, s64
    s_addc_u32 s51, s51, s51
    s_cmp_eq_u32 s5, s64
    s_addc_u32 s51, s51, s51
    s_cmp_eq_u32 s4, s64
    s_addc_u32 s51, s51, s51
    s_or_b32 s70, s70, s51
    s_cmp_eq_u32 s3, 0
    s_cbranch_scc1 L2_noh
L2_a3:
    s_bitcmp1_b32 s70, s28
    s_cbranch_scc0 L2_a3_slow
    s_add_u32 m0, s68, 49152
    s_nop 0
    buffer_load_dwordx4 v251, s[32:35], s40 offen offset:0 sc1 lds
    buffer_load_dwordx4 v251, s[32:35], s40 offen offset:1024 sc1 lds
    buffer_load_dwordx4 v251, s[32:35], s40 offen offset:2048 sc1 lds
    buffer_load_dwordx4 v251, s[32:35], s40 offen offset:3072 sc1 lds
    s_add_u32 m0, m0, 4096
    s_nop 0
    buffer_load_dwordx4 v195, s[32:35], s40 offen offset:0 sc1 lds
    buffer_load_dwordx4 v195, s[32:35], s40 offen offset:1024 sc1 lds
    buffer_load_dwordx4 v195, s[32:35], s40 offen offset:2048 sc1 lds
    buffer_load_dwordx4 v195, s[32:35], s40 offen offset:3072 sc1 lds
L2_noh:
    v_mov_b32 v4, 155928
L_fr0:
    ds_read_b32 v5, v4
    s_waitcnt lgkmcnt(0)
    v_readfirstlane_b32 s50, v5
    s_nop 0
    s_cmp_ge_u32 s50, 6
    s_cbranch_scc1 L_fr0_ok
    s_sub_u32 s79, s79, 1
    s_cbranch_scc0 L_fr0
    s_movk_i32 s78, 11
    s_branch K_bail
L_fr0_ok:
    s_add_u32 m0, s68, 65536
    s_nop 0
    buffer_load_dwordx4 v196, s[44:47], s67 offen offset:0 lds
    buffer_load_dwordx4 v197, s[44:47], s67 offen offset:1024 lds
    buffer_load_dwordx4 v198, s[44:47], s67 offen offset:2048 lds
    buffer_load_dwordx4 v199, s[44:47], s67 offen offset:3072 lds
    s_add_u32 m0, m0, 4096
    s_nop 0
    buffer_load_dwordx4 v200, s[44:47], s67 offen offset:0 lds
    buffer_load_dwordx4 v201, s[44:47], s67 offen offset:1024 lds
    buffer_load_dwordx4 v202, s[44:47], s67 offen offset:2048 lds
    buffer_load_dwordx4 v203, s[44:47], s67 offen offset:3072 lds
    v_readlane_b32 s67, v193, 5
L2_a4:
    s_bitcmp1_b32 s70, s29
    s_cbranch_scc0 L2_a4_slow
    s_add_u32 m0, s68, 0
    s_nop 0
    buffer_load_dwordx4 v251, s[32:35], s41 offen offset:0 sc1 lds
    buffer_load_dwordx4 v251, s[32:35], s41 offen offset:1024 sc1 lds
    buffer_load_dwordx4 v251, s[32:35], s41 offen offset:2048 sc1 lds
    buffer_load_dwordx4 v251, s[32:35], s41 offen offset:3072 sc1 lds
    s_add_u32 m0, m0, 4096
    s_nop 0
    buffer_load_dwordx4 v195, s[32:35], s41 offen offset:0 sc1 lds
    buffer_load_dwordx4 v195, s[32:35], s41 offen offset:1024 sc1 lds
    buffer_load_dwordx4 v195, s[32:35], s41 offen offset:2048 sc1 lds
    buffer_load_dwordx4 v195, s[32:35], s41 offen offset:3072 sc1 lds
    v_mov_b32 v4, 156040
L_fr1:
    ds_read_b32 v5, v4
    s_waitcnt lgkmcnt(0)
    v_readfirstlane_b32 s50, v5
    s_nop 0
    s_cmp_ge_u32 s50, 4
    s_cbranch_scc1 L_fr1_ok
    s_sub_u32 s79, s79, 1
    s_cbranch_scc0 L_fr1
    s_movk_i32 s78, 12
    s_branch K_bail
L_fr1_ok:
    s_add_u32 m0, s68, 81920
    s_nop 0
    buffer_load_dwordx4 v196, s[44:47], s67 offen offset:0 lds
    buffer_load_dwordx4 v197, s[44:47], s67 offen offset:1024 lds
    buffer_load_dwordx4 v198, s[44:47], s67 offen offset:2048 lds
    buffer_load_dwordx4 v199, s[44:47], s67 offen offset:3072 lds
    s_add_u32 m0, m0, 4096
    s_nop 0
    buffer_load_dwordx4 v200, s[44:47], s67 offen offset:0 lds
    buffer_load_dwordx4 v201, s[44:47], s67 offen offset:1024 lds
    buffer_load_dwordx4 v202, s[44:47], s67 offen offset:2048 lds
    buffer_load_dwordx4 v203, s[44:47], s67 offen offset:3072 lds
    v_readlane_b32 s67, v193, 6
L2_a5:
    s_bitcmp1_b32 s70, s30
    s_cbranch_scc0 L2_a5_slow
    s_add_u32 m0, s68, 16384
    s_nop 0
    buffer_load_dwordx4 v251, s[32:35], s42 offen offset:0 sc1 lds
    buffer_load_dwordx4 v251, s[32:35], s42 offen offset:1024 sc1 lds
    buffer_load_dwordx4 v251, s[32:35], s42 offen offset:2048 sc1 lds
    buffer_load_dwordx4 v251, s[32:35], s42 offen offset:3072 sc1 lds
    s_add_u32 m0, m0, 4096
    s_nop 0
    buffer_load_dwordx4 v195, s[32:35], s42 offen offset:0 sc1 lds
    buffer_load_dwordx4 v195, s[32:35], s42 offen offset:1024 sc1 lds
    buffer_load_dwordx4 v195, s[32:35], s42 offen offset:2048 sc1 lds
    buffer_load_dwordx4 v195, s[32:35], s42 offen offset:3072 sc1 lds
    v_readlane_b32 s66, v192, 6
    v_readlane_b32 s56, v194, 6
    s_add_u32 s71, s68, 0x8000
    s_mov_b32 exec_lo, s36
    s_mov_b32 exec_hi, 0
    s_cmp_eq_u32 s77, 3
    s_waitcnt vmcnt(32)
    s_cbranch_scc1 L_xa
L_xb:
    buffer_store_dword v2, v3, s[32:35], s37 offen sc0 sc1
L_xc:
    s_mov_b64 exec, -1
    s_mov_b32 s58, 6
    s_branch L2_bar
L2_loop:
    s_waitcnt vmcnt(32)
L2_bar:
    s_barrier
L2_al:
    s_bitcmp1_b32 s70, s56
    s_cbranch_scc0 L2_al_slow
    s_mov_b32 m0, s71
    s_add_u32 s58, s58, 1
    buffer_load_dwordx4 v251, s[32:35], s66 offen offset:0 sc1 lds
    buffer_load_dwordx4 v251, s[32:35], s66 offen offset:1024 sc1 lds
    buffer_load_dwordx4 v251, s[32:35], s66 offen offset:2048 sc1 lds
    buffer_load_dwordx4 v251, s[32:35], s66 offen offset:3072 sc1 lds
    s_add_u32 m0, s71, 4096
    s_add_u32 s57, s71, 16384
    buffer_load_dwordx4 v195, s[32:35], s66 offen offset:0 sc1 lds
    buffer_load_dwordx4 v195, s[32:35], s66 offen offset:1024 sc1 lds
    buffer_load_dwordx4 v195, s[32:35], s66 offen offset:2048 sc1 lds
    buffer_load_dwordx4 v195, s[32:35], s66 offen offset:3072 sc1 lds
    s_add_u32 m0, s71, 65536
    v_readlane_b32 s66, v192, s58
    buffer_load_dwordx4 v196, s[44:47], s67 offen offset:0 lds
    buffer_load_dwordx4 v197, s[44:47], s67 offen offset:1024 lds
    buffer_load_dwordx4 v198, s[44:47], s67 offen offset:2048 lds
    buffer_load_dwordx4 v199, s[44:47], s67 offen offset:3072 lds
    s_add_u32 m0, s71, 69632
    v_readlane_b32 s56, v194, s58
    buffer_load_dwordx4 v200, s[44:47], s67 offen offset:0 lds
    s_and_b32 s71, s57, 0xffff
    buffer_load_dwordx4 v201, s[44:47], s67 offen offset:1024 lds
    s_bitcmp1_b32 0x780, s58
    buffer_load_dwordx4 v202, s[44:47], s67 offen offset:2048 lds
    buffer_load_dwordx4 v203, s[44:47], s67 offen offset:3072 lds
    v_readlane_b32 s67, v193, s58
    s_cbranch_scc1 L2_ev
L2_evr:
    s_cmp_lt_u32 s58, 28
    s_cbranch_scc1 L2_loop
    s_waitcnt vmcnt(32)
    s_barrier
    s_waitcnt vmcnt(16)
    s_barrier
    s_waitcnt vmcnt(0)
    s_barrier
    s_endpgm
L2_ev:
    s_cmp_eq_u32 s58, 9
    s_cbranch_scc1 L2_lb
    s_cmp_eq_u32 s58, 10
    s_cbranch_scc1 L2_mb
    s_cmp_eq_u32 s58, 8
    s_cbranch_scc1 L2_ma
    s_xor_b32 s51, s3, 1
    s_lshl_b32 s51, s51, 7
    s_add_u32 s51, s51, s72
    s_load_dword s4, s[24:25], s51 offset:0 glc
    s_load_dword s5, s[24:25], s51 offset:512 glc
    s_load_dword s6, s[24:25], s51 offset:1024 glc
    s_load_dword s7, s[24:25], s51 offset:1536 glc
    s_load_dword s8, s[24:25], s51 offset:2048 glc
    s_load_dword s9, s[24:25], s51 offset:2560 glc
    s_load_dword s10, s[24:25], s51 offset:3072 glc
    s_load_dword s11, s[24:25], s51 offset:3584 glc
    s_branch L2_evr
L2_ma:
    s_waitcnt lgkmcnt(0)
    s_mov_b32 s51, 0
    s_cmp_eq_u32 s11, s64
    s_addc_u32 s51, s51, s51
    s_cmp_eq_u32 s10, s64
    s_addc_u32 s51, s51, s51
    s_cmp_eq_u32 s9, s64
    s_addc_u32 s51, s51, s51
    s_cmp_eq_u32 s8, s64
    s_addc_u32 s51, s51, s51
    s_cmp_eq_u32 s7, s64
    s_addc_u32 s51, s51, s51
    s_cmp_eq_u32 s6, s64
    s_addc_u32 s51, s51, s51
    s_cmp_eq_u32 s5, s64
    s_addc_u32 s51, s51, s51
    s_cmp_eq_u32 s4, s64
    s_addc_u32 s51, s51, s51
    s_or_b32 s70, s70, s51
    s_branch L2_evr
L2_a3_slow:
    s_mov_b32 s50, 0
    s_branch L2_pa
L2_a4_slow:
    s_mov_b32 s50, 1
    s_branch L2_pa
L2_a5_slow:
    s_mov_b32 s50, 2
    s_branch L2_pa
L2_al_slow:
    s_cmp_lt_u32 s56, 8
    s_cbranch_scc1 L2_al_sa
    s_xor_b32 s51, s65, 512
    s_load_dwordx2 s[6:7], s[24:25], s51 offset:256 glc
    s_xor_b32 s51, s65, 1024
    s_load_dwordx2 s[8:9], s[24:25], s51 offset:256 glc
    s_xor_b32 s51, s65, 1536
    s_load_dwordx2 s[10:11], s[24:25], s51 offset:256 glc
    s_xor_b32 s51, s65, 2048
    s_load_dwordx2 s[12:13], s[24:25], s51 offset:256 glc
    s_xor_b32 s51, s65, 2560
    s_load_dwordx2 s[14:15], s[24:25], s51 offset:256 glc
    s_xor_b32 s51, s65, 3072
    s_load_dwordx2 s[16:17], s[24:25], s51 offset:256 glc
    s_xor_b32 s51, s65, 3584
    s_load_dwordx2 s[18:19], s[24:25], s51 offset:256 glc
    s_waitcnt lgkmcnt(0)
    s_mov_b32 s51, 0
    s_cmp_eq_u64 s[18:19], s[54:55]
    s_addc_u32 s51, s51, s51
    s_cmp_eq_u64 s[16:17], s[54:55]
    s_addc_u32 s51, s51, s51
    s_cmp_eq_u64 s[14:15], s[54:55]
    s_addc_u32 s51, s51, s51
    s_cmp_eq_u64 s[12:13], s[54:55]
    s_addc_u32 s51, s51, s51
    s_cmp_eq_u64 s[10:11], s[54:55]
    s_addc_u32 s51, s51, s51
    s_cmp_eq_u64 s[8:9], s[54:55]
    s_addc_u32 s51, s51, s51
    s_cmp_eq_u64 s[6:7], s[54:55]
    s_addc_u32 s51, s51, s51
    s_lshl_b32 s51, s51, 9
    s_or_b32 s70, s70, s51
    s_sub_u32 s79, s79, 1
    s_cbranch_scc0 L2_al
    s_movk_i32 s78, 13
    s_branch K_bail
L2_al_sa:
    s_xor_b32 s51, s3, 1
    s_lshl_b32 s51, s51, 7
    s_add_u32 s51, s51, s72
    s_load_dword s28, s[24:25], s51 offset:0 glc
    s_load_dword s29, s[24:25], s51 offset:512 glc
    s_load_dword s30, s[24:25], s51 offset:1024 glc
    s_load_dword s31, s[24:25], s51 offset:1536 glc
    s_load_dword s40, s[24:25], s51 offset:2048 glc
    s_load_dword s41, s[24:25], s51 offset:2560 glc
    s_load_dword s42, s[24:25], s51 offset:3072 glc
    s_load_dword s43, s[24:25], s51 offset:3584 glc
    s_waitcnt lgkmcnt(0)
    s_mov_b32 s51, 0
    s_cmp_eq_u32 s43, s64
    s_addc_u32 s51, s51, s51
    s_cmp_eq_u32 s42, s64
    s_addc_u32 s51, s51, s51
    s_cmp_eq_u32 s41, s64
    s_addc_u32 s51, s51, s51
    s_cmp_eq_u32 s40, s64
    s_addc_u32 s51, s51, s51
    s_cmp_eq_u32 s31, s64
    s_addc_u32 s51, s51, s51
    s_cmp_eq_u32 s30, s64
    s_addc_u32 s51, s51, s51
    s_cmp_eq_u32 s29, s64
    s_addc_u32 s51, s51, s51
    s_cmp_eq_u32 s28, s64
    s_addc_u32 s51, s51, s51
    s_or_b32 s70, s70, s51
    s_sub_u32 s79, s79, 1
    s_cbranch_scc0 L2_al
    s_movk_i32 s78, 14
    s_branch K_bail
L2_pa:
    s_sleep 2
    s_xor_b32 s51, s3, 1
    s_lshl_b32 s51, s51, 7
    s_add_u32 s51, s51, s72
    s_load_dword s4, s[24:25], s51 offset:0 glc
    s_load_dword s5, s[24:25], s51 offset:512 glc
    s_load_dword s6, s[24:25], s51 offset:1024 glc
    s_load_dword s7, s[24:25], s51 offset:1536 glc
    s_load_dword s8, s[24:25], s51 offset:2048 glc
    s_load_dword s9, s[24:25], s51 offset:2560 glc
    s_load_dword s10, s[24:25], s51 offset:3072 glc
    s_load_dword s11, s[24:25], s51 offset:3584 glc
    s_waitcnt lgkmcnt(0)
    s_mov_b32 s51, 0
    s_cmp_eq_u32 s11, s64
    s_addc_u32 s51, s51, s51
    s_cmp_eq_u32 s10, s64
    s_addc_u32 s51, s51, s51
    s_cmp_eq_u32 s9, s64
    s_addc_u32 s51, s51, s51
    s_cmp_eq_u32 s8, s64
    s_addc_u32 s51, s51, s51
    s_cmp_eq_u32 s7, s64
    s_addc_u32 s51, s51, s51
    s_cmp_eq_u32 s6, s64
    s_addc_u32 s51, s51, s51
    s_cmp_eq_u32 s5, s64
    s_addc_u32 s51, s51, s51
    s_cmp_eq_u32 s4, s64
    s_addc_u32 s51, s51, s51
    s_or_b32 s70, s70, s51
    s_sub_u32 s79, s79, 1
    s_cbranch_scc1 L2_pb
    s_cmp_eq_u32 s50, 0
    s_cbranch_scc1 L2_a3
    s_cmp_eq_u32 s50, 1
    s_cbranch_scc1 L2_a4
    s_cmp_eq_u32 s50, 2
    s_cbranch_scc1 L2_a5
L2_pb:
    s_movk_i32 s78, 999
    s_branch K_bail
L2_lb:
    s_nop 0
    s_xor_b32 s51, s65, 512
    s_load_dwordx2 s[6:7], s[24:25], s51 offset:256 glc
    s_xor_b32 s51, s65, 1024
    s_load_dwordx2 s[8:9], s[24:25], s51 offset:256 glc
    s_xor_b32 s51, s65, 1536
    s_load_dwordx2 s[10:11], s[24:25], s51 offset:256 glc
    s_xor_b32 s51, s65, 2048
    s_load_dwordx2 s[12:13], s[24:25], s51 offset:256 glc
    s_xor_b32 s51, s65, 2560
    s_load_dwordx2 s[14:15], s[24:25], s51 offset:256 glc
    s_xor_b32 s51, s65, 3072
    s_load_dwordx2 s[16:17], s[24:25], s51 offset:256 glc
    s_xor_b32 s51, s65, 3584
    s_load_dwordx2 s[18:19], s[24:25], s51 offset:256 glc
    s_branch L2_evr
L2_mb:
    s_waitcnt lgkmcnt(0)
    s_mov_b32 s51, 0
    s_cmp_eq_u64 s[18:19], s[54:55]
    s_addc_u32 s51, s51, s51
    s_cmp_eq_u64 s[16:17], s[54:55]
    s_addc_u32 s51, s51, s51
    s_cmp_eq_u64 s[14:15], s[54:55]
    s_addc_u32 s51, s51, s51
    s_cmp_eq_u64 s[12:13], s[54:55]
    s_addc_u32 s51, s51, s51
    s_cmp_eq_u64 s[10:11], s[54:55]
    s_addc_u32 s51, s51, s51
    s_cmp_eq_u64 s[8:9], s[54:55]
    s_addc_u32 s51, s51, s51
    s_cmp_eq_u64 s[6:7], s[54:55]
    s_addc_u32 s51, s51, s51
    s_lshl_b32 s51, s51, 9
    s_or_b32 s70, s70, s51
    s_branch L2_evr
L_f2:
    v_mov_b32 v7, v251
    s_movk_i32 s10, 256
    s_mov_b32 s11, 0
    v_mov_b32 v2, 156032
L_p1:
    ds_read_b32 v3, v2
    s_waitcnt lgkmcnt(0)
    v_readfirstlane_b32 s50, v3
    s_nop 0
    s_cmp_ge_u32 s50, 1
    s_cbranch_scc1 L_p1_ok
    s_sub_u32 s79, s79, 1
    s_cbranch_scc0 L_p1
    s_movk_i32 s78, 15
    s_branch K_bail
L_p1_ok:
    s_waitcnt vmcnt(16)
    v_mov_b32 v2, 155924
    v_mov_b32 v3, 1
    s_mov_b64 exec, 1
    ds_add_u32 v2, v3
    s_mov_b64 exec, -1
    v_and_b32 v3, 31, v0
    v_lshlrev_b32 v3, 6, v3
    v_bfe_u32 v6, v0, 5, 1
    v_lshl_add_u32 v3, v6, 4, v3
    s_lshl_b32 s8, s10, 14
    s_lshl_b32 s9, s11, 5
    s_add_u32 s8, s8, s9
    s_add_u32 s9, s8, 25165824
    s_add_u32 s8, s8, 16777216
    buffer_load_dwordx4 v[80:83], v3, s[32:35], s8 offen sc1
    buffer_load_dwordx4 v[96:99], v3, s[32:35], s8 offen offset:2048 sc1
    s_add_u32 s8, s8, 4096
    buffer_load_dwordx4 v[84:87], v3, s[32:35], s8 offen sc1
    buffer_load_dwordx4 v[100:103], v3, s[32:35], s8 offen offset:2048 sc1
    s_add_u32 s8, s8, 4096
    buffer_load_dwordx4 v[88:91], v3, s[32:35], s8 offen sc1
    buffer_load_dwordx4 v[104:107], v3, s[32:35], s8 offen offset:2048 sc1
    s_add_u32 s8, s8, 4096
    buffer_load_dwordx4 v[92:95], v3, s[32:35], s8 offen sc1
    buffer_load_dwordx4 v[108:111], v3, s[32:35], s8 offen offset:2048 sc1
    buffer_load_dwordx4 v[176:179], v3, s[32:35], s9 offen sc1
    buffer_load_dwordx4 v[192:195], v3, s[32:35], s9 offen offset:2048 sc1
    s_add_u32 s9, s9, 4096
    buffer_load_dwordx4 v[180:183], v3, s[32:35], s9 offen sc1
    buffer_load_dwordx4 v[196:199], v3, s[32:35], s9 offen offset:2048 sc1
    s_add_u32 s9, s9, 4096
    buffer_load_dwordx4 v[184:187], v3, s[32:35], s9 offen sc1
    buffer_load_dwordx4 v[200:203], v3, s[32:35], s9 offen offset:2048 sc1
    s_add_u32 s9, s9, 4096
    buffer_load_dwordx4 v[188:191], v3, s[32:35], s9 offen sc1
    buffer_load_dwordx4 v[204:207], v3, s[32:35], s9 offen offset:2048 sc1
    v_bfe_u32 v6, v0, 1, 4
    s_mov_b32 s9, 33024
    v_mul_u32_u24 v6, s9, v6
    v_and_b32 v3, 1, v0
    v_lshl_add_u32 v6, v3, 5, v6
    v_bfe_u32 v3, v0, 5, 1
    v_lshl_add_u32 v6, v3, 4, v6
    s_lshl_b32 s8, s10, 7
    s_lshl_b32 s9, s11, 6
    s_add_u32 s8, s8, s9
    s_add_u32 s8, s8, 33554432
    s_setprio 3
    s_movk_i32 s96, 999
    s_branch F2_entry
L_f2ret:
    s_mov_b32 s44, s16
    s_and_b32 s45, s17, 0xffff
    s_mov_b32 s46, 0x700000
    s_mov_b32 s47, 0x20000
    v_and_b32 v1, 63, v0
    v_lshlrev_b32 v251, 4, v1
    v_lshrrev_b32 v2, 4, v1
    v_bfe_u32 v3, v1, 1, 3
    v_xor_b32 v3, v3, v2
    v_lshlrev_b32 v3, 5, v3
    v_and_b32 v4, 1, v1
    v_lshl_add_u32 v3, v4, 4, v3
    v_lshl_add_u32 v196, v2, 11, v3
    v_xor_b32 v197, 128, v196
    v_add_u32 v197, 7168, v197
    v_add_u32 v198, 14336, v196
    v_add_u32 v199, 14336, v197
    v_add_u32 v200, 32768, v196
    v_add_u32 v201, 32768, v197
    v_add_u32 v202, 32768, v198
    v_add_u32 v203, 32768, v199
    v_add_u32 v195, 4096, v251
    v_lshl_add_u32 v2, v1, 1, s3
    v_subrev_u32 v3, 21, v2
    v_mul_u32_u24 v4, 52, v3
    v_lshrrev_b32 v4, 8, v4
    v_mul_u32_u24 v5, 5, v4
    v_sub_u32 v5, v3, v5
    v_lshlrev_b32 v5, 2, v5
    s_mov_b32 s51, 0x36251
    v_lshrrev_b32 v5, v5, s51
    v_and_b32 v5, 15, v5
    v_add_u32 v4, 1, v4
    v_mov_b32 v194, 8
    v_mov_b32 v6, s73
    v_subrev_u32 v3, 5, v2
    v_lshrrev_b32 v3, 1, v3
    v_cmp_gt_u32 vcc, 21, v2
    s_nop 1
    v_cndmask_b32 v4, v4, v3, vcc
    v_cndmask_b32 v5, v5, v6, vcc
    v_cndmask_b32 v194, v194, 0, vcc
    v_cmp_gt_u32 vcc, 7, v2
    s_nop 1
    v_cndmask_b32 v4, v4, 0, vcc
    v_cndmask_b32 v5, v5, v2, vcc
    v_lshlrev_b32 v4, 2, v4
    v_lshrrev_b32 v4, v4, s69
    v_and_b32 v4, 15, v4
    s_and_b32 s51, s69, 7
    v_xor_b32 v3, s51, v4
    v_cmp_gt_u32 vcc, 21, v2
    s_nop 1
    v_cndmask_b32 v3, v3, v4, vcc
    v_add_u32 v194, v194, v3
    v_mad_u32_u24 v4, v4, 7, v5
    v_lshl_add_u32 v192, v4, 13, s74
    v_lshl_add_u32 v193, v4, 16, s59
    s_setprio 3
    s_mov_b32 s36, 1
    s_mov_b32 s37, 59801601
    s_mov_b32 s38, 60293120
    s_mov_b32 s39, 0
    s_mov_b32 s48, 0
    v_mov_b32 v190, 0x7ff00000
    v_mov_b32 v2, s64
    v_mov_b32 v3, 0
    s_xor_b32 s51, s3, 1
    s_lshl_b32 s51, s51, 7
    s_add_u32 s51, s51, s72
    s_load_dword s4, s[24:25], s51 offset:0 glc
    s_load_dword s5, s[24:25], s51 offset:512 glc
    s_load_dword s6, s[24:25], s51 offset:1024 glc
    s_load_dword s7, s[24:25], s51 offset:1536 glc
    s_load_dword s8, s[24:25], s51 offset:2048 glc
    s_load_dword s9, s[24:25], s51 offset:2560 glc
    s_load_dword s10, s[24:25], s51 offset:3072 glc
    s_load_dword s11, s[24:25], s51 offset:3584 glc
    s_branch L_f2back
L_xa:
    v_mov_b32 v4, 155916
    v_mov_b32 v5, 1
    ds_add_rtn_u32 v4, v4, v5
    s_waitcnt lgkmcnt(0)
    v_readfirstlane_b32 s50, v4
    s_nop 0
    s_cmp_eq_u32 s50, 2
    s_cselect_b32 s37, s37, 60293120
    buffer_store_byte v5, v3, s[32:35], s37 offen sc0 sc1
    s_branch L_xc
K_worker:
    s_sub_u32 s3, s3, 6
    s_setprio 0
    s_mov_b32 s96, 0
    s_mov_b32 s97, 17
    s_mov_b32 s98, 0
    s_mov_b32 s101, 5
    s_mov_b32 s36, s6
    s_and_b32 s37, s7, 0xffff
    s_mov_b32 s38, 0x201000
    s_mov_b32 s39, 0x20000
    s_mov_b32 s40, s8
    s_and_b32 s41, s9, 0xffff
    s_mov_b32 s42, 0x201000
    s_mov_b32 s43, 0x20000
    s_mov_b32 s32, s24
    s_and_b32 s33, s25, 0xffff
    s_mov_b32 s34, 0x10000000
    s_mov_b32 s35, 0x20000
    s_mov_b32 s28, s22
    s_and_b32 s29, s23, 0xffff
    s_mov_b32 s30, 0x100
    s_mov_b32 s31, 0x20000
    s_mov_b32 s58, 0
    s_mov_b32 s65, 0
    v_and_b32 v7, 63, v0
    v_and_b32 v1, 31, v0
    v_bfe_u32 v2, v0, 5, 1
    s_or_b32 s50, s2, s3
    s_cmp_lg_u32 s50, 0
    s_cbranch_scc1 W_nn
    s_memrealtime s[50:51]
    s_waitcnt lgkmcnt(0)
    s_or_b32 s50, s50, 1
    v_mov_b32 v4, s50
    s_mov_b64 exec, 1
    buffer_store_dword v4, off, s[28:31], 0 sc0 sc1
    s_mov_b64 exec, -1
W_nn:
    s_and_b32 s50, s75, 31
    s_lshr_b32 s51, s75, 5
    s_lshl_b32 s51, s51, 7
    s_add_u32 s50, s50, s51
    s_mul_i32 s54, s50, 1026
    s_lshl_b32 s51, s3, 9
    s_add_u32 s57, s54, s51
    s_mov_b32 s55, 1024*1026
    v_lshlrev_b32 v12, 4, v1
    v_mad_u32_u24 v12, v2, s55, v12
    s_mul_i32 s56, s3, 8704
    s_add_u32 s56, s56, 138496
    s_mov_b32 m0, s56
    v_and_b32 v13, 3, v7
    v_bfe_u32 v5, v7, 2, 1
    s_mov_b32 s51, 32832
    v_mul_u32_u24 v13, s51, v13
    v_mad_u32_u24 v13, v5, s55, v13
    v_mov_b32 v15, 0
    s_mov_b32 s44, s16
    s_and_b32 s45, s17, 0xffff
    s_mov_b32 s46, 0x700000
    s_mov_b32 s47, 0x20000
    v_lshlrev_b32 v254, 7, v7
    v_add_u32 v254, 60, v254
    s_mul_i32 s66, s2, 28672
    s_mul_i32 s67, s3, 14336
    s_add_u32 s66, s66, s67
    s_add_u32 s66, s66, 0
    buffer_load_dwordx4 v12, s[36:39], s57 offen nt lds
    s_add_u32 m0, m0, 1088
    s_nop 0
    buffer_load_dwordx4 v12, s[40:43], s57 offen nt lds
    s_add_u32 m0, m0, 1088
    s_add_u32 s57, s57, 32832
    buffer_load_dwordx4 v12, s[36:39], s57 offen nt lds
    s_add_u32 m0, m0, 1088
    s_nop 0
    buffer_load_dwordx4 v12, s[40:43], s57 offen nt lds
    s_add_u32 m0, m0, 1088
    s_add_u32 s57, s57, 32832
    buffer_load_dwordx4 v12, s[36:39], s57 offen nt lds
    s_add_u32 m0, m0, 1088
    s_nop 0
    buffer_load_dwordx4 v12, s[40:43], s57 offen nt lds
    s_add_u32 m0, m0, 1088
    s_add_u32 s57, s57, 32832
    buffer_load_dwordx4 v12, s[36:39], s57 offen nt lds
    s_add_u32 m0, m0, 1088
    s_nop 0
    buffer_load_dwordx4 v12, s[40:43], s57 offen nt lds
    s_mov_b64 exec, 0xff
    buffer_load_ushort v14, v13, s[36:39], s54 offen offset:1024
    buffer_load_short_d16_hi v15, v13, s[40:43], s54 offen offset:1024
    s_mov_b64 exec, -1
    s_lshl_b32 s50, s60, 1
    s_add_u32 s50, s50, s63
    s_lshl_b32 s50, s50, 3
    s_and_b32 s51, s61, 7
    s_add_u32 s50, s50, s51
    s_lshl_b32 s50, s50, 9
    s_add_u32 s50, s50, 60030976
    v_and_b32 v253, 63, v0
    v_lshlrev_b32 v253, 7, v253
    v_add_u32 v253, s50, v253
    s_lshr_b32 s50, s2, 2
    s_lshl_b32 s50, s50, 7
    s_and_b32 s51, s2, 3
    s_lshl2_add_u32 s50, s51, s50
    s_add_u32 s50, s50, 59768832
    v_writelane_b32 v253, s50, 3
    s_lshl_b32 s50, s61, 1
    s_add_u32 s50, s50, s3
    s_lshl_b32 s50, s50, 4
    s_add_u32 s50, s50, s60
    s_lshl_b32 s50, s50, 7
    s_add_u32 s50, s50, 59899904
    v_writelane_b32 v253, s50, 4
    s_mov_b64 exec, 31
    buffer_load_dword v252, v253, s[32:35], 0 offen sc1
    s_mov_b64 exec, -1
    v_bfe_u32 v3, v7, 2, 2
    v_mul_u32_u24 v3, 1088, v3
    v_lshl_add_u32 v3, v2, 9, v3
    v_bfe_u32 v4, v7, 4, 1
    v_lshl_add_u32 v3, v4, 5, v3
    v_and_b32 v4, 3, v7
    v_lshl_add_u32 v3, v4, 3, v3
    v_add_u32 v3, s56, v3
    v_mov_b32 v241, v1
    v_lshrrev_b32 v240, 1, v241
    v_lshlrev_b32 v240, 14, v240
    v_and_b32 v241, 1, v241
    v_lshl_add_u32 v240, v241, 5, v240
    v_lshl_add_u32 v240, v2, 4, v240
    s_lshl_b32 s68, s75, 6
    s_add_u32 s68, s68, 25165824
    s_lshl_b32 s69, s3, 21
    s_add_u32 s69, s69, s68
    s_add_u32 s68, s68, 4194304
    v_bfe_u32 v241, v7, 2, 1
    v_lshlrev_b32 v241, 4, v241
    v_lshl_add_u32 v241, v4, 2, v241
    v_lshrrev_b32 v5, 2, v7
    v_lshlrev_b32 v5, 14, v5
    v_lshl_add_u32 v5, v4, 4, v5
    s_lshl_b32 s52, s75, 6
    s_lshl_b32 s53, s3, 21
    s_add_u32 s53, s53, s52
    s_add_u32 s70, s53, 16777216
    s_add_u32 s71, s52, 20971520
    v_lshlrev_b32 v8, 4, v7
    v_add_u32 v10, 155968, v8
    v_lshrrev_b32 v8, 1, v7
    v_lshlrev_b32 v8, 4, v8
    v_and_b32 v9, 1, v7
    v_lshl_add_u32 v8, v9, 9, v8
    s_lshl_b32 s72, s3, 13
    s_add_u32 s72, s72, 107520
    v_add_u32 v4, s72, v8
    v_add_u32 v9, 123904, v8
    s_and_b32 s72, s75, 31
    s_lshr_b32 s73, s75, 5
    s_lshl_b32 s73, s73, 7
    s_add_u32 s72, s72, s73
    s_lshl_b32 s72, s72, 4
    s_add_u32 s72, s72, 58720256
    v_lshlrev_b32 v11, 9, v7
    v_lshlrev_b32 v7, 4, v7
    s_setprio 0
    v_lshlrev_b32 v242, 2, v2
    v_mul_u32_u24 v242, v242, v1
    v_mad_u32_u24 v244, v1, 0, v242
    v_cvt_f32_u32 v244, v244
    v_mul_f32 v245, 0x3d000000, v244
    v_mul_f32 v244, 0x3a800000, v244
    v_fract_f32 v245, v245
    v_cos_f32 v246, v245
    v_sin_f32 v247, v245
    v_cos_f32 v48, v244
    v_sin_f32 v49, v244
    v_cvt_pk_bf16_f32 v16, v246, v247
    v_cvt_pk_bf16_f32 v32, -v247, v246
    v_mad_u32_u24 v248, v1, 1, v242
    v_cvt_f32_u32 v248, v248
    v_mul_f32 v249, 0x3d000000, v248
    v_mul_f32 v248, 0x3a800000, v248
    v_fract_f32 v249, v249
    v_cos_f32 v250, v249
    v_sin_f32 v251, v249
    v_cos_f32 v50, v248
    v_sin_f32 v51, v248
    v_cvt_pk_bf16_f32 v17, v250, v251
    v_cvt_pk_bf16_f32 v33, -v251, v250
    v_mad_u32_u24 v244, v1, 2, v242
    v_cvt_f32_u32 v244, v244
    v_mul_f32 v245, 0x3d000000, v244
    v_mul_f32 v244, 0x3a800000, v244
    v_fract_f32 v245, v245
    v_cos_f32 v246, v245
    v_sin_f32 v247, v245
    v_cos_f32 v52, v244
    v_sin_f32 v53, v244
    v_cvt_pk_bf16_f32 v18, v246, v247
    v_cvt_pk_bf16_f32 v34, -v247, v246
    v_mad_u32_u24 v248, v1, 3, v242
    v_cvt_f32_u32 v248, v248
    v_mul_f32 v249, 0x3d000000, v248
    v_mul_f32 v248, 0x3a800000, v248
    v_fract_f32 v249, v249
    v_cos_f32 v250, v249
    v_sin_f32 v251, v249
    v_cos_f32 v54, v248
    v_sin_f32 v55, v248
    v_cvt_pk_bf16_f32 v19, v250, v251
    v_cvt_pk_bf16_f32 v35, -v251, v250
    v_mad_u32_u24 v244, v1, 8, v242
    v_cvt_f32_u32 v244, v244
    v_mul_f32 v245, 0x3d000000, v244
    v_mul_f32 v244, 0x3a800000, v244
    v_fract_f32 v245, v245
    v_cos_f32 v246, v245
    v_sin_f32 v247, v245
    v_cos_f32 v56, v244
    v_sin_f32 v57, v244
    v_cvt_pk_bf16_f32 v20, v246, v247
    v_cvt_pk_bf16_f32 v36, -v247, v246
    v_mad_u32_u24 v248, v1, 9, v242
    v_cvt_f32_u32 v248, v248
    v_mul_f32 v249, 0x3d000000, v248
    v_mul_f32 v248, 0x3a800000, v248
    v_fract_f32 v249, v249
    v_cos_f32 v250, v249
    v_sin_f32 v251, v249
    v_cos_f32 v58, v248
    v_sin_f32 v59, v248
    v_cvt_pk_bf16_f32 v21, v250, v251
    v_cvt_pk_bf16_f32 v37, -v251, v250
    v_mad_u32_u24 v244, v1, 10, v242
    v_cvt_f32_u32 v244, v244
    v_mul_f32 v245, 0x3d000000, v244
    v_mul_f32 v244, 0x3a800000, v244
    v_fract_f32 v245, v245
    v_cos_f32 v246, v245
    v_sin_f32 v247, v245
    v_cos_f32 v60, v244
    v_sin_f32 v61, v244
    v_cvt_pk_bf16_f32 v22, v246, v247
    v_cvt_pk_bf16_f32 v38, -v247, v246
    v_mad_u32_u24 v248, v1, 11, v242
    v_cvt_f32_u32 v248, v248
    v_mul_f32 v249, 0x3d000000, v248
    v_mul_f32 v248, 0x3a800000, v248
    v_fract_f32 v249, v249
    v_cos_f32 v250, v249
    v_sin_f32 v251, v249
    v_cos_f32 v62, v248
    v_sin_f32 v63, v248
    v_cvt_pk_bf16_f32 v23, v250, v251
    v_cvt_pk_bf16_f32 v39, -v251, v250
    v_mad_u32_u24 v244, v1, 16, v242
    v_cvt_f32_u32 v244, v244
    v_mul_f32 v245, 0x3d000000, v244
    v_mul_f32 v244, 0x3a800000, v244
    v_fract_f32 v245, v245
    v_cos_f32 v246, v245
    v_sin_f32 v247, v245
    v_cos_f32 v64, v244
    v_sin_f32 v65, v244
    v_cvt_pk_bf16_f32 v24, v246, v247
    v_cvt_pk_bf16_f32 v40, -v247, v246
    v_mad_u32_u24 v248, v1, 17, v242
    v_cvt_f32_u32 v248, v248
    v_mul_f32 v249, 0x3d000000, v248
    v_mul_f32 v248, 0x3a800000, v248
    v_fract_f32 v249, v249
    v_cos_f32 v250, v249
    v_sin_f32 v251, v249
    v_cos_f32 v66, v248
    v_sin_f32 v67, v248
    v_cvt_pk_bf16_f32 v25, v250, v251
    v_cvt_pk_bf16_f32 v41, -v251, v250
    v_mad_u32_u24 v244, v1, 18, v242
    v_cvt_f32_u32 v244, v244
    v_mul_f32 v245, 0x3d000000, v244
    v_mul_f32 v244, 0x3a800000, v244
    v_fract_f32 v245, v245
    v_cos_f32 v246, v245
    v_sin_f32 v247, v245
    v_cos_f32 v68, v244
    v_sin_f32 v69, v244
    v_cvt_pk_bf16_f32 v26, v246, v247
    v_cvt_pk_bf16_f32 v42, -v247, v246
    v_mad_u32_u24 v248, v1, 19, v242
    v_cvt_f32_u32 v248, v248
    v_mul_f32 v249, 0x3d000000, v248
    v_mul_f32 v248, 0x3a800000, v248
    v_fract_f32 v249, v249
    v_cos_f32 v250, v249
    v_sin_f32 v251, v249
    v_cos_f32 v70, v248
    v_sin_f32 v71, v248
    v_cvt_pk_bf16_f32 v27, v250, v251
    v_cvt_pk_bf16_f32 v43, -v251, v250
    v_mad_u32_u24 v244, v1, 24, v242
    v_cvt_f32_u32 v244, v244
    v_mul_f32 v245, 0x3d000000, v244
    v_mul_f32 v244, 0x3a800000, v244
    v_fract_f32 v245, v245
    v_cos_f32 v246, v245
    v_sin_f32 v247, v245
    v_cos_f32 v72, v244
    v_sin_f32 v73, v244
    v_cvt_pk_bf16_f32 v28, v246, v247
    v_cvt_pk_bf16_f32 v44, -v247, v246
    v_mad_u32_u24 v248, v1, 25, v242
    v_cvt_f32_u32 v248, v248
    v_mul_f32 v249, 0x3d000000, v248
    v_mul_f32 v248, 0x3a800000, v248
    v_fract_f32 v249, v249
    v_cos_f32 v250, v249
    v_sin_f32 v251, v249
    v_cos_f32 v74, v248
    v_sin_f32 v75, v248
    v_cvt_pk_bf16_f32 v29, v250, v251
    v_cvt_pk_bf16_f32 v45, -v251, v250
    v_mad_u32_u24 v244, v1, 26, v242
    v_cvt_f32_u32 v244, v244
    v_mul_f32 v245, 0x3d000000, v244
    v_mul_f32 v244, 0x3a800000, v244
    v_fract_f32 v245, v245
    v_cos_f32 v246, v245
    v_sin_f32 v247, v245
    v_cos_f32 v76, v244
    v_sin_f32 v77, v244
    v_cvt_pk_bf16_f32 v30, v246, v247
    v_cvt_pk_bf16_f32 v46, -v247, v246
    v_mad_u32_u24 v248, v1, 27, v242
    v_cvt_f32_u32 v248, v248
    v_mul_f32 v249, 0x3d000000, v248
    v_mul_f32 v248, 0x3a800000, v248
    v_fract_f32 v249, v249
    v_cos_f32 v250, v249
    v_sin_f32 v251, v249
    v_cos_f32 v78, v248
    v_sin_f32 v79, v248
    v_cvt_pk_bf16_f32 v31, v250, v251
    v_cvt_pk_bf16_f32 v47, -v251, v250
    v_lshl_add_u32 v243, v2, 7, v1
    v_cvt_f32_u32 v243, v243
    v_mul_f32 v243, 0x3a000000, v243
    v_add_f32 v244, 0x0, v243
    v_cos_f32 v208, v244
    v_sin_f32 v209, v244
    v_add_f32 v245, 0x3c800000, v243
    v_cos_f32 v210, v245
    v_sin_f32 v211, v245
    v_add_f32 v246, 0x3d000000, v243
    v_cos_f32 v212, v246
    v_sin_f32 v213, v246
    v_add_f32 v247, 0x3d400000, v243
    v_cos_f32 v214, v247
    v_sin_f32 v215, v247
    v_add_f32 v244, 0x3e000000, v243
    v_cos_f32 v216, v244
    v_sin_f32 v217, v244
    v_add_f32 v245, 0x3e100000, v243
    v_cos_f32 v218, v245
    v_sin_f32 v219, v245
    v_add_f32 v246, 0x3e200000, v243
    v_cos_f32 v220, v246
    v_sin_f32 v221, v246
    v_add_f32 v247, 0x3e300000, v243
    v_cos_f32 v222, v247
    v_sin_f32 v223, v247
    v_add_f32 v244, 0x3e800000, v243
    v_cos_f32 v224, v244
    v_sin_f32 v225, v244
    v_add_f32 v245, 0x3e880000, v243
    v_cos_f32 v226, v245
    v_sin_f32 v227, v245
    v_add_f32 v246, 0x3e900000, v243
    v_cos_f32 v228, v246
    v_sin_f32 v229, v246
    v_add_f32 v247, 0x3e980000, v243
    v_cos_f32 v230, v247
    v_sin_f32 v231, v247
    v_add_f32 v244, 0x3ec00000, v243
    v_cos_f32 v232, v244
    v_sin_f32 v233, v244
    v_add_f32 v245, 0x3ec80000, v243
    v_cos_f32 v234, v245
    v_sin_f32 v235, v245
    v_add_f32 v246, 0x3ed00000, v243
    v_cos_f32 v236, v246
    v_sin_f32 v237, v246
    v_add_f32 v247, 0x3ed80000, v243
    v_cos_f32 v238, v247
    v_sin_f32 v239, v247
    v_mov_b32 v6, 0
    s_mov_b64 exec, 0
    s_cmp_eq_u32 s3, 0
    s_cbranch_scc1 HOPSa_0
    s_branch HOPSa_1
HOPSa_ret:
    s_mov_b64 exec, -1
    s_mov_b32 s59, 0
    v_mov_b32 v242, 155936
W_w0:
    s_getreg_b32 s99, hwreg(HW_REG_IB_STS)
    s_and_b32 s99, s99, 0xc0000f
    s_cbranch_scc0 W_w1
    ds_read_b32 v243, v242
    s_waitcnt lgkmcnt(0)
    v_readfirstlane_b32 s99, v243
    s_nop 0
    s_cmp_lg_u32 s99, 0
    s_cbranch_scc1 W_w2
    s_sleep 1
    s_sub_u32 s79, s79, 1
    s_cbranch_scc0 W_w0
    s_movk_i32 s78, 16
    s_branch K_bail
W_w1:
    s_waitcnt vmcnt(0)
    s_setprio 3
    s_mov_b32 s59, 1
    ds_read_b64_tr_b16 v[112:113], v3 offset:0
    ds_read_b64_tr_b16 v[114:115], v3 offset:4352
    ds_read_b64_tr_b16 v[116:117], v3 offset:64
    ds_read_b64_tr_b16 v[118:119], v3 offset:4416
    ds_read_b64_tr_b16 v[120:121], v3 offset:128
    ds_read_b64_tr_b16 v[122:123], v3 offset:4480
    ds_read_b64_tr_b16 v[124:125], v3 offset:192
    ds_read_b64_tr_b16 v[126:127], v3 offset:4544
    ds_read_b64_tr_b16 v[128:129], v3 offset:256
    ds_read_b64_tr_b16 v[130:131], v3 offset:4608
    ds_read_b64_tr_b16 v[132:133], v3 offset:320
    ds_read_b64_tr_b16 v[134:135], v3 offset:4672
    ds_read_b64_tr_b16 v[136:137], v3 offset:384
    ds_read_b64_tr_b16 v[138:139], v3 offset:4736
    ds_read_b64_tr_b16 v[140:141], v3 offset:448
    ds_read_b64_tr_b16 v[142:143], v3 offset:4800
    v_or_b32 v14, v14, v15
    s_waitcnt lgkmcnt(14)
    buffer_store_dwordx4 v[112:115], v240, s[32:35], s69 offen sc1
    s_add_u32 s69, s69, 262144
    s_waitcnt lgkmcnt(12)
    buffer_store_dwordx4 v[116:119], v240, s[32:35], s69 offen sc1
    s_add_u32 s69, s69, 262144
    s_waitcnt lgkmcnt(10)
    buffer_store_dwordx4 v[120:123], v240, s[32:35], s69 offen sc1
    s_add_u32 s69, s69, 262144
    s_waitcnt lgkmcnt(8)
    buffer_store_dwordx4 v[124:127], v240, s[32:35], s69 offen sc1
    s_add_u32 s69, s69, 262144
    s_waitcnt lgkmcnt(6)
    buffer_store_dwordx4 v[128:131], v240, s[32:35], s69 offen sc1
    s_add_u32 s69, s69, 262144
    s_waitcnt lgkmcnt(4)
    buffer_store_dwordx4 v[132:135], v240, s[32:35], s69 offen sc1
    s_add_u32 s69, s69, 262144
    s_waitcnt lgkmcnt(2)
    buffer_store_dwordx4 v[136:139], v240, s[32:35], s69 offen sc1
    s_add_u32 s69, s69, 262144
    s_waitcnt lgkmcnt(0)
    buffer_store_dwordx4 v[140:143], v240, s[32:35], s69 offen sc1
    s_mov_b64 exec, 0xff
    buffer_store_dword v14, v241, s[32:35], s68 offen sc0 sc1
    s_mov_b64 exec, -1
W_w2:
    s_setprio 3
    buffer_load_dword v6, off, s[28:31], 0 sc1
    s_mov_b32 s98, 0
    s_cmp_lt_u32 s96, s97
    s_cbranch_scc0 WB_23
    s_barrier
    s_add_u32 s96, s96, 1
    s_mov_b32 s98, s101
WB_23:
    ds_read_b128 v[144:147], v4 offset:0
    ds_read_b128 v[148:151], v4 offset:1024
    ds_read_b128 v[152:155], v4 offset:2048
    ds_read_b128 v[156:159], v4 offset:3072
    ds_read_b128 v[160:163], v4 offset:4096
    ds_read_b128 v[164:167], v4 offset:5120
    ds_read_b128 v[168:171], v4 offset:6144
    ds_read_b128 v[172:175], v4 offset:7168
    ds_read_b128 v[176:179], v9
    ds_read_b128 v[180:183], v10
    v_mov_b32 v8, 155920
    v_mov_b32 v9, 1
    s_waitcnt lgkmcnt(0)
    s_mov_b64 exec, 1
    ds_add_u32 v8, v9
    s_mov_b64 exec, -1
    buffer_store_dwordx4 v[144:147], v5, s[32:35], s70 offen sc1
    s_sub_u32 s98, s98, 2
    s_cbranch_scc0 WB_24
    s_mov_b32 s98, 0
    s_cmp_lt_u32 s96, s97
    s_cbranch_scc0 WB_24
    s_barrier
    s_add_u32 s96, s96, 1
    s_mov_b32 s98, s101
WB_24:
    s_add_u32 s70, s70, 262144
    buffer_store_dwordx4 v[148:151], v5, s[32:35], s70 offen sc1
    s_add_u32 s70, s70, 262144
    s_mov_b32 s98, 0
    s_cmp_lt_u32 s96, s97
    s_cbranch_scc0 WB_25
    s_barrier
    s_add_u32 s96, s96, 1
    s_mov_b32 s98, s101
WB_25:
    buffer_store_dwordx4 v[152:155], v5, s[32:35], s70 offen sc1
    s_add_u32 s70, s70, 262144
    buffer_store_dwordx4 v[156:159], v5, s[32:35], s70 offen sc1
    s_sub_u32 s98, s98, 2
    s_cbranch_scc0 WB_26
    s_mov_b32 s98, 0
    s_cmp_lt_u32 s96, s97
    s_cbranch_scc0 WB_26
    s_barrier
    s_add_u32 s96, s96, 1
    s_mov_b32 s98, s101
WB_26:
    s_add_u32 s70, s70, 262144
    s_mov_b32 s98, 0
    s_cmp_lt_u32 s96, s97
    s_cbranch_scc0 WB_27
    s_barrier
    s_add_u32 s96, s96, 1
    s_mov_b32 s98, s101
WB_27:
    buffer_store_dwordx4 v[160:163], v5, s[32:35], s70 offen sc1
    s_add_u32 s70, s70, 262144
    buffer_store_dwordx4 v[164:167], v5, s[32:35], s70 offen sc1
    s_sub_u32 s98, s98, 2
    s_cbranch_scc0 WB_28
    s_mov_b32 s98, 0
    s_cmp_lt_u32 s96, s97
    s_cbranch_scc0 WB_28
    s_barrier
    s_add_u32 s96, s96, 1
    s_mov_b32 s98, s101
WB_28:
    s_add_u32 s70, s70, 262144
    s_mov_b32 s98, 0
    s_cmp_lt_u32 s96, s97
    s_cbranch_scc0 WB_29
    s_barrier
    s_add_u32 s96, s96, 1
    s_mov_b32 s98, s101
WB_29:
    buffer_store_dwordx4 v[168:171], v5, s[32:35], s70 offen sc1
    s_add_u32 s70, s70, 262144
    buffer_store_dwordx4 v[172:175], v5, s[32:35], s70 offen sc1
    s_mov_b32 s98, 0
    s_cmp_lt_u32 s96, s97
    s_cbranch_scc0 WB_30
    s_barrier
    s_add_u32 s96, s96, 1
    s_mov_b32 s98, s101
WB_30:
    s_mov_b64 exec, 0xf
    buffer_store_dwordx4 v[176:179], v5, s[32:35], s71 offen sc1
    s_mov_b64 exec, -1
WV_1:
    s_getreg_b32 s99, hwreg(HW_REG_IB_STS, 22, 2)
    s_getreg_b32 s100, hwreg(HW_REG_IB_STS, 0, 4)
    s_lshl4_add_u32 s99, s99, s100
    s_cmp_le_u32 s99, 9
    s_cbranch_scc1 WV_1_ok
    s_sleep 1
    s_sub_u32 s98, s98, 1
    s_cbranch_scc0 WB_2
    s_mov_b32 s98, 0
    s_cmp_lt_u32 s96, s97
    s_cbranch_scc0 WB_2
    s_barrier
    s_add_u32 s96, s96, 1
    s_mov_b32 s98, s101
WB_2:
    s_sub_u32 s79, s79, 1
    s_cbranch_scc0 WV_1
    s_movk_i32 s78, 17
    s_branch K_bail
WV_1_ok:
    s_waitcnt vmcnt(9)
W_non:
    v_readfirstlane_b32 s64, v6
    s_nop 0
    s_cmp_lg_u32 s64, 0
    s_cbranch_scc1 W_nok
    buffer_load_dword v6, off, s[28:31], 0 sc1
WV_3:
    s_getreg_b32 s99, hwreg(HW_REG_IB_STS)
    s_and_b32 s99, s99, 0xc0000f
    s_cbranch_scc0 WV_3_ok
    s_sleep 1
    s_sub_u32 s98, s98, 1
    s_cbranch_scc0 WB_4
    s_mov_b32 s98, 0
    s_cmp_lt_u32 s96, s97
    s_cbranch_scc0 WB_4
    s_barrier
    s_add_u32 s96, s96, 1
    s_mov_b32 s98, s101
WB_4:
    s_sub_u32 s79, s79, 1
    s_cbranch_scc0 WV_3
    s_movk_i32 s78, 18
    s_branch K_bail
WV_3_ok:
    s_waitcnt vmcnt(0)
    s_sub_u32 s98, s98, 2
    s_cbranch_scc0 WB_31
    s_mov_b32 s98, 0
    s_cmp_lt_u32 s96, s97
    s_cbranch_scc0 WB_31
    s_barrier
    s_add_u32 s96, s96, 1
    s_mov_b32 s98, s101
WB_31:
    s_sub_u32 s79, s79, 1
    s_cbranch_scc0 W_non
    s_movk_i32 s78, 19
    s_branch K_bail
W_nok:
    s_and_b32 s50, s64, 0xffff
    s_lshr_b32 s51, s64, 16
    v_or_b32 v180, s50, v180
    v_or_b32 v181, s51, v181
    v_or_b32 v182, s50, v182
    v_or_b32 v183, s51, v183
    v_mov_b32 v8, 155904
    s_mov_b64 exec, 0xf
    buffer_store_dwordx4 v[180:183], v11, s[32:35], s72 offen sc1
    s_mov_b64 exec, 1
    ds_write_b32 v8, v6
    s_sub_u32 s98, s98, 2
    s_cbranch_scc0 WB_32
    s_mov_b32 s98, 0
    s_cmp_lt_u32 s96, s97
    s_cbranch_scc0 WB_32
    s_barrier
    s_add_u32 s96, s96, 1
    s_mov_b32 s98, s101
WB_32:
    s_mov_b64 exec, -1
    s_cmp_lg_u32 s59, 0
    s_cbranch_scc1 W_w3
    ds_read_b64_tr_b16 v[112:113], v3 offset:0
    ds_read_b64_tr_b16 v[114:115], v3 offset:4352
    ds_read_b64_tr_b16 v[116:117], v3 offset:64
    ds_read_b64_tr_b16 v[118:119], v3 offset:4416
    ds_read_b64_tr_b16 v[120:121], v3 offset:128
    ds_read_b64_tr_b16 v[122:123], v3 offset:4480
    ds_read_b64_tr_b16 v[124:125], v3 offset:192
    ds_read_b64_tr_b16 v[126:127], v3 offset:4544
    ds_read_b64_tr_b16 v[128:129], v3 offset:256
    ds_read_b64_tr_b16 v[130:131], v3 offset:4608
    ds_read_b64_tr_b16 v[132:133], v3 offset:320
    ds_read_b64_tr_b16 v[134:135], v3 offset:4672
    ds_read_b64_tr_b16 v[136:137], v3 offset:384
    ds_read_b64_tr_b16 v[138:139], v3 offset:4736
    ds_read_b64_tr_b16 v[140:141], v3 offset:448
    ds_read_b64_tr_b16 v[142:143], v3 offset:4800
    v_or_b32 v14, v14, v15
    s_waitcnt lgkmcnt(14)
    buffer_store_dwordx4 v[112:115], v240, s[32:35], s69 offen sc1
    s_sub_u32 s98, s98, 2
    s_cbranch_scc0 WB_33
    s_mov_b32 s98, 0
    s_cmp_lt_u32 s96, s97
    s_cbranch_scc0 WB_33
    s_barrier
    s_add_u32 s96, s96, 1
    s_mov_b32 s98, s101
WB_33:
    s_add_u32 s69, s69, 262144
    s_waitcnt lgkmcnt(12)
    buffer_store_dwordx4 v[116:119], v240, s[32:35], s69 offen sc1
    s_add_u32 s69, s69, 262144
    s_mov_b32 s98, 0
    s_cmp_lt_u32 s96, s97
    s_cbranch_scc0 WB_34
    s_barrier
    s_add_u32 s96, s96, 1
    s_mov_b32 s98, s101
WB_34:
    s_waitcnt lgkmcnt(10)
    buffer_store_dwordx4 v[120:123], v240, s[32:35], s69 offen sc1
    s_add_u32 s69, s69, 262144
    s_waitcnt lgkmcnt(8)
    buffer_store_dwordx4 v[124:127], v240, s[32:35], s69 offen sc1
    s_sub_u32 s98, s98, 2
    s_cbranch_scc0 WB_35
    s_mov_b32 s98, 0
    s_cmp_lt_u32 s96, s97
    s_cbranch_scc0 WB_35
    s_barrier
    s_add_u32 s96, s96, 1
    s_mov_b32 s98, s101
WB_35:
    s_add_u32 s69, s69, 262144
    s_mov_b32 s98, 0
    s_cmp_lt_u32 s96, s97
    s_cbranch_scc0 WB_36
    s_barrier
    s_add_u32 s96, s96, 1
    s_mov_b32 s98, s101
WB_36:
    s_waitcnt lgkmcnt(6)
    buffer_store_dwordx4 v[128:131], v240, s[32:35], s69 offen sc1
    s_add_u32 s69, s69, 262144
    s_waitcnt lgkmcnt(4)
    buffer_store_dwordx4 v[132:135], v240, s[32:35], s69 offen sc1
    s_sub_u32 s98, s98, 2
    s_cbranch_scc0 WB_37
    s_mov_b32 s98, 0
    s_cmp_lt_u32 s96, s97
    s_cbranch_scc0 WB_37
    s_barrier
    s_add_u32 s96, s96, 1
    s_mov_b32 s98, s101
WB_37:
    s_add_u32 s69, s69, 262144
    s_mov_b32 s98, 0
    s_cmp_lt_u32 s96, s97
    s_cbranch_scc0 WB_38
    s_barrier
    s_add_u32 s96, s96, 1
    s_mov_b32 s98, s101
WB_38:
    s_waitcnt lgkmcnt(2)
    buffer_store_dwordx4 v[136:139], v240, s[32:35], s69 offen sc1
    s_add_u32 s69, s69, 262144
    s_waitcnt lgkmcnt(0)
    buffer_store_dwordx4 v[140:143], v240, s[32:35], s69 offen sc1
    s_mov_b32 s98, 0
    s_cmp_lt_u32 s96, s97
    s_cbranch_scc0 WB_39
    s_barrier
    s_add_u32 s96, s96, 1
    s_mov_b32 s98, s101
WB_39:
    s_mov_b64 exec, 0xff
    buffer_store_dword v14, v241, s[32:35], s68 offen sc0 sc1
    s_mov_b64 exec, -1
W_w3:
    s_lshl_b32 s50, s2, 1
    s_add_u32 s50, s50, s3
    s_sub_u32 s50, s50, 32
    s_cmp_lt_u32 s50, 1
    s_cbranch_scc0 W_zi
    s_lshl_b32 s50, s50, 10
    s_add_u32 s50, s50, 59801600
    v_mov_b32 v8, 0
    v_mov_b32 v9, 0
    v_mov_b32 v10, 0
    v_mov_b32 v11, 0
    buffer_store_dwordx4 v[8:11], v7, s[32:35], s50 offen sc1
W_zi:
    s_sub_u32 s98, s98, 2
    s_cbranch_scc0 WB_40
    s_mov_b32 s98, 0
    s_cmp_lt_u32 s96, s97
    s_cbranch_scc0 WB_40
    s_barrier
    s_add_u32 s96, s96, 1
    s_mov_b32 s98, s101
WB_40:
    s_lshr_b32 s50, s2, 2
    s_lshl_b32 s50, s50, 7
    s_and_b32 s51, s2, 3
    s_lshl2_add_u32 s50, s51, s50
    s_add_u32 s50, s50, 59768832
    s_mov_b32 s51, 1
WV_5:
    s_getreg_b32 s99, hwreg(HW_REG_IB_STS)
    s_and_b32 s99, s99, 0xc0000f
    s_cbranch_scc0 WV_5_ok
    s_sleep 1
    s_sub_u32 s98, s98, 1
    s_cbranch_scc0 WB_6
    s_mov_b32 s98, 0
    s_cmp_lt_u32 s96, s97
    s_cbranch_scc0 WB_6
    s_barrier
    s_add_u32 s96, s96, 1
    s_mov_b32 s98, s101
WB_6:
    s_sub_u32 s79, s79, 1
    s_cbranch_scc0 WV_5
    s_movk_i32 s78, 20
    s_branch K_bail
WV_5_ok:
    s_waitcnt vmcnt(0)
    v_mov_b32 v8, 155912
    v_mov_b32 v9, 1
    s_mov_b64 exec, 1
    ds_add_rtn_u32 v9, v8, v9
    v_mov_b32 v10, s64
    s_waitcnt lgkmcnt(0)
    v_cmp_eq_u32 vcc, s51, v9
    s_cbranch_vccz W_ar1
    buffer_store_dword v10, off, s[32:35], s50 sc0 sc1
W_ar1:
    s_mov_b64 exec, -1
    s_sub_u32 s98, s98, 2
    s_cbranch_scc0 WB_41
    s_mov_b32 s98, 0
    s_cmp_lt_u32 s96, s97
    s_cbranch_scc0 WB_41
    s_barrier
    s_add_u32 s96, s96, 1
    s_mov_b32 s98, s101
WB_41:
    s_mov_b32 s36, s14
    s_and_b32 s37, s15, 0xffff
    s_mov_b32 s38, 0x1c00
    s_mov_b32 s39, 0x20000
    v_and_b32 v8, 0x1f0, v7
    v_cmp_gt_u32 vcc, 448, v8
    v_mov_b32 v9, 0x7ff00000
    s_mul_i32 s57, s61, 448
    v_cndmask_b32 v8, v9, v8, vcc
    s_mul_i32 s59, s3, 224
    v_lshrrev_b32 v9, 1, v8
    s_add_u32 s57, s57, s59
    buffer_load_dwordx2 v[250:251], v9, s[36:39], s57 offen
    s_mov_b32 exec_lo, 0xffffffff
    s_mov_b32 exec_hi, 0xffffff
    buffer_load_dwordx2 v[252:253], v254, s[44:47], s66 offen
    s_mov_b64 exec, -1
    s_add_u32 s66, s66, 7168
    s_mov_b32 s98, 0
    s_cmp_lt_u32 s96, s97
    s_cbranch_scc0 WB_42
    s_barrier
    s_add_u32 s96, s96, 1
    s_mov_b32 s98, s101
WB_42:
    s_mov_b32 s98, 0
    s_cmp_lt_u32 s96, s97
    s_cbranch_scc0 WB_43
    s_barrier
    s_add_u32 s96, s96, 1
    s_mov_b32 s98, s101
WB_43:
    s_mov_b32 exec_lo, 0xffffffff
    s_mov_b32 exec_hi, 0xffffff
    buffer_load_dwordx2 v[252:253], v254, s[44:47], s66 offen
    s_mov_b64 exec, -1
    s_add_u32 s66, s66, 7168
    s_mov_b32 s36, s14
    s_and_b32 s37, s15, 0xffff
    s_mov_b32 s38, 0x1c00
    s_mov_b32 s39, 0x20000
    s_lshl_b32 s50, s61, 1
    s_add_u32 s50, s50, s3
    s_lshl_b32 s73, s50, 11
    s_add_u32 s73, s73, 59899904
    s_and_b32 s10, s2, 7
    s_lshl_b32 s10, s10, 1
    s_and_b32 s11, s2, 0xf0
    s_add_u32 s10, s10, s11
    s_bfe_u32 s11, s2, 0x10003
    s_add_u32 s10, s10, s11
    s_mov_b32 s11, s3
    s_lshr_b32 s50, s2, 3
    s_lshl_b32 s50, s50, 1
    s_add_u32 s50, s50, s3
    s_cmp_lg_u32 s50, 20
    s_cbranch_scc1 W_p1_w
    s_mov_b32 s50, 59768832
    v_lshlrev_b32 v244, 3, v7
W_p1:
    buffer_load_dwordx4 v[240:243], v244, s[32:35], s50 offen sc1
WV_7:
    s_getreg_b32 s99, hwreg(HW_REG_IB_STS)
    s_and_b32 s99, s99, 0xc0000f
    s_cbranch_scc0 WV_7_ok
    s_sleep 1
    s_sub_u32 s98, s98, 1
    s_cbranch_scc0 WB_8
    s_mov_b32 s98, 0
    s_cmp_lt_u32 s96, s97
    s_cbranch_scc0 WB_8
    s_barrier
    s_add_u32 s96, s96, 1
    s_mov_b32 s98, s101
WB_8:
    s_sub_u32 s79, s79, 1
    s_cbranch_scc0 WV_7
    s_movk_i32 s78, 21
    s_branch K_bail
WV_7_ok:
    s_waitcnt vmcnt(0)
    v_xor_b32 v240, s64, v240
    v_xor_b32 v241, s64, v241
    v_xor_b32 v242, s64, v242
    v_xor_b32 v243, s64, v243
    v_or3_b32 v240, v240, v241, v242
    v_or_b32 v240, v240, v243
    v_cmp_ne_u32 vcc, 0, v240
    s_cbranch_vccz W_p1_ok
    s_mov_b64 exec, vcc
    s_sleep 2
    s_sub_u32 s98, s98, 2
    s_cbranch_scc0 WB_44
    s_mov_b32 s98, 0
    s_cmp_lt_u32 s96, s97
    s_cbranch_scc0 WB_44
    s_barrier
    s_add_u32 s96, s96, 1
    s_mov_b32 s98, s101
WB_44:
    s_sub_u32 s79, s79, 1
    s_cbranch_scc0 W_p1
    s_movk_i32 s78, 22
    s_branch K_bail
W_p1_ok:
    s_mov_b64 exec, -1
    s_and_b32 s50, s2, 7
    s_lshl_b32 s50, s50, 7
    s_add_u32 s50, s50, 59965440
    v_lshlrev_b32 v240, 6, v7
    v_mov_b32 v241, s64
    s_mov_b32 exec_hi, 0
    buffer_store_dword v241, v240, s[32:35], s50 offen sc0 sc1
    s_mov_b32 exec_hi, -1
W_p1_w:
    v_lshlrev_b32 v9, 3, v7
W_fc:
    s_mov_b64 exec, 0xffff
    buffer_load_dword v8, v9, s[32:35], s73 offen sc1
    s_mov_b64 exec, -1
WV_9:
    s_getreg_b32 s99, hwreg(HW_REG_IB_STS)
    s_and_b32 s99, s99, 0xc0000f
    s_cbranch_scc0 WV_9_ok
    s_sleep 1
    s_sub_u32 s98, s98, 1
    s_cbranch_scc0 WB_10
    s_mov_b32 s98, 0
    s_cmp_lt_u32 s96, s97
    s_cbranch_scc0 WB_10
    s_barrier
    s_add_u32 s96, s96, 1
    s_mov_b32 s98, s101
WB_10:
    s_sub_u32 s79, s79, 1
    s_cbranch_scc0 WV_9
    s_movk_i32 s78, 23
    s_branch K_bail
WV_9_ok:
    s_waitcnt vmcnt(0)
    s_sub_u32 s98, s98, 2
    s_cbranch_scc0 WB_45
    s_mov_b32 s98, 0
    s_cmp_lt_u32 s96, s97
    s_cbranch_scc0 WB_45
    s_barrier
    s_add_u32 s96, s96, 1
    s_mov_b32 s98, s101
WB_45:
    s_mov_b64 exec, 0xffff
    v_cmp_ne_u32 vcc, s64, v8
    s_mov_b64 exec, -1
    s_cbranch_vccz W_fcok
    s_sub_u32 s79, s79, 1
    s_cbranch_scc0 W_fc
    s_movk_i32 s78, 24
    s_branch K_bail
W_fcok:
    s_lshr_b32 s50, s2, 3
    s_lshl_b32 s50, s50, 1
    s_add_u32 s50, s50, s3
    s_cmp_lg_u32 s50, 20
    s_cbranch_scc0 W_p1_d
    s_lshl_b32 s50, s2, 7
    s_add_u32 s50, s50, 59965440
W_p1_l:
    s_load_dword s51, s[24:25], s50 glc
WL_11:
    s_getreg_b32 s99, hwreg(HW_REG_IB_STS, 8, 4)
    s_cmp_eq_u32 s99, 0
    s_cbranch_scc1 WL_11_ok
    s_sleep 1
    s_sub_u32 s98, s98, 1
    s_cbranch_scc0 WB_12
    s_mov_b32 s98, 0
    s_cmp_lt_u32 s96, s97
    s_cbranch_scc0 WB_12
    s_barrier
    s_add_u32 s96, s96, 1
    s_mov_b32 s98, s101
WB_12:
    s_sub_u32 s79, s79, 1
    s_cbranch_scc0 WL_11
    s_movk_i32 s78, 25
    s_branch K_bail
WL_11_ok:
    s_waitcnt lgkmcnt(0)
    s_cmp_eq_u32 s51, s64
    s_cbranch_scc1 W_p1_d
    s_sleep 1
    s_sub_u32 s98, s98, 1
    s_cbranch_scc0 WB_46
    s_mov_b32 s98, 0
    s_cmp_lt_u32 s96, s97
    s_cbranch_scc0 WB_46
    s_barrier
    s_add_u32 s96, s96, 1
    s_mov_b32 s98, s101
WB_46:
    s_sub_u32 s79, s79, 1
    s_cbranch_scc0 W_p1_l
    s_movk_i32 s78, 26
    s_branch K_bail
W_p1_d:
    v_and_b32 v8, 0x1f0, v7
    v_cmp_gt_u32 vcc, 448, v8
    v_mov_b32 v9, 0x7ff00000
    s_mul_i32 s50, s3, 448
    v_cndmask_b32 v8, v9, v8, vcc
    s_lshl_b32 s51, s61, 14
    s_add_u32 s51, s51, s50
    s_add_u32 s51, s51, 58785792
    v_lshrrev_b32 v9, 1, v8
    v_lshl_add_u32 v8, v2, 13, v8
    s_mul_i32 s57, s61, 448
    s_mul_i32 s59, s3, 224
    s_add_u32 s57, s57, s59
    buffer_load_dwordx4 v[112:115], v8, s[32:35], s51 offen offset:0 sc1
    buffer_load_dwordx4 v[116:119], v8, s[32:35], s51 offen offset:1024 sc1
    buffer_load_dwordx4 v[120:123], v8, s[32:35], s51 offen offset:2048 sc1
    buffer_load_dwordx4 v[124:127], v8, s[32:35], s51 offen offset:3072 sc1
    s_add_u32 s51, s51, 4096
    buffer_load_dwordx4 v[128:131], v8, s[32:35], s51 offen offset:0 sc1
    buffer_load_dwordx4 v[132:135], v8, s[32:35], s51 offen offset:1024 sc1
    buffer_load_dwordx4 v[136:139], v8, s[32:35], s51 offen offset:2048 sc1
    buffer_load_dwordx4 v[140:143], v8, s[32:35], s51 offen offset:3072 sc1
    v_mov_b32 v240, v250
    v_mov_b32 v241, v251
    s_lshl_b32 s51, s60, 10
    s_lshl_b32 s57, s3, 9
    s_add_u32 s51, s51, s57
    s_add_u32 s51, s51, 58720256
    v_lshrrev_b32 v10, 1, v7
W_stl:
    buffer_load_dwordx2 v[242:243], v10, s[32:35], s51 offen sc1
    v_mov_b32 v8, 156032
    v_mov_b32 v9, 1
    s_mov_b64 exec, 1
    ds_add_u32 v8, v9
    s_mov_b64 exec, -1
    v_and_b32 v3, 31, v0
    v_lshlrev_b32 v3, 6, v3
    v_bfe_u32 v6, v0, 5, 1
    v_lshl_add_u32 v3, v6, 4, v3
    s_lshl_b32 s8, s10, 14
    s_lshl_b32 s9, s11, 5
    s_add_u32 s8, s8, s9
    s_add_u32 s9, s8, 25165824
    s_add_u32 s8, s8, 16777216
    buffer_load_dwordx4 v[80:83], v3, s[32:35], s8 offen sc1
    buffer_load_dwordx4 v[96:99], v3, s[32:35], s8 offen offset:2048 sc1
    s_add_u32 s8, s8, 4096
    buffer_load_dwordx4 v[84:87], v3, s[32:35], s8 offen sc1
    buffer_load_dwordx4 v[100:103], v3, s[32:35], s8 offen offset:2048 sc1
    s_add_u32 s8, s8, 4096
    s_mov_b32 s98, 0
    s_cmp_lt_u32 s96, s97
    s_cbranch_scc0 WB_47
    s_barrier
    s_add_u32 s96, s96, 1
    s_mov_b32 s98, s101
WB_47:
    buffer_load_dwordx4 v[88:91], v3, s[32:35], s8 offen sc1
    buffer_load_dwordx4 v[104:107], v3, s[32:35], s8 offen offset:2048 sc1
    s_add_u32 s8, s8, 4096
    buffer_load_dwordx4 v[92:95], v3, s[32:35], s8 offen sc1
    buffer_load_dwordx4 v[108:111], v3, s[32:35], s8 offen offset:2048 sc1
    s_mov_b32 s98, 0
    s_cmp_lt_u32 s96, s97
    s_cbranch_scc0 WB_48
    s_barrier
    s_add_u32 s96, s96, 1
    s_mov_b32 s98, s101
WB_48:
    buffer_load_dwordx4 v[176:179], v3, s[32:35], s9 offen sc1
    buffer_load_dwordx4 v[192:195], v3, s[32:35], s9 offen offset:2048 sc1
    s_add_u32 s9, s9, 4096
    buffer_load_dwordx4 v[180:183], v3, s[32:35], s9 offen sc1
    buffer_load_dwordx4 v[196:199], v3, s[32:35], s9 offen offset:2048 sc1
    s_add_u32 s9, s9, 4096
    s_mov_b32 s98, 0
    s_cmp_lt_u32 s96, s97
    s_cbranch_scc0 WB_49
    s_barrier
    s_add_u32 s96, s96, 1
    s_mov_b32 s98, s101
WB_49:
    buffer_load_dwordx4 v[184:187], v3, s[32:35], s9 offen sc1
    buffer_load_dwordx4 v[200:203], v3, s[32:35], s9 offen offset:2048 sc1
    s_add_u32 s9, s9, 4096
    buffer_load_dwordx4 v[188:191], v3, s[32:35], s9 offen sc1
    buffer_load_dwordx4 v[204:207], v3, s[32:35], s9 offen offset:2048 sc1
    s_mov_b32 s98, 0
    s_cmp_lt_u32 s96, s97
    s_cbranch_scc0 WB_50
    s_barrier
    s_add_u32 s96, s96, 1
    s_mov_b32 s98, s101
WB_50:
    v_bfe_u32 v6, v0, 1, 4
    s_mov_b32 s9, 33024
    v_mul_u32_u24 v6, s9, v6
    v_and_b32 v3, 1, v0
    v_lshl_add_u32 v6, v3, 5, v6
    v_bfe_u32 v3, v0, 5, 1
    v_lshl_add_u32 v6, v3, 4, v6
    s_lshl_b32 s8, s10, 7
    s_lshl_b32 s9, s11, 6
    s_add_u32 s8, s8, s9
    s_add_u32 s8, s8, 33554432
WV_13:
    s_getreg_b32 s99, hwreg(HW_REG_IB_STS, 22, 2)
    s_getreg_b32 s100, hwreg(HW_REG_IB_STS, 0, 4)
    s_lshl4_add_u32 s99, s99, s100
    s_cmp_le_u32 s99, 16
    s_cbranch_scc1 WV_13_ok
    s_sleep 1
    s_sub_u32 s98, s98, 1
    s_cbranch_scc0 WB_14
    s_mov_b32 s98, 0
    s_cmp_lt_u32 s96, s97
    s_cbranch_scc0 WB_14
    s_barrier
    s_add_u32 s96, s96, 1
    s_mov_b32 s98, s101
WB_14:
    s_sub_u32 s79, s79, 1
    s_cbranch_scc0 WV_13
    s_movk_i32 s78, 27
    s_branch K_bail
WV_13_ok:
    s_waitcnt vmcnt(16)
W_stok:
    v_and_b32 v243, 0xffff0000, v243
    v_add_f32 v112, v112, v128
    v_add_f32 v113, v113, v129
    v_add_f32 v114, v114, v130
    v_add_f32 v115, v115, v131
    v_add_f32 v116, v116, v132
    v_add_f32 v117, v117, v133
    v_add_f32 v118, v118, v134
    v_add_f32 v119, v119, v135
    v_add_f32 v120, v120, v136
    v_add_f32 v121, v121, v137
    v_add_f32 v122, v122, v138
    v_add_f32 v123, v123, v139
    v_add_f32 v124, v124, v140
    v_add_f32 v125, v125, v141
    s_sub_u32 s98, s98, 2
    s_cbranch_scc0 WB_51
    s_mov_b32 s98, 0
    s_cmp_lt_u32 s96, s97
    s_cbranch_scc0 WB_51
    s_barrier
    s_add_u32 s96, s96, 1
    s_mov_b32 s98, s101
WB_51:
    v_add_f32 v126, v126, v142
    v_add_f32 v127, v127, v143
    v_add_f32 v112, v112, v120
    v_add_f32 v113, v113, v121
    v_add_f32 v114, v114, v122
    v_add_f32 v115, v115, v123
    v_add_f32 v116, v116, v124
    v_add_f32 v117, v117, v125
    v_add_f32 v118, v118, v126
    v_add_f32 v119, v119, v127
    v_add_f32 v112, v112, v116
    v_add_f32 v113, v113, v117
    v_add_f32 v114, v114, v118
    v_add_f32 v115, v115, v119
    v_mov_b32 v116, v112
    v_mov_b32 v117, v113
    v_mov_b32 v118, v114
    v_mov_b32 v119, v115
    s_nop 0
    v_permlane32_swap_b32 v112, v116
    v_permlane32_swap_b32 v113, v117
    v_permlane32_swap_b32 v114, v118
    v_permlane32_swap_b32 v115, v119
    v_add_f32 v112, v112, v116
    v_add_f32 v113, v113, v117
    v_add_f32 v114, v114, v118
    v_add_f32 v115, v115, v119
    v_cvt_pk_bf16_f32 v128, v112, v113
    v_lshlrev_b32 v129, 16, v128
    v_and_b32 v130, 0xffff0000, v128
    v_sub_f32 v112, v112, v129
    v_sub_f32 v113, v113, v130
    v_cvt_pk_bf16_f32 v131, v112, v113
    v_lshlrev_b32 v129, 16, v131
    s_sub_u32 s98, s98, 2
    s_cbranch_scc0 WB_52
    s_mov_b32 s98, 0
    s_cmp_lt_u32 s96, s97
    s_cbranch_scc0 WB_52
    s_barrier
    s_add_u32 s96, s96, 1
    s_mov_b32 s98, s101
WB_52:
    v_and_b32 v130, 0xffff0000, v131
    v_sub_f32 v112, v112, v129
    v_sub_f32_e64 v113, v113, v130
    v_cvt_pk_bf16_f32 v132, v112, v113
    s_mov_b32 s51, 0x05040100
    s_mov_b32 s57, 0x07060302
    v_perm_b32 v120, v131, v128, s51
    v_perm_b32 v121, v240, v132, s51
    v_perm_b32 v122, v131, v128, s57
    v_perm_b32 v123, v240, v132, s57
    v_cvt_pk_bf16_f32 v128, v114, v115
    v_lshlrev_b32 v129, 16, v128
    v_and_b32 v130, 0xffff0000, v128
    v_sub_f32 v114, v114, v129
    v_sub_f32 v115, v115, v130
    v_cvt_pk_bf16_f32 v131, v114, v115
    v_lshlrev_b32 v129, 16, v131
    v_and_b32 v130, 0xffff0000, v131
    v_sub_f32 v114, v114, v129
    v_sub_f32 v115, v115, v130
    v_cvt_pk_bf16_f32 v132, v114, v115
    s_mov_b32 s51, 0x05040100
    s_mov_b32 s57, 0x07060302
    v_perm_b32 v124, v131, v128, s51
    v_perm_b32 v125, v241, v132, s51
    v_perm_b32 v126, v131, v128, s57
    v_perm_b32 v127, v241, v132, s57
    v_xor_b32 v242, 0x80000000, v242
    v_rcp_f32 v246, v243
    v_perm_b32 v244, v242, v242, s57
    v_perm_b32 v245, v243, v242, s57
    v_mul_f32 v246, v246, v246
    s_mul_i32 s51, s3, 896
    s_add_u32 s51, s51, 135168
    v_lshl_add_u32 v8, v7, 1, s51
    s_sub_u32 s98, s98, 2
    s_cbranch_scc0 WB_53
    s_mov_b32 s98, 0
    s_cmp_lt_u32 s96, s97
    s_cbranch_scc0 WB_53
    s_barrier
    s_add_u32 s96, s96, 1
    s_mov_b32 s98, s101
WB_53:
    s_lshl_b32 s51, s3, 9
    s_add_u32 s51, s51, 136960
    v_add_u32 v9, s51, v10
    s_lshl_b32 s51, s3, 8
    s_add_u32 s51, s51, 137984
    v_lshrrev_b32 v10, 1, v10
    v_add_u32 v10, s51, v10
    v_mov_b32 v11, 155908
    v_mov_b32 v12, 1
    ds_write_b64 v9, v[244:245]
    ds_write_b32 v10, v246
    s_mov_b32 exec_lo, 0x0fffffff
    s_mov_b32 exec_hi, 0
    ds_write_b128 v8, v[120:123]
    ds_write_b128 v8, v[124:127] offset:16
    s_mov_b64 exec, 1
    ds_add_u32 v11, v12
    s_mov_b64 exec, -1
W_dr:
    s_cmp_lt_u32 s96, 17
    s_cbranch_scc0 W_drd
    s_barrier
    s_add_u32 s96, s96, 1
    s_branch W_dr
W_drd:
    s_setprio 1
    s_lshl_b32 s50, s3, 13
    s_add_u32 s50, s50, 138496
    v_add_u32 v8, s50, v7
    s_cmp_eq_u32 s3, 0
    s_cbranch_scc0 W_c1
W_c0:
    ds_write_b128 v8, v[16:19] offset:0
    ds_write_b128 v8, v[20:23] offset:1024
    ds_write_b128 v8, v[24:27] offset:2048
    ds_write_b128 v8, v[28:31] offset:3072
    ds_write_b128 v8, v[32:35] offset:4096
    ds_write_b128 v8, v[36:39] offset:5120
    ds_write_b128 v8, v[40:43] offset:6144
    ds_write_b128 v8, v[44:47] offset:7168
    s_branch W_c2
W_c1:
    ds_write_b128 v8, v[48:51] offset:0
    ds_write_b128 v8, v[52:55] offset:1024
    ds_write_b128 v8, v[56:59] offset:2048
    ds_write_b128 v8, v[60:63] offset:3072
    ds_write_b128 v8, v[64:67] offset:4096
    ds_write_b128 v8, v[68:71] offset:5120
    ds_write_b128 v8, v[72:75] offset:6144
    ds_write_b128 v8, v[76:79] offset:7168
W_c2:
    v_mov_b32 v8, 155924
    v_mov_b32 v9, 1
    s_mov_b64 exec, 1
    ds_add_u32 v8, v9
    s_mov_b64 exec, -1
F2_entry:
    s_waitcnt vmcnt(0)
HOPSa_0:
HOPa_0:
    s_cbranch_execz HOPa_1
    v_permlane32_swap_b32 v80, v96
    v_permlane32_swap_b32 v176, v192
    v_permlane32_swap_b32 v81, v97
    v_permlane32_swap_b32 v177, v193
    v_permlane32_swap_b32 v82, v98
    v_permlane32_swap_b32 v178, v194
    v_permlane32_swap_b32 v83, v99
    v_permlane32_swap_b32 v179, v195
    v_permlane32_swap_b32 v84, v100
    v_permlane32_swap_b32 v180, v196
    v_permlane32_swap_b32 v85, v101
    v_permlane32_swap_b32 v181, v197
    v_permlane32_swap_b32 v86, v102
    v_permlane32_swap_b32 v182, v198
    v_permlane32_swap_b32 v87, v103
    v_permlane32_swap_b32 v183, v199
    v_permlane32_swap_b32 v88, v104
    v_permlane32_swap_b32 v184, v200
    v_permlane32_swap_b32 v89, v105
HOPa_1:
    s_cbranch_execz HOPa_2
    v_permlane32_swap_b32 v185, v201
    v_permlane32_swap_b32 v90, v106
    v_permlane32_swap_b32 v186, v202
    v_permlane32_swap_b32 v91, v107
    v_permlane32_swap_b32 v187, v203
    v_permlane32_swap_b32 v92, v108
    v_permlane32_swap_b32 v188, v204
    v_permlane32_swap_b32 v93, v109
    v_permlane32_swap_b32 v189, v205
    v_permlane32_swap_b32 v94, v110
    v_permlane32_swap_b32 v190, v206
    v_permlane32_swap_b32 v95, v111
    v_permlane32_swap_b32 v191, v207
    s_nop 1
    v_mfma_f32_32x32x16_bf16 v[112:127], v[80:83], v[16:19], 0
    v_mfma_f32_32x32x16_bf16 v[128:143], v[80:83], v[32:35], 0
    v_mfma_f32_32x32x16_bf16 v[112:127], v[84:87], v[20:23], v[112:127]
    v_mfma_f32_32x32x16_bf16 v[128:143], v[84:87], v[36:39], v[128:143]
    v_mfma_f32_32x32x16_bf16 v[112:127], v[88:91], v[24:27], v[112:127]
    v_mfma_f32_32x32x16_bf16 v[128:143], v[88:91], v[40:43], v[128:143]
    v_mfma_f32_32x32x16_bf16 v[112:127], v[92:95], v[28:31], v[112:127]
    v_mfma_f32_32x32x16_bf16 v[128:143], v[92:95], v[44:47], v[128:143]
    v_mfma_f32_32x32x16_bf16 v[144:159], v[96:99], v[16:19], 0
    v_mfma_f32_32x32x16_bf16 v[160:175], v[96:99], v[32:35], 0
    s_nop 8
    v_mul_f32 v8, v112, v48
    v_mul_f32 v9, v128, v48
    v_fmac_f32 v8, v128, v49
    v_fma_f32 v9, -v112, v49, v9
    v_cvt_pk_bf16_f32 v80, v8, v9
    v_mul_f32 v10, v113, v50
    v_mul_f32 v11, v129, v50
    v_fmac_f32 v10, v129, v51
    v_fma_f32 v11, -v113, v51, v11
    v_cvt_pk_bf16_f32 v81, v10, v11
    v_mul_f32 v8, v114, v52
    v_mul_f32 v9, v130, v52
    v_fmac_f32 v8, v130, v53
    v_fma_f32 v9, -v114, v53, v9
    v_mfma_f32_32x32x16_bf16 v[144:159], v[100:103], v[20:23], v[144:159]
    v_cvt_pk_bf16_f32 v82, v8, v9
    v_mul_f32 v10, v115, v54
    v_mul_f32 v11, v131, v54
    v_fmac_f32 v10, v131, v55
    v_fma_f32 v11, -v115, v55, v11
HOPa_2:
    s_cbranch_execz HOPa_3
    v_cvt_pk_bf16_f32 v83, v10, v11
    v_mul_f32 v8, v116, v56
    v_mul_f32 v9, v132, v56
    v_fmac_f32 v8, v132, v57
    v_fma_f32 v9, -v116, v57, v9
    v_cvt_pk_bf16_f32 v84, v8, v9
    v_mul_f32 v10, v117, v58
    v_mul_f32 v11, v133, v58
    v_mfma_f32_32x32x16_bf16 v[160:175], v[100:103], v[36:39], v[160:175]
    v_fmac_f32 v10, v133, v59
    v_fma_f32 v11, -v117, v59, v11
    v_cvt_pk_bf16_f32 v85, v10, v11
    v_mul_f32 v8, v118, v60
    v_mul_f32 v9, v134, v60
    v_fmac_f32 v8, v134, v61
    v_fma_f32 v9, -v118, v61, v9
    v_cvt_pk_bf16_f32 v86, v8, v9
    v_mul_f32 v10, v119, v62
    v_mul_f32 v11, v135, v62
    v_fmac_f32 v10, v135, v63
    v_fma_f32 v11, -v119, v63, v11
    v_cvt_pk_bf16_f32 v87, v10, v11
    v_mfma_f32_32x32x16_bf16 v[144:159], v[104:107], v[24:27], v[144:159]
    v_mul_f32 v8, v120, v64
    v_mul_f32 v9, v136, v64
    v_fmac_f32 v8, v136, v65
    v_fma_f32 v9, -v120, v65, v9
    v_cvt_pk_bf16_f32 v88, v8, v9
    v_mul_f32 v10, v121, v66
    v_mul_f32 v11, v137, v66
    v_fmac_f32 v10, v137, v67
    v_fma_f32 v11, -v121, v67, v11
    v_cvt_pk_bf16_f32 v89, v10, v11
    v_mul_f32 v8, v122, v68
    v_mul_f32 v9, v138, v68
    v_fmac_f32 v8, v138, v69
    v_fma_f32 v9, -v122, v69, v9
    v_mfma_f32_32x32x16_bf16 v[160:175], v[104:107], v[40:43], v[160:175]
    v_cvt_pk_bf16_f32 v90, v8, v9
    v_mul_f32 v10, v123, v70
    v_mul_f32 v11, v139, v70
    v_fmac_f32 v10, v139, v71
    v_fma_f32 v11, -v123, v71, v11
    v_cvt_pk_bf16_f32 v91, v10, v11
HOPa_3:
    s_cbranch_execz HOPa_4
    v_mul_f32 v8, v124, v72
    v_mul_f32 v9, v140, v72
    v_fmac_f32 v8, v140, v73
    v_fma_f32 v9, -v124, v73, v9
    v_cvt_pk_bf16_f32 v92, v8, v9
    v_mul_f32 v10, v125, v74
    v_mul_f32 v11, v141, v74
    v_mfma_f32_32x32x16_bf16 v[144:159], v[108:111], v[28:31], v[144:159]
    v_fmac_f32 v10, v141, v75
    v_fma_f32 v11, -v125, v75, v11
    v_cvt_pk_bf16_f32 v93, v10, v11
    v_mul_f32 v8, v126, v76
    v_mul_f32 v9, v142, v76
    v_fmac_f32 v8, v142, v77
    v_fma_f32 v9, -v126, v77, v9
    v_cvt_pk_bf16_f32 v94, v8, v9
    v_mul_f32 v10, v127, v78
    v_mul_f32 v11, v143, v78
    v_fmac_f32 v10, v143, v79
    v_fma_f32 v11, -v127, v79, v11
    v_cvt_pk_bf16_f32 v95, v10, v11
    v_mfma_f32_32x32x16_bf16 v[160:175], v[108:111], v[44:47], v[160:175]
    s_nop 1
    v_mfma_f32_32x32x16_bf16 v[112:127], v[16:19], v[80:83], 0
    v_mfma_f32_32x32x16_bf16 v[128:143], v[32:35], v[80:83], 0
    s_nop 8
    v_mul_f32 v12, v144, v48
    v_mul_f32 v13, v160, v48
    v_fmac_f32 v12, v160, v49
    v_fma_f32 v13, -v144, v49, v13
    v_cvt_pk_bf16_f32 v96, v12, v13
    v_mul_f32 v14, v145, v50
    v_mul_f32 v15, v161, v50
    v_fmac_f32 v14, v161, v51
    v_fma_f32 v15, -v145, v51, v15
    v_cvt_pk_bf16_f32 v97, v14, v15
    v_mul_f32 v12, v146, v52
    v_mul_f32 v13, v162, v52
    v_fmac_f32 v12, v162, v53
    v_fma_f32 v13, -v146, v53, v13
    v_mfma_f32_32x32x16_bf16 v[112:127], v[20:23], v[84:87], v[112:127]
    v_cvt_pk_bf16_f32 v98, v12, v13
    v_mul_f32 v14, v147, v54
HOPa_4:
    s_cbranch_execz HOPa_5
    v_mul_f32 v15, v163, v54
    v_fmac_f32 v14, v163, v55
    v_fma_f32 v15, -v147, v55, v15
    v_cvt_pk_bf16_f32 v99, v14, v15
    v_mul_f32 v12, v148, v56
    v_mul_f32 v13, v164, v56
    v_fmac_f32 v12, v164, v57
    v_fma_f32 v13, -v148, v57, v13
    v_cvt_pk_bf16_f32 v100, v12, v13
    v_mul_f32 v14, v149, v58
    v_mul_f32 v15, v165, v58
    v_mfma_f32_32x32x16_bf16 v[128:143], v[36:39], v[84:87], v[128:143]
    v_fmac_f32 v14, v165, v59
    v_fma_f32 v15, -v149, v59, v15
    v_cvt_pk_bf16_f32 v101, v14, v15
    v_mul_f32 v12, v150, v60
    v_mul_f32 v13, v166, v60
    v_fmac_f32 v12, v166, v61
    v_fma_f32 v13, -v150, v61, v13
    v_cvt_pk_bf16_f32 v102, v12, v13
    v_mul_f32 v14, v151, v62
    v_mul_f32 v15, v167, v62
    v_fmac_f32 v14, v167, v63
    v_fma_f32 v15, -v151, v63, v15
    v_cvt_pk_bf16_f32 v103, v14, v15
    v_mfma_f32_32x32x16_bf16 v[112:127], v[24:27], v[88:91], v[112:127]
    v_mul_f32 v12, v152, v64
    v_mul_f32 v13, v168, v64
    v_fmac_f32 v12, v168, v65
    v_fma_f32 v13, -v152, v65, v13
    v_cvt_pk_bf16_f32 v104, v12, v13
    v_mul_f32 v14, v153, v66
    v_mul_f32 v15, v169, v66
    v_fmac_f32 v14, v169, v67
    v_fma_f32 v15, -v153, v67, v15
    v_cvt_pk_bf16_f32 v105, v14, v15
    v_mul_f32 v12, v154, v68
    v_mul_f32 v13, v170, v68
    v_fmac_f32 v12, v170, v69
    v_fma_f32 v13, -v154, v69, v13
    v_mfma_f32_32x32x16_bf16 v[128:143], v[40:43], v[88:91], v[128:143]
    v_cvt_pk_bf16_f32 v106, v12, v13
    v_mul_f32 v14, v155, v70
    v_mul_f32 v15, v171, v70
HOPa_5:
    s_cbranch_execz HOPa_6
    v_fmac_f32 v14, v171, v71
    v_fma_f32 v15, -v155, v71, v15
    v_cvt_pk_bf16_f32 v107, v14, v15
    v_mul_f32 v12, v156, v72
    v_mul_f32 v13, v172, v72
    v_fmac_f32 v12, v172, v73
    v_fma_f32 v13, -v156, v73, v13
    v_cvt_pk_bf16_f32 v108, v12, v13
    v_mul_f32 v14, v157, v74
    v_mul_f32 v15, v173, v74
    v_mfma_f32_32x32x16_bf16 v[112:127], v[28:31], v[92:95], v[112:127]
    v_fmac_f32 v14, v173, v75
    v_fma_f32 v15, -v157, v75, v15
    v_cvt_pk_bf16_f32 v109, v14, v15
    v_mul_f32 v12, v158, v76
    v_mul_f32 v13, v174, v76
    v_fmac_f32 v12, v174, v77
    v_fma_f32 v13, -v158, v77, v13
    v_cvt_pk_bf16_f32 v110, v12, v13
    v_mul_f32 v14, v159, v78
    v_mul_f32 v15, v175, v78
    v_fmac_f32 v14, v175, v79
    v_fma_f32 v15, -v159, v79, v15
    v_cvt_pk_bf16_f32 v111, v14, v15
    v_mfma_f32_32x32x16_bf16 v[128:143], v[44:47], v[92:95], v[128:143]
    s_nop 1
    v_mfma_f32_32x32x16_bf16 v[144:159], v[16:19], v[96:99], 0
    v_mfma_f32_32x32x16_bf16 v[160:175], v[32:35], v[96:99], 0
    v_mfma_f32_32x32x16_bf16 v[144:159], v[20:23], v[100:103], v[144:159]
    v_mfma_f32_32x32x16_bf16 v[160:175], v[36:39], v[100:103], v[160:175]
    v_mfma_f32_32x32x16_bf16 v[144:159], v[24:27], v[104:107], v[144:159]
    v_mfma_f32_32x32x16_bf16 v[160:175], v[40:43], v[104:107], v[160:175]
    v_mfma_f32_32x32x16_bf16 v[144:159], v[28:31], v[108:111], v[144:159]
    v_mfma_f32_32x32x16_bf16 v[160:175], v[44:47], v[108:111], v[160:175]
    v_lshlrev_b32 v240, 16, v176
    v_and_b32 v241, 0xffff0000, v176
    v_lshlrev_b32 v242, 16, v192
    v_and_b32 v243, 0xffff0000, v192
    v_pk_add_f32 v[244:245], v[240:241], v[242:243]
HOPa_6:
    s_cbranch_execz HOPa_7
    v_pk_add_f32 v[242:243], v[240:241], v[242:243] neg_lo:[0,1] neg_hi:[0,1]
    v_pk_fma_f32 v[240:241], v[208:209], v[242:243], v[244:245] op_sel:[1,0,0] op_sel_hi:[1,1,1] neg_lo:[1,0,0] neg_hi:[1,0,0]
    v_pk_mul_f32 v[246:247], v[208:209], v[242:243] op_sel:[0,0] op_sel_hi:[0,1]
    v_pk_fma_f32 v[244:245], v[208:209], v[242:243], v[244:245] op_sel:[1,0,0] op_sel_hi:[1,1,1]
    v_lshlrev_b32 v248, 16, v177
    v_and_b32 v249, 0xffff0000, v177
    v_lshlrev_b32 v250, 16, v193
    v_and_b32 v251, 0xffff0000, v193
    v_pk_add_f32 v[252:253], v[248:249], v[250:251]
    v_pk_add_f32 v[250:251], v[248:249], v[250:251] neg_lo:[0,1] neg_hi:[0,1]
    v_pk_fma_f32 v[248:249], v[210:211], v[250:251], v[252:253] op_sel:[1,0,0] op_sel_hi:[1,1,1] neg_lo:[1,0,0] neg_hi:[1,0,0]
    v_pk_mul_f32 v[254:255], v[210:211], v[250:251] op_sel:[0,0] op_sel_hi:[0,1]
    v_pk_fma_f32 v[252:253], v[210:211], v[250:251], v[252:253] op_sel:[1,0,0] op_sel_hi:[1,1,1]
    v_pk_mul_f32 v[8:9], v[112:113], v[240:241] op_sel:[0,0] op_sel_hi:[0,1]
    v_pk_mul_f32 v[10:11], v[144:145], v[244:245] op_sel:[0,0] op_sel_hi:[0,1]
    v_pk_fma_f32 v[8:9], v[128:129], v[240:241], v[8:9] op_sel:[0,1,0] op_sel_hi:[0,0,1] neg_lo:[0,1,0]
    v_pk_fma_f32 v[10:11], v[160:161], v[244:245], v[10:11] op_sel:[0,1,0] op_sel_hi:[0,0,1] neg_lo:[0,1,0]
    v_pk_fma_f32 v[8:9], v[144:145], v[246:247], v[8:9] op_sel:[0,1,0] op_sel_hi:[0,0,1] neg_lo:[0,1,0]
    v_pk_fma_f32 v[10:11], v[112:113], v[246:247], v[10:11] op_sel:[0,1,0] op_sel_hi:[0,0,1] neg_hi:[0,1,0]
    v_pk_fma_f32 v[8:9], v[160:161], v[246:247], v[8:9] op_sel:[0,0,0] op_sel_hi:[0,1,1] neg_lo:[0,1,0] neg_hi:[0,1,0]
    v_pk_fma_f32 v[10:11], v[128:129], v[246:247], v[10:11] op_sel:[0,0,0] op_sel_hi:[0,1,1]
    v_cvt_pk_bf16_f32 v80, v9, v8
    v_cvt_pk_bf16_f32 v96, v11, v10
    v_lshlrev_b32 v240, 16, v178
    v_and_b32 v241, 0xffff0000, v178
    v_lshlrev_b32 v242, 16, v194
    v_and_b32 v243, 0xffff0000, v194
    v_pk_add_f32 v[244:245], v[240:241], v[242:243]
    v_pk_add_f32 v[242:243], v[240:241], v[242:243] neg_lo:[0,1] neg_hi:[0,1]
    v_pk_fma_f32 v[240:241], v[212:213], v[242:243], v[244:245] op_sel:[1,0,0] op_sel_hi:[1,1,1] neg_lo:[1,0,0] neg_hi:[1,0,0]
    v_pk_mul_f32 v[246:247], v[212:213], v[242:243] op_sel:[0,0] op_sel_hi:[0,1]
    v_pk_fma_f32 v[244:245], v[212:213], v[242:243], v[244:245] op_sel:[1,0,0] op_sel_hi:[1,1,1]
    v_pk_mul_f32 v[12:13], v[112:113], v[248:249] op_sel:[1,0] op_sel_hi:[1,1]
    v_pk_mul_f32 v[14:15], v[144:145], v[252:253] op_sel:[1,0] op_sel_hi:[1,1]
HOPa_7:
    s_cbranch_execz HOPa_8
    v_pk_fma_f32 v[12:13], v[128:129], v[248:249], v[12:13] op_sel:[1,1,0] op_sel_hi:[1,0,1] neg_lo:[0,1,0]
    v_pk_fma_f32 v[14:15], v[160:161], v[252:253], v[14:15] op_sel:[1,1,0] op_sel_hi:[1,0,1] neg_lo:[0,1,0]
    v_pk_fma_f32 v[12:13], v[144:145], v[254:255], v[12:13] op_sel:[1,1,0] op_sel_hi:[1,0,1] neg_lo:[0,1,0]
    v_pk_fma_f32 v[14:15], v[112:113], v[254:255], v[14:15] op_sel:[1,1,0] op_sel_hi:[1,0,1] neg_hi:[0,1,0]
    v_pk_fma_f32 v[12:13], v[160:161], v[254:255], v[12:13] op_sel:[1,0,0] op_sel_hi:[1,1,1] neg_lo:[0,1,0] neg_hi:[0,1,0]
    v_pk_fma_f32 v[14:15], v[128:129], v[254:255], v[14:15] op_sel:[1,0,0] op_sel_hi:[1,1,1]
    v_cvt_pk_bf16_f32 v81, v13, v12
    v_cvt_pk_bf16_f32 v97, v15, v14
    v_lshlrev_b32 v248, 16, v179
    v_and_b32 v249, 0xffff0000, v179
    v_lshlrev_b32_e64 v250, 16, v195
    v_and_b32 v251, 0xffff0000, v195
    v_pk_add_f32 v[252:253], v[248:249], v[250:251]
    v_pk_add_f32 v[250:251], v[248:249], v[250:251] neg_lo:[0,1] neg_hi:[0,1]
    v_pk_fma_f32 v[248:249], v[214:215], v[250:251], v[252:253] op_sel:[1,0,0] op_sel_hi:[1,1,1] neg_lo:[1,0,0] neg_hi:[1,0,0]
    v_pk_mul_f32 v[254:255], v[214:215], v[250:251] op_sel:[0,0] op_sel_hi:[0,1]
    v_pk_fma_f32 v[252:253], v[214:215], v[250:251], v[252:253] op_sel:[1,0,0] op_sel_hi:[1,1,1]
    v_pk_mul_f32 v[8:9], v[114:115], v[240:241] op_sel:[0,0] op_sel_hi:[0,1]
    v_pk_mul_f32 v[10:11], v[146:147], v[244:245] op_sel:[0,0] op_sel_hi:[0,1]
    v_pk_fma_f32 v[8:9], v[130:131], v[240:241], v[8:9] op_sel:[0,1,0] op_sel_hi:[0,0,1] neg_lo:[0,1,0]
    v_pk_fma_f32 v[10:11], v[162:163], v[244:245], v[10:11] op_sel:[0,1,0] op_sel_hi:[0,0,1] neg_lo:[0,1,0]
    v_pk_fma_f32 v[8:9], v[146:147], v[246:247], v[8:9] op_sel:[0,1,0] op_sel_hi:[0,0,1] neg_lo:[0,1,0]
    v_pk_fma_f32 v[10:11], v[114:115], v[246:247], v[10:11] op_sel:[0,1,0] op_sel_hi:[0,0,1] neg_hi:[0,1,0]
    v_pk_fma_f32 v[8:9], v[162:163], v[246:247], v[8:9] op_sel:[0,0,0] op_sel_hi:[0,1,1] neg_lo:[0,1,0] neg_hi:[0,1,0]
    v_pk_fma_f32 v[10:11], v[130:131], v[246:247], v[10:11] op_sel:[0,0,0] op_sel_hi:[0,1,1]
    v_cvt_pk_bf16_f32 v82, v9, v8
    v_cvt_pk_bf16_f32 v98, v11, v10
    v_lshlrev_b32 v240, 16, v180
    v_and_b32 v241, 0xffff0000, v180
    v_lshlrev_b32_e64 v242, 16, v196
    v_and_b32 v243, 0xffff0000, v196
    v_pk_add_f32 v[244:245], v[240:241], v[242:243]
    v_pk_add_f32 v[242:243], v[240:241], v[242:243] neg_lo:[0,1] neg_hi:[0,1]
HOPa_8:
    s_cbranch_execz HOPa_9
    v_pk_fma_f32 v[240:241], v[216:217], v[242:243], v[244:245] op_sel:[1,0,0] op_sel_hi:[1,1,1] neg_lo:[1,0,0] neg_hi:[1,0,0]
    v_pk_mul_f32 v[246:247], v[216:217], v[242:243] op_sel:[0,0] op_sel_hi:[0,1]
    v_pk_fma_f32 v[244:245], v[216:217], v[242:243], v[244:245] op_sel:[1,0,0] op_sel_hi:[1,1,1]
    v_pk_mul_f32 v[12:13], v[114:115], v[248:249] op_sel:[1,0] op_sel_hi:[1,1]
    v_pk_mul_f32 v[14:15], v[146:147], v[252:253] op_sel:[1,0] op_sel_hi:[1,1]
    v_pk_fma_f32 v[12:13], v[130:131], v[248:249], v[12:13] op_sel:[1,1,0] op_sel_hi:[1,0,1] neg_lo:[0,1,0]
    v_pk_fma_f32 v[14:15], v[162:163], v[252:253], v[14:15] op_sel:[1,1,0] op_sel_hi:[1,0,1] neg_lo:[0,1,0]
    v_pk_fma_f32 v[12:13], v[146:147], v[254:255], v[12:13] op_sel:[1,1,0] op_sel_hi:[1,0,1] neg_lo:[0,1,0]
    v_pk_fma_f32 v[14:15], v[114:115], v[254:255], v[14:15] op_sel:[1,1,0] op_sel_hi:[1,0,1] neg_hi:[0,1,0]
    v_pk_fma_f32 v[12:13], v[162:163], v[254:255], v[12:13] op_sel:[1,0,0] op_sel_hi:[1,1,1] neg_lo:[0,1,0] neg_hi:[0,1,0]
    v_pk_fma_f32 v[14:15], v[130:131], v[254:255], v[14:15] op_sel:[1,0,0] op_sel_hi:[1,1,1]
    v_cvt_pk_bf16_f32 v83, v13, v12
    v_cvt_pk_bf16_f32 v99, v15, v14
    v_lshlrev_b32 v248, 16, v181
    v_and_b32 v249, 0xffff0000, v181
    v_lshlrev_b32 v250, 16, v197
    v_and_b32 v251, 0xffff0000, v197
    v_pk_add_f32 v[252:253], v[248:249], v[250:251]
    v_pk_add_f32 v[250:251], v[248:249], v[250:251] neg_lo:[0,1] neg_hi:[0,1]
    v_pk_fma_f32 v[248:249], v[218:219], v[250:251], v[252:253] op_sel:[1,0,0] op_sel_hi:[1,1,1] neg_lo:[1,0,0] neg_hi:[1,0,0]
    v_pk_mul_f32 v[254:255], v[218:219], v[250:251] op_sel:[0,0] op_sel_hi:[0,1]
    v_pk_fma_f32 v[252:253], v[218:219], v[250:251], v[252:253] op_sel:[1,0,0] op_sel_hi:[1,1,1]
    v_pk_mul_f32 v[8:9], v[116:117], v[240:241] op_sel:[0,0] op_sel_hi:[0,1]
    v_pk_mul_f32 v[10:11], v[148:149], v[244:245] op_sel:[0,0] op_sel_hi:[0,1]
    v_pk_fma_f32 v[8:9], v[132:133], v[240:241], v[8:9] op_sel:[0,1,0] op_sel_hi:[0,0,1] neg_lo:[0,1,0]
    v_pk_fma_f32 v[10:11], v[164:165], v[244:245], v[10:11] op_sel:[0,1,0] op_sel_hi:[0,0,1] neg_lo:[0,1,0]
    v_pk_fma_f32 v[8:9], v[148:149], v[246:247], v[8:9] op_sel:[0,1,0] op_sel_hi:[0,0,1] neg_lo:[0,1,0]
    v_pk_fma_f32 v[10:11], v[116:117], v[246:247], v[10:11] op_sel:[0,1,0] op_sel_hi:[0,0,1] neg_hi:[0,1,0]
    v_pk_fma_f32 v[8:9], v[164:165], v[246:247], v[8:9] op_sel:[0,0,0] op_sel_hi:[0,1,1] neg_lo:[0,1,0] neg_hi:[0,1,0]
    v_pk_fma_f32 v[10:11], v[132:133], v[246:247], v[10:11] op_sel:[0,0,0] op_sel_hi:[0,1,1]
    v_cvt_pk_bf16_f32 v84, v9, v8
    v_cvt_pk_bf16_f32 v100, v11, v10
HOPa_9:
    s_cbranch_execz HOPa_10
    v_lshlrev_b32 v240, 16, v182
    v_and_b32 v241, 0xffff0000, v182
    v_lshlrev_b32_e64 v242, 16, v198
    v_and_b32 v243, 0xffff0000, v198
    v_pk_add_f32 v[244:245], v[240:241], v[242:243]
    v_pk_add_f32 v[242:243], v[240:241], v[242:243] neg_lo:[0,1] neg_hi:[0,1]
    v_pk_fma_f32 v[240:241], v[220:221], v[242:243], v[244:245] op_sel:[1,0,0] op_sel_hi:[1,1,1] neg_lo:[1,0,0] neg_hi:[1,0,0]
    v_pk_mul_f32 v[246:247], v[220:221], v[242:243] op_sel:[0,0] op_sel_hi:[0,1]
    v_pk_fma_f32 v[244:245], v[220:221], v[242:243], v[244:245] op_sel:[1,0,0] op_sel_hi:[1,1,1]
    v_pk_mul_f32 v[12:13], v[116:117], v[248:249] op_sel:[1,0] op_sel_hi:[1,1]
    v_pk_mul_f32 v[14:15], v[148:149], v[252:253] op_sel:[1,0] op_sel_hi:[1,1]
    v_pk_fma_f32 v[12:13], v[132:133], v[248:249], v[12:13] op_sel:[1,1,0] op_sel_hi:[1,0,1] neg_lo:[0,1,0]
    v_pk_fma_f32 v[14:15], v[164:165], v[252:253], v[14:15] op_sel:[1,1,0] op_sel_hi:[1,0,1] neg_lo:[0,1,0]
    v_pk_fma_f32 v[12:13], v[148:149], v[254:255], v[12:13] op_sel:[1,1,0] op_sel_hi:[1,0,1] neg_lo:[0,1,0]
    v_pk_fma_f32 v[14:15], v[116:117], v[254:255], v[14:15] op_sel:[1,1,0] op_sel_hi:[1,0,1] neg_hi:[0,1,0]
    v_pk_fma_f32 v[12:13], v[164:165], v[254:255], v[12:13] op_sel:[1,0,0] op_sel_hi:[1,1,1] neg_lo:[0,1,0] neg_hi:[0,1,0]
    v_pk_fma_f32 v[14:15], v[132:133], v[254:255], v[14:15] op_sel:[1,0,0] op_sel_hi:[1,1,1]
    v_cvt_pk_bf16_f32 v85, v13, v12
    v_cvt_pk_bf16_f32 v101, v15, v14
    v_lshlrev_b32 v248, 16, v183
    v_and_b32 v249, 0xffff0000, v183
    v_lshlrev_b32 v250, 16, v199
    v_and_b32 v251, 0xffff0000, v199
    v_pk_add_f32 v[252:253], v[248:249], v[250:251]
    v_pk_add_f32 v[250:251], v[248:249], v[250:251] neg_lo:[0,1] neg_hi:[0,1]
    v_pk_fma_f32 v[248:249], v[222:223], v[250:251], v[252:253] op_sel:[1,0,0] op_sel_hi:[1,1,1] neg_lo:[1,0,0] neg_hi:[1,0,0]
    v_pk_mul_f32 v[254:255], v[222:223], v[250:251] op_sel:[0,0] op_sel_hi:[0,1]
    v_pk_fma_f32 v[252:253], v[222:223], v[250:251], v[252:253] op_sel:[1,0,0] op_sel_hi:[1,1,1]
    v_pk_mul_f32 v[8:9], v[118:119], v[240:241] op_sel:[0,0] op_sel_hi:[0,1]
    v_pk_mul_f32 v[10:11], v[150:151], v[244:245] op_sel:[0,0] op_sel_hi:[0,1]
    v_pk_fma_f32 v[8:9], v[134:135], v[240:241], v[8:9] op_sel:[0,1,0] op_sel_hi:[0,0,1] neg_lo:[0,1,0]
    v_pk_fma_f32 v[10:11], v[166:167], v[244:245], v[10:11] op_sel:[0,1,0] op_sel_hi:[0,0,1] neg_lo:[0,1,0]
    v_pk_fma_f32 v[8:9], v[150:151], v[246:247], v[8:9] op_sel:[0,1,0] op_sel_hi:[0,0,1] neg_lo:[0,1,0]
HOPa_10:
    s_cbranch_execz HOPa_11
    v_pk_fma_f32 v[10:11], v[118:119], v[246:247], v[10:11] op_sel:[0,1,0] op_sel_hi:[0,0,1] neg_hi:[0,1,0]
    v_pk_fma_f32 v[8:9], v[166:167], v[246:247], v[8:9] op_sel:[0,0,0] op_sel_hi:[0,1,1] neg_lo:[0,1,0] neg_hi:[0,1,0]
    v_pk_fma_f32 v[10:11], v[134:135], v[246:247], v[10:11] op_sel:[0,0,0] op_sel_hi:[0,1,1]
    v_cvt_pk_bf16_f32 v86, v9, v8
    v_cvt_pk_bf16_f32 v102, v11, v10
    v_lshlrev_b32 v240, 16, v184
    v_and_b32 v241, 0xffff0000, v184
    v_lshlrev_b32_e64 v242, 16, v200
    v_and_b32 v243, 0xffff0000, v200
    v_pk_add_f32 v[244:245], v[240:241], v[242:243]
    v_pk_add_f32 v[242:243], v[240:241], v[242:243] neg_lo:[0,1] neg_hi:[0,1]
    v_pk_fma_f32 v[240:241], v[224:225], v[242:243], v[244:245] op_sel:[1,0,0] op_sel_hi:[1,1,1] neg_lo:[1,0,0] neg_hi:[1,0,0]
    v_pk_mul_f32 v[246:247], v[224:225], v[242:243] op_sel:[0,0] op_sel_hi:[0,1]
    v_pk_fma_f32 v[244:245], v[224:225], v[242:243], v[244:245] op_sel:[1,0,0] op_sel_hi:[1,1,1]
    v_pk_mul_f32 v[12:13], v[118:119], v[248:249] op_sel:[1,0] op_sel_hi:[1,1]
    v_pk_mul_f32 v[14:15], v[150:151], v[252:253] op_sel:[1,0] op_sel_hi:[1,1]
    v_pk_fma_f32 v[12:13], v[134:135], v[248:249], v[12:13] op_sel:[1,1,0] op_sel_hi:[1,0,1] neg_lo:[0,1,0]
    v_pk_fma_f32 v[14:15], v[166:167], v[252:253], v[14:15] op_sel:[1,1,0] op_sel_hi:[1,0,1] neg_lo:[0,1,0]
    v_pk_fma_f32 v[12:13], v[150:151], v[254:255], v[12:13] op_sel:[1,1,0] op_sel_hi:[1,0,1] neg_lo:[0,1,0]
    v_pk_fma_f32 v[14:15], v[118:119], v[254:255], v[14:15] op_sel:[1,1,0] op_sel_hi:[1,0,1] neg_hi:[0,1,0]
    v_pk_fma_f32 v[12:13], v[166:167], v[254:255], v[12:13] op_sel:[1,0,0] op_sel_hi:[1,1,1] neg_lo:[0,1,0] neg_hi:[0,1,0]
    v_pk_fma_f32 v[14:15], v[134:135], v[254:255], v[14:15] op_sel:[1,0,0] op_sel_hi:[1,1,1]
    v_cvt_pk_bf16_f32 v87, v13, v12
    v_cvt_pk_bf16_f32 v103, v15, v14
    v_lshlrev_b32 v248, 16, v185
    v_and_b32 v249, 0xffff0000, v185
    v_lshlrev_b32 v250, 16, v201
    v_and_b32 v251, 0xffff0000, v201
    v_pk_add_f32 v[252:253], v[248:249], v[250:251]
    v_pk_add_f32 v[250:251], v[248:249], v[250:251] neg_lo:[0,1] neg_hi:[0,1]
    v_pk_fma_f32 v[248:249], v[226:227], v[250:251], v[252:253] op_sel:[1,0,0] op_sel_hi:[1,1,1] neg_lo:[1,0,0] neg_hi:[1,0,0]
    v_pk_mul_f32 v[254:255], v[226:227], v[250:251] op_sel:[0,0] op_sel_hi:[0,1]
    v_pk_fma_f32 v[252:253], v[226:227], v[250:251], v[252:253] op_sel:[1,0,0] op_sel_hi:[1,1,1]
HOPa_11:
    s_cbranch_execz HOPa_12
    s_nop 0
    v_pk_mul_f32 v[8:9], v[120:121], v[240:241] op_sel:[0,0] op_sel_hi:[0,1]
    v_pk_mul_f32 v[10:11], v[152:153], v[244:245] op_sel:[0,0] op_sel_hi:[0,1]
    v_pk_fma_f32 v[8:9], v[136:137], v[240:241], v[8:9] op_sel:[0,1,0] op_sel_hi:[0,0,1] neg_lo:[0,1,0]
    v_pk_fma_f32 v[10:11], v[168:169], v[244:245], v[10:11] op_sel:[0,1,0] op_sel_hi:[0,0,1] neg_lo:[0,1,0]
    v_pk_fma_f32 v[8:9], v[152:153], v[246:247], v[8:9] op_sel:[0,1,0] op_sel_hi:[0,0,1] neg_lo:[0,1,0]
    v_pk_fma_f32 v[10:11], v[120:121], v[246:247], v[10:11] op_sel:[0,1,0] op_sel_hi:[0,0,1] neg_hi:[0,1,0]
    v_pk_fma_f32 v[8:9], v[168:169], v[246:247], v[8:9] op_sel:[0,0,0] op_sel_hi:[0,1,1] neg_lo:[0,1,0] neg_hi:[0,1,0]
    v_pk_fma_f32 v[10:11], v[136:137], v[246:247], v[10:11] op_sel:[0,0,0] op_sel_hi:[0,1,1]
    v_cvt_pk_bf16_f32 v88, v9, v8
    v_cvt_pk_bf16_f32 v104, v11, v10
    v_lshlrev_b32 v240, 16, v186
    v_and_b32 v241, 0xffff0000, v186
    v_lshlrev_b32 v242, 16, v202
    v_and_b32 v243, 0xffff0000, v202
    v_pk_add_f32 v[244:245], v[240:241], v[242:243]
    v_pk_add_f32 v[242:243], v[240:241], v[242:243] neg_lo:[0,1] neg_hi:[0,1]
    v_pk_fma_f32 v[240:241], v[228:229], v[242:243], v[244:245] op_sel:[1,0,0] op_sel_hi:[1,1,1] neg_lo:[1,0,0] neg_hi:[1,0,0]
    v_pk_mul_f32 v[246:247], v[228:229], v[242:243] op_sel:[0,0] op_sel_hi:[0,1]
    v_pk_fma_f32 v[244:245], v[228:229], v[242:243], v[244:245] op_sel:[1,0,0] op_sel_hi:[1,1,1]
    v_pk_mul_f32 v[12:13], v[120:121], v[248:249] op_sel:[1,0] op_sel_hi:[1,1]
    v_pk_mul_f32 v[14:15], v[152:153], v[252:253] op_sel:[1,0] op_sel_hi:[1,1]
    v_pk_fma_f32 v[12:13], v[136:137], v[248:249], v[12:13] op_sel:[1,1,0] op_sel_hi:[1,0,1] neg_lo:[0,1,0]
    v_pk_fma_f32 v[14:15], v[168:169], v[252:253], v[14:15] op_sel:[1,1,0] op_sel_hi:[1,0,1] neg_lo:[0,1,0]
    v_pk_fma_f32 v[12:13], v[152:153], v[254:255], v[12:13] op_sel:[1,1,0] op_sel_hi:[1,0,1] neg_lo:[0,1,0]
    v_pk_fma_f32 v[14:15], v[120:121], v[254:255], v[14:15] op_sel:[1,1,0] op_sel_hi:[1,0,1] neg_hi:[0,1,0]
    v_pk_fma_f32 v[12:13], v[168:169], v[254:255], v[12:13] op_sel:[1,0,0] op_sel_hi:[1,1,1] neg_lo:[0,1,0] neg_hi:[0,1,0]
    v_pk_fma_f32 v[14:15], v[136:137], v[254:255], v[14:15] op_sel:[1,0,0] op_sel_hi:[1,1,1]
    v_cvt_pk_bf16_f32 v89, v13, v12
    v_cvt_pk_bf16_f32 v105, v15, v14
    v_lshlrev_b32 v248, 16, v187
    v_and_b32 v249, 0xffff0000, v187
    v_lshlrev_b32_e64 v250, 16, v203
    v_and_b32 v251, 0xffff0000, v203
HOPa_12:
    s_cbranch_execz HOPa_13
    v_pk_add_f32 v[252:253], v[248:249], v[250:251]
    v_pk_add_f32 v[250:251], v[248:249], v[250:251] neg_lo:[0,1] neg_hi:[0,1]
    v_pk_fma_f32 v[248:249], v[230:231], v[250:251], v[252:253] op_sel:[1,0,0] op_sel_hi:[1,1,1] neg_lo:[1,0,0] neg_hi:[1,0,0]
    v_pk_mul_f32 v[254:255], v[230:231], v[250:251] op_sel:[0,0] op_sel_hi:[0,1]
    v_pk_fma_f32 v[252:253], v[230:231], v[250:251], v[252:253] op_sel:[1,0,0] op_sel_hi:[1,1,1]
    v_pk_mul_f32 v[8:9], v[122:123], v[240:241] op_sel:[0,0] op_sel_hi:[0,1]
    v_pk_mul_f32 v[10:11], v[154:155], v[244:245] op_sel:[0,0] op_sel_hi:[0,1]
    v_pk_fma_f32 v[8:9], v[138:139], v[240:241], v[8:9] op_sel:[0,1,0] op_sel_hi:[0,0,1] neg_lo:[0,1,0]
    v_pk_fma_f32 v[10:11], v[170:171], v[244:245], v[10:11] op_sel:[0,1,0] op_sel_hi:[0,0,1] neg_lo:[0,1,0]
    v_pk_fma_f32 v[8:9], v[154:155], v[246:247], v[8:9] op_sel:[0,1,0] op_sel_hi:[0,0,1] neg_lo:[0,1,0]
    v_pk_fma_f32 v[10:11], v[122:123], v[246:247], v[10:11] op_sel:[0,1,0] op_sel_hi:[0,0,1] neg_hi:[0,1,0]
    v_pk_fma_f32 v[8:9], v[170:171], v[246:247], v[8:9] op_sel:[0,0,0] op_sel_hi:[0,1,1] neg_lo:[0,1,0] neg_hi:[0,1,0]
    v_pk_fma_f32 v[10:11], v[138:139], v[246:247], v[10:11] op_sel:[0,0,0] op_sel_hi:[0,1,1]
    v_cvt_pk_bf16_f32 v90, v9, v8
    v_cvt_pk_bf16_f32 v106, v11, v10
    v_lshlrev_b32 v240, 16, v188
    v_and_b32 v241, 0xffff0000, v188
    v_lshlrev_b32 v242, 16, v204
    v_and_b32 v243, 0xffff0000, v204
    v_pk_add_f32 v[244:245], v[240:241], v[242:243]
    v_pk_add_f32 v[242:243], v[240:241], v[242:243] neg_lo:[0,1] neg_hi:[0,1]
    v_pk_fma_f32 v[240:241], v[232:233], v[242:243], v[244:245] op_sel:[1,0,0] op_sel_hi:[1,1,1] neg_lo:[1,0,0] neg_hi:[1,0,0]
    v_pk_mul_f32 v[246:247], v[232:233], v[242:243] op_sel:[0,0] op_sel_hi:[0,1]
    v_pk_fma_f32 v[244:245], v[232:233], v[242:243], v[244:245] op_sel:[1,0,0] op_sel_hi:[1,1,1]
    v_pk_mul_f32 v[12:13], v[122:123], v[248:249] op_sel:[1,0] op_sel_hi:[1,1]
    v_pk_mul_f32 v[14:15], v[154:155], v[252:253] op_sel:[1,0] op_sel_hi:[1,1]
    v_pk_fma_f32 v[12:13], v[138:139], v[248:249], v[12:13] op_sel:[1,1,0] op_sel_hi:[1,0,1] neg_lo:[0,1,0]
    v_pk_fma_f32 v[14:15], v[170:171], v[252:253], v[14:15] op_sel:[1,1,0] op_sel_hi:[1,0,1] neg_lo:[0,1,0]
    v_pk_fma_f32 v[12:13], v[154:155], v[254:255], v[12:13] op_sel:[1,1,0] op_sel_hi:[1,0,1] neg_lo:[0,1,0]
    v_pk_fma_f32 v[14:15], v[122:123], v[254:255], v[14:15] op_sel:[1,1,0] op_sel_hi:[1,0,1] neg_hi:[0,1,0]
    v_pk_fma_f32 v[12:13], v[170:171], v[254:255], v[12:13] op_sel:[1,0,0] op_sel_hi:[1,1,1] neg_lo:[0,1,0] neg_hi:[0,1,0]
    v_pk_fma_f32 v[14:15], v[138:139], v[254:255], v[14:15] op_sel:[1,0,0] op_sel_hi:[1,1,1]
HOPa_13:
    s_cbranch_execz HOPa_14
    v_cvt_pk_bf16_f32 v91, v13, v12
    v_cvt_pk_bf16_f32 v107, v15, v14
    v_lshlrev_b32 v248, 16, v189
    v_and_b32 v249, 0xffff0000, v189
    v_lshlrev_b32_e64 v250, 16, v205
    v_and_b32 v251, 0xffff0000, v205
    v_pk_add_f32 v[252:253], v[248:249], v[250:251]
    v_pk_add_f32 v[250:251], v[248:249], v[250:251] neg_lo:[0,1] neg_hi:[0,1]
    v_pk_fma_f32 v[248:249], v[234:235], v[250:251], v[252:253] op_sel:[1,0,0] op_sel_hi:[1,1,1] neg_lo:[1,0,0] neg_hi:[1,0,0]
    v_pk_mul_f32 v[254:255], v[234:235], v[250:251] op_sel:[0,0] op_sel_hi:[0,1]
    v_pk_fma_f32 v[252:253], v[234:235], v[250:251], v[252:253] op_sel:[1,0,0] op_sel_hi:[1,1,1]
    v_pk_mul_f32 v[8:9], v[124:125], v[240:241] op_sel:[0,0] op_sel_hi:[0,1]
    v_pk_mul_f32 v[10:11], v[156:157], v[244:245] op_sel:[0,0] op_sel_hi:[0,1]
    v_pk_fma_f32 v[8:9], v[140:141], v[240:241], v[8:9] op_sel:[0,1,0] op_sel_hi:[0,0,1] neg_lo:[0,1,0]
    v_pk_fma_f32 v[10:11], v[172:173], v[244:245], v[10:11] op_sel:[0,1,0] op_sel_hi:[0,0,1] neg_lo:[0,1,0]
    v_pk_fma_f32 v[8:9], v[156:157], v[246:247], v[8:9] op_sel:[0,1,0] op_sel_hi:[0,0,1] neg_lo:[0,1,0]
    v_pk_fma_f32 v[10:11], v[124:125], v[246:247], v[10:11] op_sel:[0,1,0] op_sel_hi:[0,0,1] neg_hi:[0,1,0]
    v_pk_fma_f32 v[8:9], v[172:173], v[246:247], v[8:9] op_sel:[0,0,0] op_sel_hi:[0,1,1] neg_lo:[0,1,0] neg_hi:[0,1,0]
    v_pk_fma_f32 v[10:11], v[140:141], v[246:247], v[10:11] op_sel:[0,0,0] op_sel_hi:[0,1,1]
    v_cvt_pk_bf16_f32 v92, v9, v8
    v_cvt_pk_bf16_f32 v108, v11, v10
    v_lshlrev_b32 v240, 16, v190
    v_and_b32 v241, 0xffff0000, v190
    v_lshlrev_b32 v242, 16, v206
    v_and_b32 v243, 0xffff0000, v206
    v_pk_add_f32 v[244:245], v[240:241], v[242:243]
    v_pk_add_f32 v[242:243], v[240:241], v[242:243] neg_lo:[0,1] neg_hi:[0,1]
    v_pk_fma_f32 v[240:241], v[236:237], v[242:243], v[244:245] op_sel:[1,0,0] op_sel_hi:[1,1,1] neg_lo:[1,0,0] neg_hi:[1,0,0]
    v_pk_mul_f32 v[246:247], v[236:237], v[242:243] op_sel:[0,0] op_sel_hi:[0,1]
    v_pk_fma_f32 v[244:245], v[236:237], v[242:243], v[244:245] op_sel:[1,0,0] op_sel_hi:[1,1,1]
    v_pk_mul_f32 v[12:13], v[124:125], v[248:249] op_sel:[1,0] op_sel_hi:[1,1]
    v_pk_mul_f32 v[14:15], v[156:157], v[252:253] op_sel:[1,0] op_sel_hi:[1,1]
    v_pk_fma_f32 v[12:13], v[140:141], v[248:249], v[12:13] op_sel:[1,1,0] op_sel_hi:[1,0,1] neg_lo:[0,1,0]
HOPa_14:
    s_cbranch_execz HOPSa_ret
    v_pk_fma_f32 v[14:15], v[172:173], v[252:253], v[14:15] op_sel:[1,1,0] op_sel_hi:[1,0,1] neg_lo:[0,1,0]
    v_pk_fma_f32 v[12:13], v[156:157], v[254:255], v[12:13] op_sel:[1,1,0] op_sel_hi:[1,0,1] neg_lo:[0,1,0]
    v_pk_fma_f32 v[14:15], v[124:125], v[254:255], v[14:15] op_sel:[1,1,0] op_sel_hi:[1,0,1] neg_hi:[0,1,0]
    v_pk_fma_f32 v[12:13], v[172:173], v[254:255], v[12:13] op_sel:[1,0,0] op_sel_hi:[1,1,1] neg_lo:[0,1,0] neg_hi:[0,1,0]
    v_pk_fma_f32 v[14:15], v[140:141], v[254:255], v[14:15] op_sel:[1,0,0] op_sel_hi:[1,1,1]
    v_cvt_pk_bf16_f32 v93, v13, v12
    v_cvt_pk_bf16_f32 v109, v15, v14
    v_lshlrev_b32 v248, 16, v191
    v_and_b32 v249, 0xffff0000, v191
    v_lshlrev_b32_e64 v250, 16, v207
    v_and_b32 v251, 0xffff0000, v207
    v_pk_add_f32 v[252:253], v[248:249], v[250:251]
    v_pk_add_f32 v[250:251], v[248:249], v[250:251] neg_lo:[0,1] neg_hi:[0,1]
    v_pk_fma_f32 v[248:249], v[238:239], v[250:251], v[252:253] op_sel:[1,0,0] op_sel_hi:[1,1,1] neg_lo:[1,0,0] neg_hi:[1,0,0]
    v_pk_mul_f32 v[254:255], v[238:239], v[250:251] op_sel:[0,0] op_sel_hi:[0,1]
    v_pk_fma_f32 v[252:253], v[238:239], v[250:251], v[252:253] op_sel:[1,0,0] op_sel_hi:[1,1,1]
    v_pk_mul_f32 v[8:9], v[126:127], v[240:241] op_sel:[0,0] op_sel_hi:[0,1]
    v_pk_mul_f32 v[10:11], v[158:159], v[244:245] op_sel:[0,0] op_sel_hi:[0,1]
    v_pk_fma_f32 v[8:9], v[142:143], v[240:241], v[8:9] op_sel:[0,1,0] op_sel_hi:[0,0,1] neg_lo:[0,1,0]
    v_pk_fma_f32 v[10:11], v[174:175], v[244:245], v[10:11] op_sel:[0,1,0] op_sel_hi:[0,0,1] neg_lo:[0,1,0]
    v_pk_fma_f32 v[8:9], v[158:159], v[246:247], v[8:9] op_sel:[0,1,0] op_sel_hi:[0,0,1] neg_lo:[0,1,0]
    v_pk_fma_f32 v[10:11], v[126:127], v[246:247], v[10:11] op_sel:[0,1,0] op_sel_hi:[0,0,1] neg_hi:[0,1,0]
    v_pk_fma_f32 v[8:9], v[174:175], v[246:247], v[8:9] op_sel:[0,0,0] op_sel_hi:[0,1,1] neg_lo:[0,1,0] neg_hi:[0,1,0]
    v_pk_fma_f32 v[10:11], v[142:143], v[246:247], v[10:11] op_sel:[0,0,0] op_sel_hi:[0,1,1]
    v_cvt_pk_bf16_f32 v94, v9, v8
    v_cvt_pk_bf16_f32 v110, v11, v10
    v_pk_mul_f32 v[12:13], v[126:127], v[248:249] op_sel:[1,0] op_sel_hi:[1,1]
    v_pk_mul_f32 v[14:15], v[158:159], v[252:253] op_sel:[1,0] op_sel_hi:[1,1]
    v_pk_fma_f32 v[12:13], v[142:143], v[248:249], v[12:13] op_sel:[1,1,0] op_sel_hi:[1,0,1] neg_lo:[0,1,0]
    v_pk_fma_f32 v[14:15], v[174:175], v[252:253], v[14:15] op_sel:[1,1,0] op_sel_hi:[1,0,1] neg_lo:[0,1,0]
    v_pk_fma_f32 v[12:13], v[158:159], v[254:255], v[12:13] op_sel:[1,1,0] op_sel_hi:[1,0,1] neg_lo:[0,1,0]
    v_pk_fma_f32 v[14:15], v[126:127], v[254:255], v[14:15] op_sel:[1,1,0] op_sel_hi:[1,0,1] neg_hi:[0,1,0]
HOPSa_1:
HOPa_15:
    s_cbranch_execz HOPa_16
    v_pk_fma_f32 v[12:13], v[174:175], v[254:255], v[12:13] op_sel:[1,0,0] op_sel_hi:[1,1,1] neg_lo:[0,1,0] neg_hi:[0,1,0]
    v_pk_fma_f32 v[14:15], v[142:143], v[254:255], v[14:15] op_sel:[1,0,0] op_sel_hi:[1,1,1]
    v_cvt_pk_bf16_f32 v95, v13, v12
    v_cvt_pk_bf16_f32 v111, v15, v14
    s_nop 1
    v_mfma_f32_32x32x16_bf16 v[112:127], v[80:83], v[16:19], 0
    v_mfma_f32_32x32x16_bf16 v[128:143], v[80:83], v[32:35], 0
    v_mfma_f32_32x32x16_bf16 v[112:127], v[84:87], v[20:23], v[112:127]
    v_mfma_f32_32x32x16_bf16 v[128:143], v[84:87], v[36:39], v[128:143]
    v_mfma_f32_32x32x16_bf16 v[112:127], v[88:91], v[24:27], v[112:127]
    v_mfma_f32_32x32x16_bf16 v[128:143], v[88:91], v[40:43], v[128:143]
    v_mfma_f32_32x32x16_bf16 v[112:127], v[92:95], v[28:31], v[112:127]
    v_mfma_f32_32x32x16_bf16 v[128:143], v[92:95], v[44:47], v[128:143]
    v_mfma_f32_32x32x16_bf16 v[144:159], v[96:99], v[16:19], 0
    v_mfma_f32_32x32x16_bf16 v[160:175], v[96:99], v[32:35], 0
    s_nop 8
    v_mul_f32 v8, v112, v48
    v_mul_f32 v9, v128, v48
    v_fmac_f32 v8, v128, v49
    v_fma_f32 v9, -v112, v49, v9
    v_cvt_pk_bf16_f32 v80, v8, v9
    v_mul_f32 v10, v113, v50
    v_mul_f32 v11, v129, v50
    v_fmac_f32 v10, v129, v51
    v_fma_f32 v11, -v113, v51, v11
    v_cvt_pk_bf16_f32 v81, v10, v11
    v_mul_f32 v8, v114, v52
    v_mul_f32 v9, v130, v52
    v_fmac_f32 v8, v130, v53
    v_fma_f32 v9, -v114, v53, v9
    v_mfma_f32_32x32x16_bf16 v[144:159], v[100:103], v[20:23], v[144:159]
    v_cvt_pk_bf16_f32 v82, v8, v9
    v_mul_f32 v10, v115, v54
    v_mul_f32 v11, v131, v54
    v_fmac_f32 v10, v131, v55
    v_fma_f32 v11, -v115, v55, v11
    v_cvt_pk_bf16_f32 v83, v10, v11
    v_mul_f32 v8, v116, v56
    v_mul_f32 v9, v132, v56
    v_fmac_f32 v8, v132, v57
HOPa_16:
    s_cbranch_execz HOPa_17
    v_fma_f32 v9, -v116, v57, v9
    v_cvt_pk_bf16_f32 v84, v8, v9
    v_mul_f32 v10, v117, v58
    v_mul_f32 v11, v133, v58
    v_mfma_f32_32x32x16_bf16 v[160:175], v[100:103], v[36:39], v[160:175]
    v_fmac_f32 v10, v133, v59
    v_fma_f32 v11, -v117, v59, v11
    v_cvt_pk_bf16_f32 v85, v10, v11
    v_mul_f32 v8, v118, v60
    v_mul_f32 v9, v134, v60
    v_fmac_f32 v8, v134, v61
    v_fma_f32 v9, -v118, v61, v9
    v_cvt_pk_bf16_f32 v86, v8, v9
    v_mul_f32 v10, v119, v62
    v_mul_f32 v11, v135, v62
    v_fmac_f32 v10, v135, v63
    v_fma_f32 v11, -v119, v63, v11
    v_cvt_pk_bf16_f32 v87, v10, v11
    v_mfma_f32_32x32x16_bf16 v[144:159], v[104:107], v[24:27], v[144:159]
    v_mul_f32 v8, v120, v64
    v_mul_f32 v9, v136, v64
    v_fmac_f32 v8, v136, v65
    v_fma_f32 v9, -v120, v65, v9
    v_cvt_pk_bf16_f32 v88, v8, v9
    v_mul_f32 v10, v121, v66
    v_mul_f32 v11, v137, v66
    v_fmac_f32 v10, v137, v67
    v_fma_f32 v11, -v121, v67, v11
    v_cvt_pk_bf16_f32 v89, v10, v11
    v_mul_f32 v8, v122, v68
    v_mul_f32 v9, v138, v68
    v_fmac_f32 v8, v138, v69
    v_fma_f32 v9, -v122, v69, v9
    v_mfma_f32_32x32x16_bf16 v[160:175], v[104:107], v[40:43], v[160:175]
    v_cvt_pk_bf16_f32 v90, v8, v9
    v_mul_f32 v10, v123, v70
    v_mul_f32 v11, v139, v70
    v_fmac_f32 v10, v139, v71
    v_fma_f32 v11, -v123, v71, v11
    v_cvt_pk_bf16_f32 v91, v10, v11
    v_mul_f32 v8, v124, v72
    v_mul_f32 v9, v140, v72
    v_fmac_f32 v8, v140, v73
    v_fma_f32 v9, -v124, v73, v9
HOPa_17:
    s_cbranch_execz HOPa_18
    v_cvt_pk_bf16_f32 v92, v8, v9
    v_mul_f32 v10, v125, v74
    v_mul_f32 v11, v141, v74
    v_mfma_f32_32x32x16_bf16 v[144:159], v[108:111], v[28:31], v[144:159]
    v_fmac_f32 v10, v141, v75
    v_fma_f32 v11, -v125, v75, v11
    v_cvt_pk_bf16_f32 v93, v10, v11
    v_mul_f32 v8, v126, v76
    v_mul_f32 v9, v142, v76
    v_fmac_f32 v8, v142, v77
    v_fma_f32 v9, -v126, v77, v9
    v_cvt_pk_bf16_f32 v94, v8, v9
    v_mul_f32 v10, v127, v78
    v_mul_f32 v11, v143, v78
    v_fmac_f32 v10, v143, v79
    v_fma_f32 v11, -v127, v79, v11
    v_cvt_pk_bf16_f32 v95, v10, v11
    v_mfma_f32_32x32x16_bf16 v[160:175], v[108:111], v[44:47], v[160:175]
    s_nop 1
    v_mfma_f32_32x32x16_bf16 v[112:127], v[16:19], v[80:83], 0
    v_mfma_f32_32x32x16_bf16 v[128:143], v[32:35], v[80:83], 0
    s_nop 8
    v_mul_f32 v12, v144, v48
    v_mul_f32 v13, v160, v48
    v_fmac_f32 v12, v160, v49
    v_fma_f32 v13, -v144, v49, v13
    v_cvt_pk_bf16_f32 v96, v12, v13
    v_mul_f32 v14, v145, v50
    v_mul_f32 v15, v161, v50
    v_fmac_f32 v14, v161, v51
    v_fma_f32 v15, -v145, v51, v15
    v_cvt_pk_bf16_f32 v97, v14, v15
    v_mul_f32 v12, v146, v52
    v_mul_f32 v13, v162, v52
    v_fmac_f32 v12, v162, v53
    v_fma_f32 v13, -v146, v53, v13
    v_mfma_f32_32x32x16_bf16 v[112:127], v[20:23], v[84:87], v[112:127]
    v_cvt_pk_bf16_f32 v98, v12, v13
    v_mul_f32 v14, v147, v54
    v_mul_f32 v15, v163, v54
    v_fmac_f32 v14, v163, v55
    v_fma_f32 v15, -v147, v55, v15
    v_cvt_pk_bf16_f32 v99, v14, v15
HOPa_18:
    s_cbranch_execz HOPa_19
    v_mul_f32 v12, v148, v56
    v_mul_f32 v13, v164, v56
    v_fmac_f32 v12, v164, v57
    v_fma_f32 v13, -v148, v57, v13
    s_mov_b32 s97, 37
    s_mov_b32 s101, 3
    s_mov_b32 s98, 0
    s_setprio 1
    s_mov_b32 s98, 0
    s_cmp_lt_u32 s96, s97
    s_cbranch_scc0 WB_54
    s_barrier
    s_add_u32 s96, s96, 1
    s_mov_b32 s98, s101
WB_54:
    v_cvt_pk_bf16_f32 v100, v12, v13
    v_mul_f32 v14, v149, v58
    v_mul_f32 v15, v165, v58
    v_mfma_f32_32x32x16_bf16 v[128:143], v[36:39], v[84:87], v[128:143]
    v_fmac_f32 v14, v165, v59
    v_fma_f32 v15, -v149, v59, v15
    v_cvt_pk_bf16_f32 v101, v14, v15
    v_mul_f32 v12, v150, v60
    v_mul_f32 v13, v166, v60
    v_fmac_f32 v12, v166, v61
    v_fma_f32 v13, -v150, v61, v13
    v_cvt_pk_bf16_f32 v102, v12, v13
    v_mul_f32 v14, v151, v62
    v_mul_f32 v15, v167, v62
    v_fmac_f32 v14, v167, v63
    v_fma_f32 v15, -v151, v63, v15
    v_cvt_pk_bf16_f32 v103, v14, v15
    v_mfma_f32_32x32x16_bf16 v[112:127], v[24:27], v[88:91], v[112:127]
    v_mul_f32 v12, v152, v64
    v_mul_f32 v13, v168, v64
    v_fmac_f32 v12, v168, v65
    v_fma_f32 v13, -v152, v65, v13
    v_cvt_pk_bf16_f32 v104, v12, v13
    v_mul_f32 v14, v153, v66
    v_mul_f32 v15, v169, v66
    v_fmac_f32 v14, v169, v67
    v_fma_f32 v15, -v153, v67, v15
    v_cvt_pk_bf16_f32 v105, v14, v15
    v_mul_f32 v12, v154, v68
    v_mul_f32 v13, v170, v68
    v_fmac_f32 v12, v170, v69
    v_fma_f32 v13, -v154, v69, v13
    v_mfma_f32_32x32x16_bf16 v[128:143], v[40:43], v[88:91], v[128:143]
HOPa_19:
    s_cbranch_execz HOPa_20
    v_cvt_pk_bf16_f32 v106, v12, v13
    v_mul_f32 v14, v155, v70
    v_mul_f32 v15, v171, v70
    v_fmac_f32 v14, v171, v71
    v_fma_f32 v15, -v155, v71, v15
    v_cvt_pk_bf16_f32 v107, v14, v15
    s_mov_b32 s98, 0
    s_cmp_lt_u32 s96, s97
    s_cbranch_scc0 WB_55
    s_barrier
    s_add_u32 s96, s96, 1
    s_mov_b32 s98, s101
WB_55:
    v_mul_f32 v12, v156, v72
    v_mul_f32 v13, v172, v72
    v_fmac_f32 v12, v172, v73
    v_fma_f32 v13, -v156, v73, v13
    v_cvt_pk_bf16_f32 v108, v12, v13
    v_mul_f32 v14, v157, v74
    v_mul_f32 v15, v173, v74
    v_mfma_f32_32x32x16_bf16 v[112:127], v[28:31], v[92:95], v[112:127]
    v_fmac_f32 v14, v173, v75
    v_fma_f32 v15, -v157, v75, v15
    v_cvt_pk_bf16_f32 v109, v14, v15
    v_mul_f32 v12, v158, v76
    v_mul_f32 v13, v174, v76
    v_fmac_f32 v12, v174, v77
    v_fma_f32 v13, -v158, v77, v13
    v_cvt_pk_bf16_f32 v110, v12, v13
    v_mul_f32 v14, v159, v78
    v_mul_f32 v15, v175, v78
    v_fmac_f32 v14, v175, v79
    v_fma_f32 v15, -v159, v79, v15
    v_cvt_pk_bf16_f32 v111, v14, v15
    v_mfma_f32_32x32x16_bf16 v[128:143], v[44:47], v[92:95], v[128:143]
    s_nop 1
    v_mfma_f32_32x32x16_bf16 v[144:159], v[16:19], v[96:99], 0
    v_mfma_f32_32x32x16_bf16 v[160:175], v[32:35], v[96:99], 0
    v_mfma_f32_32x32x16_bf16 v[144:159], v[20:23], v[100:103], v[144:159]
    s_mov_b32 s98, 0
    s_cmp_lt_u32 s96, s97
    s_cbranch_scc0 WB_56
    s_barrier
    s_add_u32 s96, s96, 1
    s_mov_b32 s98, s101
WB_56:
    v_mfma_f32_32x32x16_bf16 v[160:175], v[36:39], v[100:103], v[160:175]
HOPa_20:
    s_cbranch_execz HOPa_21
    v_mfma_f32_32x32x16_bf16 v[144:159], v[24:27], v[104:107], v[144:159]
    v_mfma_f32_32x32x16_bf16 v[160:175], v[40:43], v[104:107], v[160:175]
    v_mfma_f32_32x32x16_bf16 v[144:159], v[28:31], v[108:111], v[144:159]
    v_mfma_f32_32x32x16_bf16 v[160:175], v[44:47], v[108:111], v[160:175]
    s_and_b32 s9, s10, 255
    s_or_b32 s9, s9, s11
    s_cmp_lg_u32 s9, 0
    s_cbranch_scc1 W2_ns
    s_nop 11
    v_sub_f32 v112, v112, v144
    v_add_f32 v128, v128, v160
    v_mul_f32 v112, 0.5, v112
    v_mul_f32 v128, 0.5, v128
    v_sub_f32 v144, 0, v112
    v_mov_b32 v160, v128
    v_sub_f32 v113, v113, v145
    v_add_f32 v129, v129, v161
    v_mul_f32 v113, 0.5, v113
    v_mul_f32 v129, 0.5, v129
    v_sub_f32 v145, 0, v113
    v_mov_b32 v161, v129
    s_mov_b32 s98, 0
    s_cmp_lt_u32 s96, s97
    s_cbranch_scc0 WB_57
    s_barrier
    s_add_u32 s96, s96, 1
    s_mov_b32 s98, s101
WB_57:
    v_sub_f32 v114, v114, v146
    v_add_f32 v130, v130, v162
    v_mul_f32 v114, 0.5, v114
    v_mul_f32 v130, 0.5, v130
    v_sub_f32 v146, 0, v114
    v_mov_b32 v162, v130
    v_sub_f32 v115, v115, v147
    v_add_f32 v131, v131, v163
    v_mul_f32 v115, 0.5, v115
    v_mul_f32 v131, 0.5, v131
    v_sub_f32 v147, 0, v115
    v_mov_b32 v163, v131
    v_sub_f32 v116, v116, v148
    v_add_f32 v132, v132, v164
    v_mul_f32 v116, 0.5, v116
    v_mul_f32 v132, 0.5, v132
    v_sub_f32 v148, 0, v116
    v_mov_b32 v164, v132
    v_sub_f32 v117, v117, v149
    v_add_f32 v133, v133, v165
    v_mul_f32 v117, 0.5, v117
    v_mul_f32 v133, 0.5, v133
    v_sub_f32 v149, 0, v117
    v_mov_b32 v165, v133
    v_sub_f32 v118, v118, v150
    v_add_f32 v134, v134, v166
    v_mul_f32 v118, 0.5, v118
    v_mul_f32 v134, 0.5, v134
    v_sub_f32 v150, 0, v118
    v_mov_b32 v166, v134
    v_sub_f32 v119, v119, v151
HOPa_21:
    s_cbranch_execz HOPa_22
    v_add_f32 v135, v135, v167
    v_mul_f32 v119, 0.5, v119
    v_mul_f32 v135, 0.5, v135
    v_sub_f32 v151, 0, v119
    v_mov_b32 v167, v135
    v_sub_f32 v120, v120, v152
    v_add_f32 v136, v136, v168
    v_mul_f32 v120, 0.5, v120
    v_mul_f32 v136, 0.5, v136
    v_sub_f32 v152, 0, v120
    v_mov_b32 v168, v136
    v_sub_f32 v121, v121, v153
    v_add_f32 v137, v137, v169
    v_mul_f32 v121, 0.5, v121
    v_mul_f32 v137, 0.5, v137
    v_sub_f32 v153, 0, v121
    v_mov_b32 v169, v137
    v_sub_f32 v122, v122, v154
    v_add_f32 v138, v138, v170
    v_mul_f32 v122, 0.5, v122
    v_mul_f32 v138, 0.5, v138
    v_sub_f32 v154, 0, v122
    v_mov_b32 v170, v138
    v_sub_f32 v123, v123, v155
    v_add_f32 v139, v139, v171
    v_mul_f32 v123, 0.5, v123
    v_mul_f32 v139, 0.5, v139
    v_sub_f32 v155, 0, v123
    v_mov_b32 v171, v139
    s_mov_b32 s98, 0
    s_cmp_lt_u32 s96, s97
    s_cbranch_scc0 WB_58
    s_barrier
    s_add_u32 s96, s96, 1
    s_mov_b32 s98, s101
WB_58:
    v_sub_f32 v124, v124, v156
    v_add_f32 v140, v140, v172
    v_mul_f32 v124, 0.5, v124
    v_mul_f32 v140, 0.5, v140
    v_sub_f32 v156, 0, v124
    v_mov_b32 v172, v140
    v_sub_f32 v125, v125, v157
    v_add_f32 v141, v141, v173
    v_mul_f32 v125, 0.5, v125
    v_mul_f32 v141, 0.5, v141
    v_sub_f32 v157, 0, v125
    v_mov_b32 v173, v141
    v_sub_f32 v126, v126, v158
    v_add_f32 v142, v142, v174
    v_mul_f32 v126, 0.5, v126
    v_mul_f32 v142, 0.5, v142
    v_sub_f32 v158, 0, v126
    v_mov_b32 v174, v142
    v_sub_f32 v127, v127, v159
    v_add_f32 v143, v143, v175
    v_mul_f32 v127, 0.5, v127
    v_mul_f32 v143, 0.5, v143
    v_sub_f32 v159, 0, v127
    v_mov_b32_e64 v175, v143
W2_ns:
    v_cvt_pk_bf16_f32 v80, v112, v128
    v_cvt_pk_bf16_f32 v81, v113, v129
HOPa_22:
    s_cbranch_execz HOPa_23
    v_cvt_pk_bf16_f32 v82, v114, v130
    v_cvt_pk_bf16_f32 v83, v115, v131
    v_cvt_pk_bf16_f32 v84, v116, v132
    v_cvt_pk_bf16_f32 v85, v117, v133
    v_cvt_pk_bf16_f32 v86, v118, v134
    v_cvt_pk_bf16_f32 v87, v119, v135
    v_cvt_pk_bf16_f32 v88, v120, v136
    v_cvt_pk_bf16_f32 v89, v121, v137
    v_cvt_pk_bf16_f32 v90, v122, v138
    v_cvt_pk_bf16_f32 v91, v123, v139
    v_cvt_pk_bf16_f32 v92, v124, v140
    v_cvt_pk_bf16_f32 v93, v125, v141
    v_cvt_pk_bf16_f32 v94, v126, v142
    v_cvt_pk_bf16_f32 v95, v127, v143
    v_cvt_pk_bf16_f32 v176, -v144, v160
    v_cvt_pk_bf16_f32 v177, -v145, v161
    v_cvt_pk_bf16_f32 v178, -v146, v162
    v_cvt_pk_bf16_f32 v179, -v147, v163
    s_nop 1
    v_permlane32_swap_b32 v80, v176
    v_permlane32_swap_b32 v81, v177
    v_permlane32_swap_b32 v82, v178
    v_permlane32_swap_b32 v83, v179
    buffer_store_dwordx4 v[80:83], v6, s[32:35], s8 offen sc1
    s_mov_b32 s98, 0
    s_cmp_lt_u32 s96, s97
    s_cbranch_scc0 WB_59
    s_barrier
    s_add_u32 s96, s96, 1
    s_mov_b32 s98, s101
WB_59:
    s_add_u32 s8, s8, 528384
    buffer_store_dwordx4 v[176:179], v6, s[32:35], s8 offen sc1
    s_add_u32 s8, s8, 528384
    v_cvt_pk_bf16_f32 v180, -v148, v164
    v_cvt_pk_bf16_f32 v181, -v149, v165
    v_cvt_pk_bf16_f32 v182, -v150, v166
    v_cvt_pk_bf16_f32 v183, -v151, v167
HOPa_23:
    s_cbranch_execz HOPa_24
    s_nop 1
    v_permlane32_swap_b32 v84, v180
    v_permlane32_swap_b32 v85, v181
    v_permlane32_swap_b32 v86, v182
    v_permlane32_swap_b32 v87, v183
    buffer_store_dwordx4 v[84:87], v6, s[32:35], s8 offen sc1
    s_add_u32 s8, s8, 528384
    buffer_store_dwordx4 v[180:183], v6, s[32:35], s8 offen sc1
    s_mov_b32 s98, 0
    s_cmp_lt_u32 s96, s97
    s_cbranch_scc0 WB_60
    s_barrier
    s_add_u32 s96, s96, 1
    s_mov_b32 s98, s101
WB_60:
    s_add_u32 s8, s8, 528384
    v_cvt_pk_bf16_f32 v184, -v152, v168
    v_cvt_pk_bf16_f32 v185, -v153, v169
    v_cvt_pk_bf16_f32 v186, -v154, v170
    v_cvt_pk_bf16_f32 v187, -v155, v171
    s_nop 1
    v_permlane32_swap_b32 v88, v184
    v_permlane32_swap_b32 v89, v185
    v_permlane32_swap_b32 v90, v186
    v_permlane32_swap_b32 v91, v187
    buffer_store_dwordx4 v[88:91], v6, s[32:35], s8 offen sc1
    s_add_u32 s8, s8, 528384
    buffer_store_dwordx4 v[184:187], v6, s[32:35], s8 offen sc1
    s_add_u32 s8, s8, 528384
    v_cvt_pk_bf16_f32 v188, -v156, v172
    v_cvt_pk_bf16_f32 v189, -v157, v173
    v_cvt_pk_bf16_f32 v190, -v158, v174
    v_cvt_pk_bf16_f32 v191, -v159, v175
    s_nop 1
    v_permlane32_swap_b32 v92, v188
    v_permlane32_swap_b32 v93, v189
    v_permlane32_swap_b32 v94, v190
    v_permlane32_swap_b32 v95, v191
    buffer_store_dwordx4 v[92:95], v6, s[32:35], s8 offen sc1
    s_mov_b32 s98, 0
    s_cmp_lt_u32 s96, s97
    s_cbranch_scc0 WB_61
    s_barrier
    s_add_u32 s96, s96, 1
    s_mov_b32 s98, s101
WB_61:
    s_add_u32 s8, s8, 528384
HOPa_24:
    s_cbranch_execz HOPa_25
    buffer_store_dwordx4 v[188:191], v6, s[32:35], s8 offen sc1
    s_cmp_eq_u32 s10, 256
    s_cbranch_scc1 L_f2ret
    s_setprio 3
    s_lshr_b32 s50, s2, 5
    s_lshl_b32 s50, s50, 7
    s_and_b32 s51, s2, 31
    s_add_u32 s50, s51, s50
    s_add_u32 s50, s50, 59801600
    s_mov_b32 s51, 1
    s_cmp_eq_u32 s2, 1
    s_cselect_b32 s51, 2, 1
WV_15:
    s_getreg_b32 s99, hwreg(HW_REG_IB_STS)
    s_and_b32 s99, s99, 0xc0000f
    s_cbranch_scc0 WV_15_ok
    s_sleep 1
    s_sub_u32 s98, s98, 1
    s_cbranch_scc0 WB_16
    s_mov_b32 s98, 0
    s_cmp_lt_u32 s96, s97
    s_cbranch_scc0 WB_16
    s_barrier
    s_add_u32 s96, s96, 1
    s_mov_b32 s98, s101
WB_16:
    s_sub_u32 s79, s79, 1
    s_cbranch_scc0 WV_15
    s_movk_i32 s78, 28
    s_branch K_bail
WV_15_ok:
    s_waitcnt vmcnt(0)
    v_mov_b32 v8, 155916
    v_mov_b32 v9, 1
    s_mov_b64 exec, 1
    ds_add_rtn_u32 v9, v8, v9
    v_mov_b32_e64 v10, 1
    s_waitcnt lgkmcnt(0)
    v_cmp_eq_u32 vcc, s51, v9
    s_cbranch_vccz W_ar2
    buffer_store_byte v10, off, s[32:35], s50 sc0 sc1
W_ar2:
    s_mov_b64 exec, -1
    s_sub_u32 s98, s98, 2
    s_cbranch_scc0 WB_62
    s_mov_b32 s98, 0
    s_cmp_lt_u32 s96, s97
    s_cbranch_scc0 WB_62
    s_barrier
    s_add_u32 s96, s96, 1
    s_mov_b32 s98, s101
WB_62:
    s_lshr_b32 s52, s2, 3
    s_cmp_eq_u32 s52, 10
    s_cselect_b32 s52, 26, 29
W_dp:
    s_cmp_lt_u32 s96, s52
    s_cbranch_scc0 W_dpd
    s_barrier
    s_add_u32 s96, s96, 1
    s_branch W_dp
W_dpd:
HOPa_25:
    s_cbranch_execz HOPa_26
    s_mov_b32 s54, s64
    s_mov_b32 s55, s64
    s_lshr_b32 s52, s2, 3
    s_cmp_lg_u32 s52, 10
    s_cbranch_scc1 W_p2_w
    s_lshl_b32 s52, s3, 9
    s_add_u32 s52, s52, 59801600
W_p2:
    s_load_dwordx8 s[4:11], s[24:25], s52 offset:0 glc
    s_load_dwordx8 s[12:19], s[24:25], s52 offset:128 glc
    s_load_dwordx8 s[36:43], s[24:25], s52 offset:256 glc
    s_load_dwordx8 s[44:51], s[24:25], s52 offset:384 glc
WL_17:
    s_getreg_b32 s99, hwreg(HW_REG_IB_STS, 8, 4)
    s_cmp_eq_u32 s99, 0
    s_cbranch_scc1 WL_17_ok
    s_sleep 1
    s_sub_u32 s98, s98, 1
    s_cbranch_scc0 WB_18
    s_mov_b32 s98, 0
    s_cmp_lt_u32 s96, s97
    s_cbranch_scc0 WB_18
    s_barrier
    s_add_u32 s96, s96, 1
    s_mov_b32 s98, s101
WB_18:
    s_sub_u32 s79, s79, 1
    s_cbranch_scc0 WL_17
    s_movk_i32 s78, 29
    s_branch K_bail
WL_17_ok:
    s_waitcnt lgkmcnt(0)
    s_and_b64 s[4:5], s[4:5], s[6:7]
    s_and_b64 s[4:5], s[4:5], s[8:9]
    s_and_b64 s[4:5], s[4:5], s[10:11]
    s_and_b64 s[4:5], s[4:5], s[12:13]
    s_and_b64 s[4:5], s[4:5], s[14:15]
    s_and_b64 s[4:5], s[4:5], s[16:17]
    s_and_b64 s[4:5], s[4:5], s[18:19]
    s_and_b64 s[4:5], s[4:5], s[36:37]
    s_and_b64 s[4:5], s[4:5], s[38:39]
    s_and_b64 s[4:5], s[4:5], s[40:41]
    s_and_b64 s[4:5], s[4:5], s[42:43]
    s_and_b64 s[4:5], s[4:5], s[44:45]
    s_and_b64 s[4:5], s[4:5], s[46:47]
    s_and_b64 s[4:5], s[4:5], s[48:49]
    s_and_b64 s[4:5], s[4:5], s[50:51]
    s_and_b32 s4, s4, s5
    s_cmp_eq_u32 s4, 0x01010101
    s_cbranch_scc1 W_p2_ok
    s_sub_u32 s98, s98, 2
    s_cbranch_scc0 WB_63
    s_mov_b32 s98, 0
    s_cmp_lt_u32 s96, s97
    s_cbranch_scc0 WB_63
    s_barrier
    s_add_u32 s96, s96, 1
    s_mov_b32 s98, s101
WB_63:
    s_sub_u32 s79, s79, 1
    s_cbranch_scc0 W_p2
HOPa_26:
    s_cbranch_execz HOPa_27
    s_movk_i32 s78, 30
    s_branch K_bail
W_p2_ok:
    v_lshlrev_b32 v240, 6, v7
    v_mov_b32 v241, s64
    s_mov_b32 exec_hi, 0
    s_add_u32 s50, s2, 0
    s_and_b32 s50, s50, 7
    s_lshl_b32 s50, s50, 5
    s_add_u32 s50, s50, s3
    s_lshl_b32 s50, s50, 2
    s_add_u32 s50, s50, 59998208
    buffer_store_dword v241, v240, s[32:35], s50 offen sc0 sc1
    s_mov_b32 exec_hi, -1
W_p2_w:
    s_lshl_b32 s50, s2, 7
    s_add_u32 s50, s50, 59998208
W_p2_l:
    s_load_dwordx2 s[4:5], s[24:25], s50 glc
WL_19:
    s_getreg_b32 s99, hwreg(HW_REG_IB_STS, 8, 4)
    s_cmp_eq_u32 s99, 0
    s_cbranch_scc1 WL_19_ok
    s_sleep 1
    s_sub_u32 s98, s98, 1
    s_cbranch_scc0 WB_20
    s_mov_b32 s98, 0
    s_cmp_lt_u32 s96, s97
    s_cbranch_scc0 WB_20
    s_barrier
    s_add_u32 s96, s96, 1
    s_mov_b32 s98, s101
WB_20:
    s_sub_u32 s79, s79, 1
    s_cbranch_scc0 WL_19
    s_movk_i32 s78, 31
    s_branch K_bail
WL_19_ok:
    s_waitcnt lgkmcnt(0)
    s_cmp_eq_u64 s[4:5], s[54:55]
    s_cbranch_scc1 W_p2_d
    s_sleep 1
    s_sub_u32 s98, s98, 1
    s_cbranch_scc0 WB_64
    s_mov_b32 s98, 0
    s_cmp_lt_u32 s96, s97
    s_cbranch_scc0 WB_64
    s_barrier
    s_add_u32 s96, s96, 1
    s_mov_b32 s98, s101
WB_64:
    s_sub_u32 s79, s79, 1
    s_cbranch_scc0 W_p2_l
    s_movk_i32 s78, 32
    s_branch K_bail
W_p2_d:
    v_lshlrev_b32_e64 v5, 6, v1
    v_lshl_add_u32 v5, v2, 4, v5
    s_lshr_b32 s50, s75, 1
    s_mul_i32 s50, s50, 33024
    s_and_b32 s51, s75, 1
    s_lshl_b32 s51, s51, 5
    s_add_u32 s50, s50, s51
    s_add_u32 s50, s50, 33554432
HOPa_27:
    s_cbranch_execz HOPa_28
    s_add_u32 s52, s50, 32784
    s_lshl_b32 s51, s3, 13
    s_add_u32 m0, s51, 138496
    s_lshl_b32 s51, s3, 14
    s_add_u32 s50, s50, s51
W_de:
    s_cmp_lt_u32 s96, 29
    s_cbranch_scc0 W_ded
    s_barrier
    s_add_u32 s96, s96, 1
    s_branch W_de
W_ded:
    buffer_load_dwordx4 v5, s[32:35], s50 offen sc1 lds
    s_add_u32 m0, m0, 1024
    s_add_u32 s50, s50, 2048
    buffer_load_dwordx4 v5, s[32:35], s50 offen sc1 lds
    s_add_u32 m0, m0, 1024
    s_add_u32 s50, s50, 2048
    s_mov_b32 s98, 0
    s_cmp_lt_u32 s96, s97
    s_cbranch_scc0 WB_65
    s_barrier
    s_add_u32 s96, s96, 1
    s_mov_b32 s98, s101
WB_65:
    buffer_load_dwordx4 v5, s[32:35], s50 offen sc1 lds
    s_add_u32 m0, m0, 1024
    s_add_u32 s50, s50, 2048
    buffer_load_dwordx4 v5, s[32:35], s50 offen sc1 lds
    s_add_u32 m0, m0, 1024
    s_add_u32 s50, s50, 2048
    s_mov_b32 s98, 0
    s_cmp_lt_u32 s96, s97
    s_cbranch_scc0 WB_66
    s_barrier
    s_add_u32 s96, s96, 1
    s_mov_b32 s98, s101
WB_66:
    buffer_load_dwordx4 v5, s[32:35], s50 offen sc1 lds
    s_add_u32 m0, m0, 1024
    s_add_u32 s50, s50, 2048
    buffer_load_dwordx4 v5, s[32:35], s50 offen sc1 lds
    s_add_u32 m0, m0, 1024
    s_add_u32 s50, s50, 2048
    s_mov_b32 s98, 0
    s_cmp_lt_u32 s96, s97
HOPa_28:
    s_cbranch_execz HOPSa_ret
    s_cbranch_scc0 WB_67
    s_barrier
    s_add_u32 s96, s96, 1
    s_mov_b32 s98, s101
WB_67:
    buffer_load_dwordx4 v5, s[32:35], s50 offen sc1 lds
    s_add_u32 m0, m0, 1024
    s_add_u32 s50, s50, 2048
    buffer_load_dwordx4 v5, s[32:35], s50 offen sc1 lds
    s_mov_b32 m0, 155392
    s_add_u32 s50, s50, 2048
    s_mov_b64 exec, 1
    buffer_load_dwordx4 v5, s[32:35], s52 offen sc1 lds
    s_mov_b64 exec, -1
WV_21:
    s_getreg_b32 s99, hwreg(HW_REG_IB_STS)
    s_and_b32 s99, s99, 0xc0000f
    s_cbranch_scc0 WV_21_ok
    s_sleep 1
    s_sub_u32 s98, s98, 1
    s_cbranch_scc0 WB_22
    s_mov_b32 s98, 0
    s_cmp_lt_u32 s96, s97
    s_cbranch_scc0 WB_22
    s_barrier
    s_add_u32 s96, s96, 1
    s_mov_b32 s98, s101
WB_22:
    s_sub_u32 s79, s79, 1
    s_cbranch_scc0 WV_21
    s_movk_i32 s78, 33
    s_branch K_bail
WV_21_ok:
    s_waitcnt vmcnt(0)
    v_mov_b32 v8, 155932
    v_mov_b32 v9, 1
    s_mov_b64 exec, 1
    ds_add_u32 v8, v9
    s_mov_b64 exec, -1
    s_endpgm
K_bail:
    s_mov_b64 exec, 1
    v_lshrrev_b32 v1, 6, v0
    v_lshlrev_b32 v1, 2, v1
    s_lshl_b32 s79, s2, 8
    s_or_b32 s78, s78, s79
    v_mov_b32 v2, s78
    global_store_dword v1, v2, s[22:23] offset:16
K_end:
    s_endpgm
.section .rodata,"a"
.p2align 6
.amdhsa_kernel recurrent_scan__spectral_gfnet__dense_activation_squared_relu__prompt_kernel
  .amdhsa_next_free_vgpr 256
  .amdhsa_next_free_sgpr 102
  .amdhsa_accum_offset 256
  .amdhsa_group_segment_fixed_size 0
  .amdhsa_kernarg_size 88
  .amdhsa_user_sgpr_count 2
  .amdhsa_user_sgpr_kernarg_segment_ptr 1
  .amdhsa_system_sgpr_workgroup_id_x 1
  .amdhsa_float_denorm_mode_32 3
  .amdhsa_float_denorm_mode_16_64 3
.end_amdhsa_kernel
```
